```python
import torch

def _softmax(x, axis=-1):
    return torch.softmax(x, dim=axis)
def _gelu(x):
    return torch.nn.functional.gelu(x, approximate="tanh")
def _silu(x):
    return torch.nn.functional.silu(x)
def _sigmoid(x):
    return torch.sigmoid(x)
def _layernorm(x, axis=-1, eps=1e-5):
    m = x.mean(dim=axis, keepdim=True)
    v = x.var(dim=axis, keepdim=True, unbiased=False)
    return (x - m) / torch.sqrt(v + eps)
def _scatter_add(tgt, idx, src, axis=0):
    return tgt.clone().index_add_(axis, idx, src)
def _segment_sum(src, seg, n):
    out = torch.zeros((n,) + src.shape[1:], dtype=src.dtype)
    return out.index_add_(0, seg, src)
def _pad(x, pw):
    flat = tuple(v for pair in reversed(pw) for v in pair)
    return torch.nn.functional.pad(x, flat)

kernel_name = 'interleave_layers__ssm_conv_s4__mixer_token_mlp__prompt'

def setup_inputs():

    _w = (lambda a: (lambda t: t.to(torch.bfloat16) if t.is_floating_point() else t)(torch.as_tensor(a)))
    def _A_setup():
        B, L, D, N = 1, 2048, 448, 256
        A_re = -(lambda _x: torch.exp(torch.as_tensor(_x)))((lambda *s: torch.randn(*s, dtype=torch.bfloat16) * 3.2)(D, N))
        A_im = torch.pi * (lambda *s: torch.randn(*s, dtype=torch.bfloat16) * 0.05)(D, N)
        B_re = (lambda *s: torch.randn(*s, dtype=torch.bfloat16) * 0.05)(D, N)
        B_im = (lambda *s: torch.randn(*s, dtype=torch.bfloat16) * 0.05)(D, N)
        C_re = (lambda *s: torch.randn(*s, dtype=torch.bfloat16) * 0.05)(D, N)
        C_im = (lambda *s: torch.randn(*s, dtype=torch.bfloat16) * 0.05)(D, N)
        log_dt = (lambda *s: torch.randn(*s, dtype=torch.bfloat16) * 0.05)(D) * 0.5 - 4.0
        Dskip = (lambda *s: torch.randn(*s, dtype=torch.bfloat16) * 0.05)(D)
        return {
            "u": _w((lambda *s: torch.randn(*s, dtype=torch.bfloat16) * 0.05)(B, L, D)),
            "A_re": _w(A_re),
            "A_im": _w(A_im),
            "B_re": _w(B_re),
            "B_im": _w(B_im),
            "C_re": _w(C_re),
            "C_im": _w(C_im),
            "log_dt": _w(log_dt),
            "Dskip": _w(Dskip),
        }
    _A_in = _A_setup()

    def _B_setup():
        B, S, D, F = 1, 2048, 448, 1792
        return {
            "x": _w((lambda *s: torch.randn(*s, dtype=torch.bfloat16) * 0.05)(B, S, D)),
            "w1": _w((lambda *s: torch.randn(*s, dtype=torch.bfloat16) * 0.4)(S, F) * (S ** -0.5)),
            "b1": _w((lambda *s: torch.randn(*s, dtype=torch.bfloat16) * 0.2)(F) * 0.02),
            "w2": _w((lambda *s: torch.randn(*s, dtype=torch.bfloat16) * 0.2)(F, S) * (F ** -0.5)),
            "b2": _w((lambda *s: torch.randn(*s, dtype=torch.bfloat16) * 0.2)(S) * 0.02),
        }
    _B_in = _B_setup()

    return {
        "A_u": _A_in["u"],
        "A_A_re": _A_in["A_re"],
        "A_A_im": _A_in["A_im"],
        "A_B_re": _A_in["B_re"],
        "A_B_im": _A_in["B_im"],
        "A_C_re": _A_in["C_re"],
        "A_C_im": _A_in["C_im"],
        "A_log_dt": _A_in["log_dt"],
        "A_Dskip": _A_in["Dskip"],
        "B_x": _B_in["x"],
        "B_w1": _B_in["w1"],
        "B_b1": _B_in["b1"],
        "B_w2": _B_in["w2"],
        "B_b2": _B_in["b2"],
    }

def reference(A_u, A_A_re, A_A_im, A_B_re, A_B_im, A_C_re, A_C_im, A_log_dt, A_Dskip, B_x, B_w1, B_b1, B_w2, B_b2):
    def _A_ref(u, A_re, A_im, B_re, B_im, C_re, C_im, log_dt, Dskip):
        Bsz, L, D = u.shape
        dt = torch.exp(log_dt)[:, None]
        A = A_re + 1j * A_im
        Bc = B_re + 1j * B_im
        Cc = C_re + 1j * C_im
        logdA = dt * A
        dB = dt * Bc
        l = (lambda x, dt: x.to(dt))(torch.arange(L), A_re.dtype)
        P = torch.exp(logdA[:, :, None] * l[None, None, :])
        K = torch.einsum("dn,dnl,dn->dl", Cc, P, dB).real
        L2 = 2 * L
        Kp = _pad(K, ((0, 0), (0, L)))
        up = (lambda x, *d: x.permute(*d))(u, 0, 2, 1)
        up = _pad(up, ((0, 0), (0, 0), (0, L)))
        Kf = (lambda x, axes=(-2,-1): torch.fft.rfft2(x.float(), dim=axes))(Kp[:, None, :], axes=(-2, -1))
        Uf = (lambda x, axes=(-2,-1): torch.fft.rfft2(x.float(), dim=axes))(up[:, :, None, :], axes=(-2, -1))
        Yf = Uf * Kf[None, :, :, :]
        y = (lambda x, s, axes=(-2,-1): torch.fft.irfft2(x, s=s, dim=axes).to(torch.bfloat16))(Yf, (1, L2), axes=(-2, -1))[:, :, 0, :L]
        y = (lambda x, *d: x.permute(*d))(y, 0, 2, 1) + u * Dskip[None, None, :]
        return y

    def _B_ref(x, w1, b1, w2, b2):
        B, S, D = x.shape
        h = _layernorm(x, axis=-1)
        u = torch.einsum("bsd,sf->bdf", h, w1) + b1
        u = _gelu(u)
        y = torch.einsum("bdf,fs->bds", u, w2) + b2
        return (lambda x, *d: x.permute(*d))(y, 0, 2, 1)

    x = A_u
    x = x + _A_ref(_layernorm(x, axis=-1), A_A_re, A_A_im, A_B_re, A_B_im, A_C_re, A_C_im, A_log_dt, A_Dskip)
    x = x + _B_ref(_layernorm(x, axis=-1), B_w1, B_b1, B_w2, B_b2)
    x = x + _A_ref(_layernorm(x, axis=-1), A_A_re, A_A_im, A_B_re, A_B_im, A_C_re, A_C_im, A_log_dt, A_Dskip)
    x = x + _B_ref(_layernorm(x, axis=-1), B_w1, B_b1, B_w2, B_b2)
    return x
```

```asm
; @launch grid=(256,1,1) block=(256,1,1) lds=163840
.amdgcn_target "amdgcn-amd-amdhsa--gfx950"
.text
.globl interleave_layers__ssm_conv_s4__mixer_token_mlp__prompt_kernel
.p2align 8
.type interleave_layers__ssm_conv_s4__mixer_token_mlp__prompt_kernel,@function
interleave_layers__ssm_conv_s4__mixer_token_mlp__prompt_kernel:
    s_cmp_ge_u32 s2, 24
    s_cbranch_scc1 Lt_1
    s_getpc_b64 s[80:81]
L_pc:
    s_lshr_b32 s72, s2, 3
    s_lshl_b32 s72, s72, 14
    v_lshl_add_u32 v5, v0, 6, s72
    v_min_u32 v5, L_end-L_pc, v5
    global_load_dword a254, v5, s[80:81]
Lt_1:
    s_cmp_ge_u32 s2, 256
    s_cbranch_scc1 L_end
    s_load_dwordx16 s[16:31], s[0:1], 0
    s_load_dwordx16 s[32:47], s[0:1], 64
    s_load_dwordx2 s[48:49], s[0:1], 128
    v_lshrrev_b32 v4, 6, v0
    v_and_b32 v1, 63, v0
    v_readfirstlane_b32 s50, v4
    v_lshlrev_b32 v2, 4, v1
    v_mov_b32 v3, 0
    s_and_b32 s57, s2, 7
    s_lshr_b32 s58, s2, 3
    s_lshl_b32 s59, s57, 5
    s_add_u32 s59, s59, s58
    s_mul_i32 s60, s57, 28
    s_add_u32 s60, s60, s58
    s_lshl_b32 s60, s60, 1
    s_and_b32 s72, s57, 1
    s_mul_i32 s73, s72, 25
    s_add_u32 s73, s73, s58
    s_lshr_b32 s76, s57, 1
    s_sub_u32 s77, 25, s72
    s_cmp_lt_u32 s58, s77
    s_cselect_b32 s61, 1, 0
    s_mul_i32 s74, s73, 37
    s_lshr_b32 s74, s74, 8
    s_mul_i32 s75, s74, 7
    s_sub_u32 s75, s73, s75
    s_mul_i32 s77, s76, 7
    s_min_u32 s74, s74, 6
    s_add_u32 s62, s77, s74
    s_mov_b32 s63, s75
    s_lshl_b32 s64, s57, 2
    s_and_b32 s72, s58, 3
    s_add_u32 s64, s64, s72
    s_lshr_b32 s65, s58, 2
    s_mov_b32 s51, 0
    s_mov_b32 s66, 0
    s_mov_b32 s68, 2097152
    s_mov_b32 s69, 1048576
    s_mov_b32 s3, 0
    s_mov_b32 s71, 0
    s_waitcnt lgkmcnt(0)
    s_mov_b32 s4, s48
    s_mov_b32 s5, s49
    s_mov_b32 s6, 0x10000000
    s_mov_b32 s7, 0x20000
    s_mov_b32 s8, s36
    s_mov_b32 s9, s37
    s_mov_b32 s10, 7340032
    s_mov_b32 s11, 0x20000
    s_mov_b32 s12, s40
    s_mov_b32 s13, s41
    s_mov_b32 s14, 7340032
    s_mov_b32 s15, 0x20000
    s_mov_b32 s52, s44
    s_mov_b32 s53, s45
    s_mov_b32 s54, 1835008
    s_mov_b32 s55, 0x20000
    s_mov_b32 s44, 8
    s_cmp_ge_u32 s58, 28
    s_cbranch_scc1 L_helper
    s_lshl_b32 s72, s60, 9
    s_lshl_b32 s73, s50, 8
    s_add_u32 s72, s72, s73
    v_lshl_add_u32 v4, v1, 2, s72
    global_load_dword v16, v4, s[18:19]
    global_load_dword v17, v4, s[20:21]
    global_load_dword v18, v4, s[22:23]
    global_load_dword v19, v4, s[24:25]
    global_load_dword v20, v4, s[26:27]
    global_load_dword v21, v4, s[28:29]
    s_lshr_b32 s73, s50, 1
    s_add_u32 s73, s73, s60
    s_lshl_b32 s73, s73, 1
    v_mov_b32 v5, s73
    global_load_ushort v22, v5, s[30:31]
    s_lshl_b32 s73, s60, 1
    v_mov_b32 v6, s73
    global_load_dword v23, v6, s[32:33]
    s_mul_i32 s72, s59, 7168
    s_lshl_b32 s73, s50, 7
    s_add_u32 s72, s72, s73
    s_add_u32 s72, s72, 3584
    v_lshl_add_u32 v4, v1, 1, s72
    global_load_short_d16_hi v32, v4, s[16:17] offset:-3584
    global_load_short_d16_hi v33, v4, s[16:17] offset:-2688
    global_load_short_d16_hi v34, v4, s[16:17] offset:-1792
    global_load_short_d16_hi v35, v4, s[16:17] offset:-896
    global_load_short_d16_hi v36, v4, s[16:17] offset:0
    global_load_short_d16_hi v37, v4, s[16:17] offset:896
    global_load_short_d16_hi v38, v4, s[16:17] offset:1792
    global_load_short_d16_hi v39, v4, s[16:17] offset:2688
    v_mov_b32 v40, 0
    v_mov_b32 v41, 0
    v_mov_b32 v42, 0
    v_mov_b32 v43, 0
    v_mov_b32 v44, 0
    v_mov_b32 v45, 0
    v_mov_b32 v46, 0
    v_mov_b32 v47, 0
    s_cmp_eq_u32 s50, 3
    s_cbranch_scc1 Lp_2
    global_load_short_d16_hi v40, v4, s[16:17] offset:-3072
    global_load_short_d16_hi v41, v4, s[16:17] offset:-2176
    global_load_short_d16_hi v42, v4, s[16:17] offset:-1280
    global_load_short_d16_hi v43, v4, s[16:17] offset:-384
    global_load_short_d16_hi v44, v4, s[16:17] offset:512
    global_load_short_d16_hi v45, v4, s[16:17] offset:1408
    global_load_short_d16_hi v46, v4, s[16:17] offset:2304
    global_load_short_d16_hi v47, v4, s[16:17] offset:3200
Lp_2:
    buffer_load_dword v96, off, s[4:7], 0 sc1
    v_lshrrev_b32 v9, 3, v1
    s_mul_i32 s78, s50, 512
    v_add_u32 v9, s78, v9
    v_mul_u32_u24 v9, 3584, v9
    v_lshrrev_b32 v114, 2, v1
    v_and_b32 v114, 4, v114
    v_and_b32 v115, 7, v1
    v_xor_b32 v114, v114, v115
    s_lshl_b32 s78, s62, 7
    v_lshl_add_u32 v114, v114, 4, s78
    v_add_u32 v9, v9, v114
    v_add_u32 v10, 27648, v9
    s_mov_b32 s72, 102080
    s_mov_b32 s73, 136128
    v_mov_b32 v120, 137410
    v_lshlrev_b32 v114, 2, v0
    v_sub_u32 v114, 1023, v114
    v_cvt_f32_i32 v115, v114
    v_subrev_f32 v116, 0x00000000, v115
    v_subrev_f32 v117, 0x3f800000, v115
    v_cvt_pk_bf16_f32 v116, v116, v117
    v_and_b32 v117, 0xffff, v116
    v_lshl_add_u32 v107, v117, 1, s72
    v_lshrrev_b32 v117, 16, v116
    v_lshl_add_u32 v108, v117, 1, s72
    v_subrev_f32 v116, 0x40000000, v115
    v_subrev_f32 v117, 0x40400000, v115
    v_cvt_pk_bf16_f32 v116, v116, v117
    v_and_b32 v117, 0xffff, v116
    v_lshl_add_u32 v109, v117, 1, s72
    v_lshrrev_b32 v117, 16, v116
    v_lshl_add_u32 v110, v117, 1, s72
    v_subrev_f32 v116, 0x40800000, v115
    v_subrev_f32 v117, 0x40a00000, v115
    v_cvt_pk_bf16_f32 v116, v116, v117
    v_and_b32 v117, 0xffff, v116
    v_lshl_add_u32 v111, v117, 1, s72
    v_lshrrev_b32 v117, 16, v116
    v_lshl_add_u32 v112, v117, 1, s72
    v_subrev_f32 v116, 0x40c00000, v115
    v_subrev_f32 v117, 0x40e00000, v115
    v_cvt_pk_bf16_f32 v116, v116, v117
    v_and_b32 v117, 0xffff, v116
    v_lshl_add_u32 v113, v117, 1, s72
    v_subrev_u32 v116, 0, v114
    v_lshl_add_u32 v117, v116, 1, s73
    v_cmp_gt_i32 vcc, 0x80, v116
    s_nop 1
    v_cndmask_b32 v107, v107, v117, vcc
    v_subrev_u32 v116, 1, v114
    v_lshl_add_u32 v117, v116, 1, s73
    v_cmp_gt_i32 vcc, 0x80, v116
    s_nop 1
    v_cndmask_b32 v108, v108, v117, vcc
    v_subrev_u32 v116, 2, v114
    v_lshl_add_u32 v117, v116, 1, s73
    v_cmp_gt_i32 vcc, 0x80, v116
    s_nop 1
    v_cndmask_b32 v109, v109, v117, vcc
    v_subrev_u32 v116, 3, v114
    v_lshl_add_u32 v117, v116, 1, s73
    v_cmp_gt_i32 vcc, 0x80, v116
    s_nop 1
    v_cndmask_b32 v110, v110, v117, vcc
    v_subrev_u32 v116, 4, v114
    v_lshl_add_u32 v117, v116, 1, s73
    v_cmp_gt_i32 vcc, 0x80, v116
    s_nop 1
    v_cndmask_b32 v111, v111, v117, vcc
    v_cmp_gt_i32 vcc, 0, v116
    s_nop 1
    v_cndmask_b32 v111, v111, v120, vcc
    v_subrev_u32 v116, 5, v114
    v_lshl_add_u32 v117, v116, 1, s73
    v_cmp_gt_i32 vcc, 0x80, v116
    s_nop 1
    v_cndmask_b32 v112, v112, v117, vcc
    v_cmp_gt_i32 vcc, 0, v116
    s_nop 1
    v_cndmask_b32 v112, v112, v120, vcc
    v_subrev_u32 v116, 6, v114
    v_lshl_add_u32 v117, v116, 1, s73
    v_cmp_gt_i32 vcc, 0x80, v116
    s_nop 1
    v_cndmask_b32 v113, v113, v117, vcc
    v_cmp_gt_i32 vcc, 0, v116
    s_nop 1
    v_cndmask_b32 v113, v113, v120, vcc
    v_lshlrev_b32 v99, 5, v1
    v_add_u32 v99, 118880, v99
    s_cmp_eq_u32 s50, 3
    s_cbranch_scc1 Lk_4
    s_cmp_lg_u32 s50, 0
    s_cbranch_scc1 Lk_3
    v_and_b32 v118, 7, v1
    v_lshlrev_b32 v114, 2, v118
    v_sub_u32 v114, 1055, v114
    v_bfe_u32 v119, v1, 3, 1
    v_cvt_f32_i32 v115, v114
    v_subrev_f32 v116, 0x00000000, v115
    v_subrev_f32 v117, 0x3f800000, v115
    v_cvt_pk_bf16_f32 v116, v116, v117
    v_and_b32 v117, 0xffff, v116
    v_lshl_add_u32 v100, v117, 1, s72
    v_lshrrev_b32 v117, 16, v116
    v_lshl_add_u32 v101, v117, 1, s72
    v_subrev_f32 v116, 0x40000000, v115
    v_subrev_f32 v117, 0x40400000, v115
    v_cvt_pk_bf16_f32 v116, v116, v117
    v_and_b32 v117, 0xffff, v116
    v_lshl_add_u32 v102, v117, 1, s72
    v_lshrrev_b32 v117, 16, v116
    v_lshl_add_u32 v103, v117, 1, s72
    v_subrev_f32 v116, 0x40800000, v115
    v_subrev_f32 v117, 0x40a00000, v115
    v_cvt_pk_bf16_f32 v116, v116, v117
    v_and_b32 v117, 0xffff, v116
    v_lshl_add_u32 v104, v117, 1, s72
    v_lshrrev_b32 v117, 16, v116
    v_lshl_add_u32 v105, v117, 1, s72
    v_subrev_f32 v116, 0x40c00000, v115
    v_subrev_f32 v117, 0x40e00000, v115
    v_cvt_pk_bf16_f32 v116, v116, v117
    v_and_b32 v117, 0xffff, v116
    v_lshl_add_u32 v106, v117, 1, s72
    v_mul_u32_u24 v115, 1328, v119
    v_add_u32 v100, v100, v115
    v_cmp_le_i32 vcc, 1036, v114
    s_nop 1
    v_cndmask_b32 v100, v100, v120, vcc
    v_add_u32 v101, v101, v115
    v_cmp_le_i32 vcc, 1037, v114
    s_nop 1
    v_cndmask_b32 v101, v101, v120, vcc
    v_add_u32 v102, v102, v115
    v_cmp_le_i32 vcc, 1038, v114
    s_nop 1
    v_cndmask_b32 v102, v102, v120, vcc
    v_add_u32 v103, v103, v115
    v_cmp_le_i32 vcc, 1039, v114
    s_nop 1
    v_cndmask_b32 v103, v103, v120, vcc
    v_add_u32 v104, v104, v115
    v_cmp_le_i32 vcc, 1040, v114
    s_nop 1
    v_cndmask_b32 v104, v104, v120, vcc
    v_add_u32 v105, v105, v115
    v_cmp_le_i32 vcc, 1041, v114
    s_nop 1
    v_cndmask_b32 v105, v105, v120, vcc
    v_add_u32 v106, v106, v115
    v_cmp_le_i32 vcc, 1042, v114
    s_nop 1
    v_cndmask_b32 v106, v106, v120, vcc
    v_mul_u32_u24 v98, 16480, v119
    v_lshl_add_u32 v98, v118, 5, v98
    v_add_u32 v98, 106240, v98
    v_cmp_gt_u32 vcc, 16, v1
    s_branch Lk_5
Lk_3:
    v_cmp_le_u32 vcc, 24, v1
    s_nop 1
    v_cndmask_b32 v119, 0, 1, vcc
    v_mul_u32_u24 v118, 24, v119
    v_sub_u32 v118, v1, v118
    v_lshlrev_b32 v114, 2, v118
    v_sub_u32 v114, 67, v114
    s_sub_u32 s74, s50, 1
    s_mul_i32 s75, s74, 1328
    s_add_u32 s75, s75, 137156
    v_lshl_add_u32 v115, v119, 1, s75
    v_subrev_u32 v116, 0, v114
    v_lshl_add_u32 v100, v116, 2, v115
    v_cmp_lt_u32 vcc, 63, v116
    s_nop 1
    v_cndmask_b32 v100, v100, v120, vcc
    v_subrev_u32 v116, 1, v114
    v_lshl_add_u32 v101, v116, 2, v115
    v_cmp_lt_u32 vcc, 63, v116
    s_nop 1
    v_cndmask_b32 v101, v101, v120, vcc
    v_subrev_u32 v116, 2, v114
    v_lshl_add_u32 v102, v116, 2, v115
    v_cmp_lt_u32 vcc, 63, v116
    s_nop 1
    v_cndmask_b32 v102, v102, v120, vcc
    v_subrev_u32 v116, 3, v114
    v_lshl_add_u32 v103, v116, 2, v115
    v_cmp_lt_u32 vcc, 63, v116
    s_nop 1
    v_cndmask_b32 v103, v103, v120, vcc
    v_subrev_u32 v116, 4, v114
    v_lshl_add_u32 v104, v116, 2, v115
    v_cmp_lt_u32 vcc, 63, v116
    s_nop 1
    v_cndmask_b32 v104, v104, v120, vcc
    v_subrev_u32 v116, 5, v114
    v_lshl_add_u32 v105, v116, 2, v115
    v_cmp_lt_u32 vcc, 63, v116
    s_nop 1
    v_cndmask_b32 v105, v105, v120, vcc
    v_subrev_u32 v116, 6, v114
    v_lshl_add_u32 v106, v116, 2, v115
    v_cmp_lt_u32 vcc, 63, v116
    s_nop 1
    v_cndmask_b32 v106, v106, v120, vcc
    s_mul_i32 s75, s74, 16480
    s_add_u32 s75, s75, 98304
    v_lshl_add_u32 v98, v1, 5, s75
    v_cmp_gt_u32 vcc, 48, v1
    s_branch Lk_5
Lk_4:
    v_mov_b32 v100, v120
    v_mov_b32 v101, v120
    v_mov_b32 v102, v120
    v_mov_b32 v103, v120
    v_mov_b32 v104, v120
    v_mov_b32 v105, v120
    v_mov_b32 v106, v120
    v_cmp_le_u32 vcc, 11, v1
    s_nop 1
    v_cndmask_b32 v119, 0, 1, vcc
    v_mul_u32_u24 v119, 16128, v119
    v_lshl_add_u32 v98, v1, 5, v119
    v_add_u32 v98, 105216, v98
    v_cmp_gt_u32 vcc, 22, v1
Lk_5:
    s_nop 1
    v_cndmask_b32 v98, v99, v98, vcc
    s_and_b32 s74, s50, 1
    s_sub_u32 s75, 4, s74
    s_lshl_b32 s76, s75, 1
    v_lshrrev_b32 v114, 4, v1
    v_lshlrev_b32 v114, 3, v114
    v_and_b32 v115, 15, v1
    v_sub_u32 v114, v114, v115
    v_add_u32 v114, s75, v114
    v_mov_b32 v115, 0x3f80
    v_mov_b32 v121, 0x3f800000
    v_add_u32 v99, -8, v114
    v_cmp_ge_u32 vcc, s76, v99
    s_nop 1
    v_cndmask_b32 v116, 0, v115, vcc
    v_add_u32 v99, -7, v114
    v_cmp_ge_u32 vcc, s76, v99
    s_nop 1
    v_cndmask_b32 v99, 0, v121, vcc
    v_or_b32 v116, v116, v99
    v_add_u32 v99, -6, v114
    v_cmp_ge_u32 vcc, s76, v99
    s_nop 1
    v_cndmask_b32 v117, 0, v115, vcc
    v_add_u32 v99, -5, v114
    v_cmp_ge_u32 vcc, s76, v99
    s_nop 1
    v_cndmask_b32 v99, 0, v121, vcc
    v_or_b32 v117, v117, v99
    v_add_u32 v99, -4, v114
    v_cmp_ge_u32 vcc, s76, v99
    s_nop 1
    v_cndmask_b32 v118, 0, v115, vcc
    v_add_u32 v99, -3, v114
    v_cmp_ge_u32 vcc, s76, v99
    s_nop 1
    v_cndmask_b32 v99, 0, v121, vcc
    v_or_b32 v118, v118, v99
    v_add_u32 v99, -2, v114
    v_cmp_ge_u32 vcc, s76, v99
    s_nop 1
    v_cndmask_b32 v119, 0, v115, vcc
    v_add_u32 v99, -1, v114
    v_cmp_ge_u32 vcc, s76, v99
    s_nop 1
    v_cndmask_b32 v99, 0, v121, vcc
    v_or_b32 v119, v119, v99
    s_lshl_b32 s74, s74, 10
    s_add_u32 s74, s74, 116832
    v_add_u32 v99, s74, v2
    ds_write_b128 v99, v[116:119]
    v_lshrrev_b32 v13, 3, v1
    s_mul_i32 s78, s50, 448
    v_add_u32 v13, s78, v13
    v_mul_u32_u24 v13, 4096, v13
    v_lshrrev_b32 v114, 2, v1
    v_and_b32 v114, 4, v114
    v_and_b32 v115, 7, v1
    v_xor_b32 v114, v114, v115
    s_lshl_b32 s78, s64, 7
    v_lshl_add_u32 v114, v114, 4, s78
    v_add_u32 v13, v13, v114
    v_add_u32 v14, 31744, v13
    v_lshrrev_b32 v114, 5, v1
    v_lshlrev_b32 v114, 3, v114
    v_bfe_u32 v115, v1, 2, 2
    v_add_u32 v114, v114, v115
    v_lshlrev_b32 v114, 7, v114
    s_mul_i32 s78, s50, 24576
    v_add_u32 v114, s78, v114
    v_and_b32 v115, 1, v1
    v_lshlrev_b32 v115, 4, v115
    v_bfe_u32 v116, v1, 1, 1
    v_lshl_add_u32 v115, v116, 3, v115
    v_add_u32 v114, v114, v115
    v_bfe_u32 v115, v1, 4, 1
    v_add_u32 v115, s50, v115
    v_bfe_u32 v116, v1, 3, 1
    v_lshl_add_u32 v115, v116, 1, v115
    v_and_b32 v115, 3, v115
    v_lshl_add_u32 v11, v115, 5, v114
    v_xor_b32 v115, 2, v115
    v_lshl_add_u32 v12, v115, 5, v114
    s_lshr_b32 s84, s50, 1
    s_and_b32 s85, s50, 1
    v_and_b32 v28, 15, v1
    v_lshrrev_b32 v29, 4, v1
    s_mul_i32 s74, s84, 7520
    s_lshl_b32 s75, s85, 8
    s_sub_u32 s74, s74, s75
    s_add_u32 s74, s74, 131264
    v_lshlrev_b32 v4, 5, v28
    v_lshl_add_u32 v4, v29, 4, v4
    v_add_u32 v4, s74, v4
    s_mul_i32 s74, s84, 16480
    s_lshl_b32 s75, s85, 10
    s_sub_u32 s74, s74, s75
    s_add_u32 s74, s74, 98424
    v_lshlrev_b32 v5, 6, v29
    v_lshrrev_b32 v6, 2, v28
    v_lshlrev_b32 v6, 5, v6
    v_sub_u32 v5, v5, v6
    v_and_b32 v6, 3, v1
    v_lshlrev_b32 v6, 3, v6
    v_sub_u32 v5, v5, v6
    v_add_u32 v5, s74, v5
    s_lshl_b32 s74, s84, 11
    s_lshl_b32 s75, s85, 13
    s_add_u32 s74, s74, 143552
    s_add_u32 s76, s74, s75
    s_xor_b32 s75, s75, 8192
    s_add_u32 s77, s74, s75
    v_lshlrev_b32 v7, 6, v28
    v_lshl_add_u32 v7, v29, 4, v7
    v_add_u32 v6, s76, v7
    v_add_u32 v7, s77, v2
    s_mov_b32 s87, s76
    v_lshlrev_b32 v8, 5, v28
    v_and_b32 v28, 1, v29
    v_lshl_add_u32 v8, v28, 9, v8
    v_lshrrev_b32 v29, 1, v29
    v_lshl_add_u32 v8, v29, 4, v8
    s_lshl_b32 s86, s60, 12
    s_lshl_b32 s75, s84, 12
    s_add_u32 s86, s86, s75
    s_lshl_b32 s75, s85, 11
    s_add_u32 s86, s86, s75
    s_add_u32 s86, s86, s66
    s_add_u32 s86, s86, 4194304
    s_lshl_b32 s74, s50, 12
    s_add_u32 s74, s74, 143552
    v_lshrrev_b32 v24, 1, v1
    v_lshrrev_b32 v25, 5, v1
    v_xor_b32 v24, v24, v25
    v_lshlrev_b32 v24, 4, v24
    v_and_b32 v25, 1, v1
    v_lshl_add_u32 v24, v25, 3, v24
    v_add_u32 v24, s74, v24
    v_xor_b32 v25, 32, v24
    v_bfe_u32 v26, v1, 2, 2
    v_lshlrev_b32 v26, 4, v26
    v_lshl_add_u32 v26, v1, 6, v26
    v_add_u32 v26, s74, v26
    v_xor_b32 v27, 16, v26
    v_xor_b32 v28, 32, v26
    v_xor_b32 v29, 48, v26
    v_lshl_add_u32 v30, v1, 5, s74
    v_lshlrev_b32 v31, 4, v0
    v_add_u32 v31, 131744, v31
    s_waitcnt vmcnt(9)
    v_lshlrev_b32 v22, 16, v22
    v_mul_f32 v22, 0x3fb8aa3b, v22
    v_exp_f32 v22, v22
    v_readfirstlane_b32 s35, v23
    v_cvt_pk_bf16_f32 v22, v22, v22
    v_and_b32 v22, 0xffff0000, v22
    s_lshl_b32 s34, s35, 16
    s_and_b32 s35, s35, 0xffff0000
    v_lshlrev_b32 v82, 16, v16
    v_lshlrev_b32 v83, 16, v17
    v_lshlrev_b32 v114, 16, v18
    v_lshlrev_b32 v115, 16, v19
    v_lshlrev_b32 v116, 16, v20
    v_lshlrev_b32 v117, 16, v21
    v_pk_mul_f32 v[82:83], v[82:83], v[22:23] op_sel_hi:[1,0]
    v_pk_mul_f32 v[114:115], v[114:115], v[22:23] op_sel_hi:[1,0]
    v_mul_f32 v82, 0x3fb8aa3b, v82
    v_mul_f32 v83, 0.15915494, v83
    v_pk_mul_f32 v[80:81], v[116:117], v[114:115] op_sel_hi:[0,1]
    v_pk_fma_f32 v[78:79], v[116:117], v[114:115], v[80:81] op_sel:[1,1,0] op_sel_hi:[1,0,1] neg_lo:[1,0,0]
    v_and_b32 v94, 0xffff0000, v16
    v_and_b32 v95, 0xffff0000, v17
    v_and_b32 v118, 0xffff0000, v18
    v_and_b32 v119, 0xffff0000, v19
    v_and_b32 v120, 0xffff0000, v20
    v_and_b32 v121, 0xffff0000, v21
    v_pk_mul_f32 v[94:95], v[94:95], v[22:23] op_sel_hi:[1,0]
    v_pk_mul_f32 v[118:119], v[118:119], v[22:23] op_sel_hi:[1,0]
    v_mul_f32 v94, 0x3fb8aa3b, v94
    v_mul_f32 v95, 0.15915494, v95
    v_pk_mul_f32 v[92:93], v[120:121], v[118:119] op_sel_hi:[0,1]
    v_pk_fma_f32 v[90:91], v[120:121], v[118:119], v[92:93] op_sel:[1,1,0] op_sel_hi:[1,0,1] neg_lo:[1,0,0]
    v_mul_f32 v114, 0x3f800000, v82
    v_mul_f32 v115, 0x3f800000, v83
    v_exp_f32 v114, v114
    v_fract_f32 v115, v115
    v_cos_f32 v72, v115
    v_sin_f32 v73, v115
    v_mul_f32 v118, 0x3f800000, v94
    v_mul_f32 v119, 0x3f800000, v95
    v_exp_f32 v118, v118
    v_fract_f32 v119, v119
    v_cos_f32 v84, v119
    v_sin_f32 v85, v119
    v_pk_mul_f32 v[72:73], v[72:73], v[114:115] op_sel_hi:[1,0]
    v_pk_mul_f32 v[84:85], v[84:85], v[118:119] op_sel_hi:[1,0]
    v_mul_f32 v114, 0x41000000, v82
    v_mul_f32 v115, 0x41000000, v83
    v_exp_f32 v114, v114
    v_fract_f32 v115, v115
    v_cos_f32 v74, v115
    v_sin_f32 v75, v115
    v_mul_f32 v118, 0x41000000, v94
    v_mul_f32 v119, 0x41000000, v95
    v_exp_f32 v118, v118
    v_fract_f32 v119, v119
    v_cos_f32 v86, v119
    v_sin_f32 v87, v119
    v_pk_mul_f32 v[74:75], v[74:75], v[114:115] op_sel_hi:[1,0]
    v_pk_mul_f32 v[86:87], v[86:87], v[118:119] op_sel_hi:[1,0]
    v_mul_f32 v114, 0x43800000, v82
    v_mul_f32 v115, 0x43800000, v83
    v_exp_f32 v114, v114
    v_fract_f32 v115, v115
    v_cos_f32 v76, v115
    v_sin_f32 v77, v115
    v_mul_f32 v118, 0x43800000, v94
    v_mul_f32 v119, 0x43800000, v95
    v_exp_f32 v118, v118
    v_fract_f32 v119, v119
    v_cos_f32 v88, v119
    v_sin_f32 v89, v119
    v_pk_mul_f32 v[76:77], v[76:77], v[114:115] op_sel_hi:[1,0]
    v_pk_mul_f32 v[88:89], v[88:89], v[118:119] op_sel_hi:[1,0]
    v_pk_mul_f32 v[114:115], v[74:75], v[74:75] op_sel_hi:[0,1]
    v_pk_fma_f32 v[80:81], v[74:75], v[74:75], v[114:115] op_sel:[1,1,0] op_sel_hi:[1,0,1] neg_lo:[1,0,0]
    v_pk_mul_f32 v[118:119], v[86:87], v[86:87] op_sel_hi:[0,1]
    v_pk_fma_f32 v[92:93], v[86:87], v[86:87], v[118:119] op_sel:[1,1,0] op_sel_hi:[1,0,1] neg_lo:[1,0,0]
    s_waitcnt vmcnt(0)
    v_readfirstlane_b32 s56, v96
    s_mov_b32 s74, 0x07060302
    v_perm_b32 v114, v33, v32, s74
    v_perm_b32 v115, v35, v34, s74
    v_perm_b32 v116, v37, v36, s74
    v_perm_b32 v117, v39, v38, s74
    v_perm_b32 v118, v41, v40, s74
    v_perm_b32 v119, v43, v42, s74
    v_perm_b32 v120, v45, v44, s74
    v_perm_b32 v121, v47, v46, s74
    s_mul_i32 s72, s59, 7168
    s_lshl_b32 s73, s50, 10
    s_add_u32 s72, s72, s73
    s_add_u32 s72, s72, 2097152
    buffer_store_dwordx4 v[114:117], v2, s[4:7], s72 offen sc1
    s_cmp_eq_u32 s50, 3
    s_cbranch_scc1 Lp_6
    s_add_u32 s72, s72, 4096
    buffer_store_dwordx4 v[118:121], v2, s[4:7], s72 offen sc1
Lp_6:
    s_add_u32 s56, s56, 1
    s_mov_b32 s67, s56
    v_pk_add_f32 v[48:49], v[32:33], v[40:41]
    v_pk_mul_f32 v[56:57], v[32:33], v[32:33]
    v_pk_add_f32 v[50:51], v[34:35], v[42:43]
    v_pk_mul_f32 v[58:59], v[34:35], v[34:35]
    v_pk_add_f32 v[52:53], v[36:37], v[44:45]
    v_pk_mul_f32 v[60:61], v[36:37], v[36:37]
    v_pk_add_f32 v[54:55], v[38:39], v[46:47]
    v_pk_mul_f32 v[62:63], v[38:39], v[38:39]
    v_pk_fma_f32 v[56:57], v[40:41], v[40:41], v[56:57]
    v_pk_fma_f32 v[58:59], v[42:43], v[42:43], v[58:59]
    v_pk_fma_f32 v[60:61], v[44:45], v[44:45], v[60:61]
    v_pk_fma_f32 v[62:63], v[46:47], v[46:47], v[62:63]
    v_add_f32_dpp v64, v48, v48 row_shl:4 row_mask:0xf bank_mask:0x5
    v_add_f32_dpp v65, v50, v50 row_shl:4 row_mask:0xf bank_mask:0x5
    v_add_f32_dpp v66, v52, v52 row_shl:4 row_mask:0xf bank_mask:0x5
    v_add_f32_dpp v67, v54, v54 row_shl:4 row_mask:0xf bank_mask:0x5
    v_add_f32_dpp v68, v56, v56 row_shl:4 row_mask:0xf bank_mask:0x5
    v_add_f32_dpp v69, v58, v58 row_shl:4 row_mask:0xf bank_mask:0x5
    v_add_f32_dpp v70, v60, v60 row_shl:4 row_mask:0xf bank_mask:0x5
    v_add_f32_dpp v71, v62, v62 row_shl:4 row_mask:0xf bank_mask:0x5
    v_add_f32_dpp v64, v49, v49 row_shr:4 row_mask:0xf bank_mask:0xa
    v_add_f32_dpp v65, v51, v51 row_shr:4 row_mask:0xf bank_mask:0xa
    v_add_f32_dpp v66, v53, v53 row_shr:4 row_mask:0xf bank_mask:0xa
    v_add_f32_dpp v67, v55, v55 row_shr:4 row_mask:0xf bank_mask:0xa
    v_add_f32_dpp v68, v57, v57 row_shr:4 row_mask:0xf bank_mask:0xa
    v_add_f32_dpp v69, v59, v59 row_shr:4 row_mask:0xf bank_mask:0xa
    v_add_f32_dpp v70, v61, v61 row_shr:4 row_mask:0xf bank_mask:0xa
    v_add_f32_dpp v71, v63, v63 row_shr:4 row_mask:0xf bank_mask:0xa
    v_add_f32_dpp v48, v64, v64 row_shl:8 row_mask:0xf bank_mask:0x3
    v_add_f32_dpp v49, v66, v66 row_shl:8 row_mask:0xf bank_mask:0x3
    v_add_f32_dpp v50, v68, v68 row_shl:8 row_mask:0xf bank_mask:0x3
    v_add_f32_dpp v51, v70, v70 row_shl:8 row_mask:0xf bank_mask:0x3
    v_add_f32_dpp v48, v65, v65 row_shr:8 row_mask:0xf bank_mask:0xc
    v_add_f32_dpp v49, v67, v67 row_shr:8 row_mask:0xf bank_mask:0xc
    v_add_f32_dpp v50, v69, v69 row_shr:8 row_mask:0xf bank_mask:0xc
    v_add_f32_dpp v51, v71, v71 row_shr:8 row_mask:0xf bank_mask:0xc
    v_permlane16_swap_b32 v48, v49
    s_nop 0
    v_permlane16_swap_b32 v50, v51
    v_add_f32 v64, v48, v49
    v_add_f32 v66, v50, v51
    s_nop 1
    v_permlane32_swap_b32 v64, v66
    v_add_f32 v64, v64, v66
    s_nop 1
    v_add_f32_dpp v64, v64, v64 quad_perm:[1,0,3,2] row_mask:0xf bank_mask:0xf
    s_nop 1
    v_add_f32_dpp v64, v64, v64 quad_perm:[2,3,0,1] row_mask:0xf bank_mask:0xf
    s_lshl_b32 s72, s50, 2
    s_add_u32 s72, s72, 135872
    v_lshrrev_b32 v15, 2, v1
    v_lshl_add_u32 v15, v15, 4, s72
    ds_write_b32 v15, v64
    s_lshr_b32 s72, s50, 1
    s_mul_i32 s72, s72, 55968
    s_and_b32 s73, s50, 1
    s_lshl_b32 s73, s73, 9
    s_add_u32 s72, s72, s73
    v_lshl_add_u32 v97, v1, 3, s72
    v_mov_b32 v22, 0x3f80
    v_mov_b32 v23, 0x3f80
    ds_write_b64 v97, v[22:23] offset:22176
    v_cvt_pk_bf16_f32 v16, v78, -v79
    v_cvt_pk_bf16_f32 v17, v90, -v91
    ds_write_b64 v97, v[16:17] offset:0
    v_cvt_pk_bf16_f32 v18, v74, v75
    v_cvt_pk_bf16_f32 v19, v86, v87
    ds_write_b64 v97, v[18:19] offset:23232
    v_cvt_pk_bf16_f32 v20, v80, v81
    v_cvt_pk_bf16_f32 v21, v92, v93
    ds_write_b64 v97, v[20:21] offset:24288
    v_pk_mul_f32 v[44:45], v[78:79], v[72:73] op_sel_hi:[0,1]
    v_pk_mul_f32 v[62:63], v[90:91], v[84:85] op_sel_hi:[0,1]
    v_pk_mul_f32 v[46:47], v[74:75], v[80:81] op_sel_hi:[0,1]
    v_pk_mul_f32 v[64:65], v[86:87], v[92:93] op_sel_hi:[0,1]
    v_pk_mul_f32 v[48:49], v[80:81], v[80:81] op_sel_hi:[0,1]
    v_pk_mul_f32 v[66:67], v[92:93], v[92:93] op_sel_hi:[0,1]
    v_pk_fma_f32 v[38:39], v[78:79], v[72:73], v[44:45] op_sel:[1,1,0] op_sel_hi:[1,0,1] neg_lo:[1,0,0]
    v_pk_fma_f32 v[56:57], v[90:91], v[84:85], v[62:63] op_sel:[1,1,0] op_sel_hi:[1,0,1] neg_lo:[1,0,0]
    v_pk_fma_f32 v[42:43], v[74:75], v[80:81], v[46:47] op_sel:[1,1,0] op_sel_hi:[1,0,1] neg_lo:[1,0,0]
    v_pk_fma_f32 v[60:61], v[86:87], v[92:93], v[64:65] op_sel:[1,1,0] op_sel_hi:[1,0,1] neg_lo:[1,0,0]
    v_pk_fma_f32 v[40:41], v[80:81], v[80:81], v[48:49] op_sel:[1,1,0] op_sel_hi:[1,0,1] neg_lo:[1,0,0]
    v_pk_fma_f32 v[58:59], v[92:93], v[92:93], v[66:67] op_sel:[1,1,0] op_sel_hi:[1,0,1] neg_lo:[1,0,0]
    v_cvt_pk_bf16_f32 v22, v38, -v39
    v_cvt_pk_bf16_f32 v23, v56, -v57
    ds_write_b64 v97, v[22:23] offset:1056
    v_cvt_pk_bf16_f32 v16, v42, v43
    v_cvt_pk_bf16_f32 v17, v60, v61
    ds_write_b64 v97, v[16:17] offset:25344
    v_cvt_pk_bf16_f32 v18, v40, v41
    v_cvt_pk_bf16_f32 v19, v58, v59
    ds_write_b64 v97, v[18:19] offset:26400
    v_pk_mul_f32 v[44:45], v[38:39], v[72:73] op_sel_hi:[0,1]
    v_pk_mul_f32 v[62:63], v[56:57], v[84:85] op_sel_hi:[0,1]
    v_pk_mul_f32 v[46:47], v[42:43], v[80:81] op_sel_hi:[0,1]
    v_pk_mul_f32 v[64:65], v[60:61], v[92:93] op_sel_hi:[0,1]
    v_pk_mul_f32 v[48:49], v[40:41], v[80:81] op_sel_hi:[0,1]
    v_pk_mul_f32 v[66:67], v[58:59], v[92:93] op_sel_hi:[0,1]
    v_pk_fma_f32 v[32:33], v[38:39], v[72:73], v[44:45] op_sel:[1,1,0] op_sel_hi:[1,0,1] neg_lo:[1,0,0]
    v_pk_fma_f32 v[50:51], v[56:57], v[84:85], v[62:63] op_sel:[1,1,0] op_sel_hi:[1,0,1] neg_lo:[1,0,0]
    v_pk_fma_f32 v[42:43], v[42:43], v[80:81], v[46:47] op_sel:[1,1,0] op_sel_hi:[1,0,1] neg_lo:[1,0,0]
    v_pk_fma_f32 v[60:61], v[60:61], v[92:93], v[64:65] op_sel:[1,1,0] op_sel_hi:[1,0,1] neg_lo:[1,0,0]
    v_pk_fma_f32 v[40:41], v[40:41], v[80:81], v[48:49] op_sel:[1,1,0] op_sel_hi:[1,0,1] neg_lo:[1,0,0]
    v_pk_fma_f32 v[58:59], v[58:59], v[92:93], v[66:67] op_sel:[1,1,0] op_sel_hi:[1,0,1] neg_lo:[1,0,0]
    v_cvt_pk_bf16_f32 v20, v32, -v33
    v_cvt_pk_bf16_f32 v21, v50, -v51
    ds_write_b64 v97, v[20:21] offset:2112
    v_cvt_pk_bf16_f32 v22, v42, v43
    v_cvt_pk_bf16_f32 v23, v60, v61
    ds_write_b64 v97, v[22:23] offset:27456
    v_cvt_pk_bf16_f32 v16, v40, v41
    v_cvt_pk_bf16_f32 v17, v58, v59
    ds_write_b64 v97, v[16:17] offset:28512
    s_waitcnt vmcnt(0) lgkmcnt(0)
    s_barrier
    s_cmp_lg_u32 s50, 3
    s_cbranch_scc1 Lp_7
    v_and_b32 v15, 7, v1
    v_lshlrev_b32 v15, 4, v15
    v_add_u32 v15, 135872, v15
    ds_read_b128 v[114:117], v15
    ds_read_b128 v[118:121], v15 offset:128
    s_waitcnt lgkmcnt(0)
    v_add_f32 v114, v114, v115
    v_add_f32 v118, v118, v119
    v_add_f32 v116, v116, v117
    v_add_f32 v120, v120, v121
    v_add_f32 v114, v114, v116
    v_add_f32 v118, v118, v120
    v_mov_b32 v115, v118
    v_mov_b32 v116, s56
    v_mov_b32 v117, 0
    s_lshl_b32 s72, s59, 7
    s_add_u32 s72, s72, 1048576
    s_mov_b64 exec, 0xff
    buffer_store_dwordx4 v[114:117], v2, s[4:7], s72 offen sc1
    s_mov_b64 exec, -1
Lp_7:
    v_pk_mul_f32 v[44:45], v[32:33], v[72:73] op_sel_hi:[0,1]
    v_pk_mul_f32 v[62:63], v[50:51], v[84:85] op_sel_hi:[0,1]
    v_pk_mul_f32 v[46:47], v[42:43], v[80:81] op_sel_hi:[0,1]
    v_pk_mul_f32 v[64:65], v[60:61], v[92:93] op_sel_hi:[0,1]
    v_pk_mul_f32 v[48:49], v[40:41], v[80:81] op_sel_hi:[0,1]
    v_pk_mul_f32 v[66:67], v[58:59], v[92:93] op_sel_hi:[0,1]
    v_pk_fma_f32 v[38:39], v[32:33], v[72:73], v[44:45] op_sel:[1,1,0] op_sel_hi:[1,0,1] neg_lo:[1,0,0]
    v_pk_fma_f32 v[56:57], v[50:51], v[84:85], v[62:63] op_sel:[1,1,0] op_sel_hi:[1,0,1] neg_lo:[1,0,0]
    v_pk_fma_f32 v[42:43], v[42:43], v[80:81], v[46:47] op_sel:[1,1,0] op_sel_hi:[1,0,1] neg_lo:[1,0,0]
    v_pk_fma_f32 v[60:61], v[60:61], v[92:93], v[64:65] op_sel:[1,1,0] op_sel_hi:[1,0,1] neg_lo:[1,0,0]
    v_pk_fma_f32 v[40:41], v[40:41], v[80:81], v[48:49] op_sel:[1,1,0] op_sel_hi:[1,0,1] neg_lo:[1,0,0]
    v_pk_fma_f32 v[58:59], v[58:59], v[92:93], v[66:67] op_sel:[1,1,0] op_sel_hi:[1,0,1] neg_lo:[1,0,0]
    v_cvt_pk_bf16_f32 v18, v38, -v39
    v_cvt_pk_bf16_f32 v19, v56, -v57
    ds_write_b64 v97, v[18:19] offset:3168
    v_cvt_pk_bf16_f32 v20, v42, v43
    v_cvt_pk_bf16_f32 v21, v60, v61
    ds_write_b64 v97, v[20:21] offset:29568
    v_cvt_pk_bf16_f32 v22, v40, v41
    v_cvt_pk_bf16_f32 v23, v58, v59
    ds_write_b64 v97, v[22:23] offset:30624
    v_pk_mul_f32 v[44:45], v[38:39], v[72:73] op_sel_hi:[0,1]
    v_pk_mul_f32 v[62:63], v[56:57], v[84:85] op_sel_hi:[0,1]
    v_pk_mul_f32 v[46:47], v[42:43], v[80:81] op_sel_hi:[0,1]
    v_pk_mul_f32 v[64:65], v[60:61], v[92:93] op_sel_hi:[0,1]
    v_pk_mul_f32 v[48:49], v[40:41], v[80:81] op_sel_hi:[0,1]
    v_pk_mul_f32 v[66:67], v[58:59], v[92:93] op_sel_hi:[0,1]
    v_pk_fma_f32 v[34:35], v[38:39], v[72:73], v[44:45] op_sel:[1,1,0] op_sel_hi:[1,0,1] neg_lo:[1,0,0]
    v_pk_fma_f32 v[52:53], v[56:57], v[84:85], v[62:63] op_sel:[1,1,0] op_sel_hi:[1,0,1] neg_lo:[1,0,0]
    v_pk_fma_f32 v[42:43], v[42:43], v[80:81], v[46:47] op_sel:[1,1,0] op_sel_hi:[1,0,1] neg_lo:[1,0,0]
    v_pk_fma_f32 v[60:61], v[60:61], v[92:93], v[64:65] op_sel:[1,1,0] op_sel_hi:[1,0,1] neg_lo:[1,0,0]
    v_pk_fma_f32 v[40:41], v[40:41], v[80:81], v[48:49] op_sel:[1,1,0] op_sel_hi:[1,0,1] neg_lo:[1,0,0]
    v_pk_fma_f32 v[58:59], v[58:59], v[92:93], v[66:67] op_sel:[1,1,0] op_sel_hi:[1,0,1] neg_lo:[1,0,0]
    v_cvt_pk_bf16_f32 v16, v34, -v35
    v_cvt_pk_bf16_f32 v17, v52, -v53
    ds_write_b64 v97, v[16:17] offset:4224
    v_cvt_pk_bf16_f32 v18, v42, v43
    v_cvt_pk_bf16_f32 v19, v60, v61
    ds_write_b64 v97, v[18:19] offset:31680
    v_cvt_pk_bf16_f32 v20, v40, v41
    v_cvt_pk_bf16_f32 v21, v58, v59
    ds_write_b64 v97, v[20:21] offset:32736
    v_pk_mul_f32 v[44:45], v[34:35], v[72:73] op_sel_hi:[0,1]
    v_pk_mul_f32 v[62:63], v[52:53], v[84:85] op_sel_hi:[0,1]
    v_pk_mul_f32 v[46:47], v[42:43], v[80:81] op_sel_hi:[0,1]
    v_pk_mul_f32 v[64:65], v[60:61], v[92:93] op_sel_hi:[0,1]
    v_pk_mul_f32 v[48:49], v[40:41], v[80:81] op_sel_hi:[0,1]
    v_pk_mul_f32 v[66:67], v[58:59], v[92:93] op_sel_hi:[0,1]
    v_pk_fma_f32 v[38:39], v[34:35], v[72:73], v[44:45] op_sel:[1,1,0] op_sel_hi:[1,0,1] neg_lo:[1,0,0]
    v_pk_fma_f32 v[56:57], v[52:53], v[84:85], v[62:63] op_sel:[1,1,0] op_sel_hi:[1,0,1] neg_lo:[1,0,0]
    v_pk_fma_f32 v[42:43], v[42:43], v[80:81], v[46:47] op_sel:[1,1,0] op_sel_hi:[1,0,1] neg_lo:[1,0,0]
    v_pk_fma_f32 v[60:61], v[60:61], v[92:93], v[64:65] op_sel:[1,1,0] op_sel_hi:[1,0,1] neg_lo:[1,0,0]
    v_pk_fma_f32 v[40:41], v[40:41], v[80:81], v[48:49] op_sel:[1,1,0] op_sel_hi:[1,0,1] neg_lo:[1,0,0]
    v_pk_fma_f32 v[58:59], v[58:59], v[92:93], v[66:67] op_sel:[1,1,0] op_sel_hi:[1,0,1] neg_lo:[1,0,0]
    v_cvt_pk_bf16_f32 v22, v38, -v39
    v_cvt_pk_bf16_f32 v23, v56, -v57
    ds_write_b64 v97, v[22:23] offset:5280
    v_cvt_pk_bf16_f32 v16, v42, v43
    v_cvt_pk_bf16_f32 v17, v60, v61
    ds_write_b64 v97, v[16:17] offset:33792
    v_cvt_pk_bf16_f32 v18, v40, v41
    v_cvt_pk_bf16_f32 v19, v58, v59
    ds_write_b64 v97, v[18:19] offset:34848
    v_pk_mul_f32 v[44:45], v[38:39], v[72:73] op_sel_hi:[0,1]
    v_pk_mul_f32 v[62:63], v[56:57], v[84:85] op_sel_hi:[0,1]
    v_pk_mul_f32 v[46:47], v[42:43], v[80:81] op_sel_hi:[0,1]
    v_pk_mul_f32 v[64:65], v[60:61], v[92:93] op_sel_hi:[0,1]
    v_pk_mul_f32 v[48:49], v[40:41], v[80:81] op_sel_hi:[0,1]
    v_pk_mul_f32 v[66:67], v[58:59], v[92:93] op_sel_hi:[0,1]
    v_pk_fma_f32 v[36:37], v[38:39], v[72:73], v[44:45] op_sel:[1,1,0] op_sel_hi:[1,0,1] neg_lo:[1,0,0]
    v_pk_fma_f32 v[54:55], v[56:57], v[84:85], v[62:63] op_sel:[1,1,0] op_sel_hi:[1,0,1] neg_lo:[1,0,0]
    v_pk_fma_f32 v[42:43], v[42:43], v[80:81], v[46:47] op_sel:[1,1,0] op_sel_hi:[1,0,1] neg_lo:[1,0,0]
    v_pk_fma_f32 v[60:61], v[60:61], v[92:93], v[64:65] op_sel:[1,1,0] op_sel_hi:[1,0,1] neg_lo:[1,0,0]
    v_pk_fma_f32 v[40:41], v[40:41], v[80:81], v[48:49] op_sel:[1,1,0] op_sel_hi:[1,0,1] neg_lo:[1,0,0]
    v_pk_fma_f32 v[58:59], v[58:59], v[92:93], v[66:67] op_sel:[1,1,0] op_sel_hi:[1,0,1] neg_lo:[1,0,0]
    v_cvt_pk_bf16_f32 v20, v36, -v37
    v_cvt_pk_bf16_f32 v21, v54, -v55
    ds_write_b64 v97, v[20:21] offset:6336
    v_cvt_pk_bf16_f32 v22, v42, v43
    v_cvt_pk_bf16_f32 v23, v60, v61
    ds_write_b64 v97, v[22:23] offset:35904
    v_cvt_pk_bf16_f32 v16, v40, v41
    v_cvt_pk_bf16_f32 v17, v58, v59
    ds_write_b64 v97, v[16:17] offset:36960
    v_pk_mul_f32 v[44:45], v[36:37], v[72:73] op_sel_hi:[0,1]
    v_pk_mul_f32 v[62:63], v[54:55], v[84:85] op_sel_hi:[0,1]
    v_pk_mul_f32 v[46:47], v[42:43], v[80:81] op_sel_hi:[0,1]
    v_pk_mul_f32 v[64:65], v[60:61], v[92:93] op_sel_hi:[0,1]
    v_pk_mul_f32 v[48:49], v[40:41], v[80:81] op_sel_hi:[0,1]
    v_pk_mul_f32 v[66:67], v[58:59], v[92:93] op_sel_hi:[0,1]
    v_pk_fma_f32 v[38:39], v[36:37], v[72:73], v[44:45] op_sel:[1,1,0] op_sel_hi:[1,0,1] neg_lo:[1,0,0]
    v_pk_fma_f32 v[56:57], v[54:55], v[84:85], v[62:63] op_sel:[1,1,0] op_sel_hi:[1,0,1] neg_lo:[1,0,0]
    v_pk_fma_f32 v[42:43], v[42:43], v[80:81], v[46:47] op_sel:[1,1,0] op_sel_hi:[1,0,1] neg_lo:[1,0,0]
    v_pk_fma_f32 v[60:61], v[60:61], v[92:93], v[64:65] op_sel:[1,1,0] op_sel_hi:[1,0,1] neg_lo:[1,0,0]
    v_pk_fma_f32 v[40:41], v[40:41], v[80:81], v[48:49] op_sel:[1,1,0] op_sel_hi:[1,0,1] neg_lo:[1,0,0]
    v_pk_fma_f32 v[58:59], v[58:59], v[92:93], v[66:67] op_sel:[1,1,0] op_sel_hi:[1,0,1] neg_lo:[1,0,0]
    v_cvt_pk_bf16_f32 v18, v38, -v39
    v_cvt_pk_bf16_f32 v19, v56, -v57
    ds_write_b64 v97, v[18:19] offset:7392
    v_cvt_pk_bf16_f32 v20, v42, v43
    v_cvt_pk_bf16_f32 v21, v60, v61
    ds_write_b64 v97, v[20:21] offset:38016
    v_cvt_pk_bf16_f32 v22, v40, v41
    v_cvt_pk_bf16_f32 v23, v58, v59
    ds_write_b64 v97, v[22:23] offset:39072
    v_pk_mul_f32 v[44:45], v[78:79], v[76:77] op_sel_hi:[0,1]
    v_pk_mul_f32 v[62:63], v[90:91], v[88:89] op_sel_hi:[0,1]
    v_pk_mul_f32 v[46:47], v[32:33], v[76:77] op_sel_hi:[0,1]
    v_pk_mul_f32 v[64:65], v[50:51], v[88:89] op_sel_hi:[0,1]
    v_pk_mul_f32 v[48:49], v[42:43], v[80:81] op_sel_hi:[0,1]
    v_pk_mul_f32 v[66:67], v[60:61], v[92:93] op_sel_hi:[0,1]
    v_pk_fma_f32 v[78:79], v[78:79], v[76:77], v[44:45] op_sel:[1,1,0] op_sel_hi:[1,0,1] neg_lo:[1,0,0]
    v_pk_fma_f32 v[90:91], v[90:91], v[88:89], v[62:63] op_sel:[1,1,0] op_sel_hi:[1,0,1] neg_lo:[1,0,0]
    v_pk_fma_f32 v[32:33], v[32:33], v[76:77], v[46:47] op_sel:[1,1,0] op_sel_hi:[1,0,1] neg_lo:[1,0,0]
    v_pk_fma_f32 v[50:51], v[50:51], v[88:89], v[64:65] op_sel:[1,1,0] op_sel_hi:[1,0,1] neg_lo:[1,0,0]
    v_pk_fma_f32 v[42:43], v[42:43], v[80:81], v[48:49] op_sel:[1,1,0] op_sel_hi:[1,0,1] neg_lo:[1,0,0]
    v_pk_fma_f32 v[60:61], v[60:61], v[92:93], v[66:67] op_sel:[1,1,0] op_sel_hi:[1,0,1] neg_lo:[1,0,0]
    v_cvt_pk_bf16_f32 v16, v78, -v79
    v_cvt_pk_bf16_f32 v17, v90, -v91
    ds_write_b64 v97, v[16:17] offset:8448
    v_cvt_pk_bf16_f32 v18, v32, -v33
    v_cvt_pk_bf16_f32 v19, v50, -v51
    ds_write_b64 v97, v[18:19] offset:9504
    v_cvt_pk_bf16_f32 v20, v42, v43
    v_cvt_pk_bf16_f32 v21, v60, v61
    ds_write_b64 v97, v[20:21] offset:40128
    v_pk_mul_f32 v[44:45], v[34:35], v[76:77] op_sel_hi:[0,1]
    v_pk_mul_f32 v[62:63], v[52:53], v[88:89] op_sel_hi:[0,1]
    v_pk_mul_f32 v[46:47], v[40:41], v[80:81] op_sel_hi:[0,1]
    v_pk_mul_f32 v[64:65], v[58:59], v[92:93] op_sel_hi:[0,1]
    v_pk_mul_f32 v[48:49], v[42:43], v[80:81] op_sel_hi:[0,1]
    v_pk_mul_f32 v[66:67], v[60:61], v[92:93] op_sel_hi:[0,1]
    v_pk_fma_f32 v[34:35], v[34:35], v[76:77], v[44:45] op_sel:[1,1,0] op_sel_hi:[1,0,1] neg_lo:[1,0,0]
    v_pk_fma_f32 v[52:53], v[52:53], v[88:89], v[62:63] op_sel:[1,1,0] op_sel_hi:[1,0,1] neg_lo:[1,0,0]
    v_pk_fma_f32 v[40:41], v[40:41], v[80:81], v[46:47] op_sel:[1,1,0] op_sel_hi:[1,0,1] neg_lo:[1,0,0]
    v_pk_fma_f32 v[58:59], v[58:59], v[92:93], v[64:65] op_sel:[1,1,0] op_sel_hi:[1,0,1] neg_lo:[1,0,0]
    v_pk_fma_f32 v[42:43], v[42:43], v[80:81], v[48:49] op_sel:[1,1,0] op_sel_hi:[1,0,1] neg_lo:[1,0,0]
    v_pk_fma_f32 v[60:61], v[60:61], v[92:93], v[66:67] op_sel:[1,1,0] op_sel_hi:[1,0,1] neg_lo:[1,0,0]
    v_cvt_pk_bf16_f32 v22, v34, -v35
    v_cvt_pk_bf16_f32 v23, v52, -v53
    ds_write_b64 v97, v[22:23] offset:10560
    v_cvt_pk_bf16_f32 v16, v40, v41
    v_cvt_pk_bf16_f32 v17, v58, v59
    ds_write_b64 v97, v[16:17] offset:41184
    v_cvt_pk_bf16_f32 v18, v42, v43
    v_cvt_pk_bf16_f32 v19, v60, v61
    ds_write_b64 v97, v[18:19] offset:42240
    s_mov_b32 s90, 1048576
    v_lshlrev_b32 v122, 7, v0
    buffer_load_dword v123, v122, s[4:7], s90 offen offset:8 sc1
    buffer_load_dword v124, v122, s[4:7], s90 offen offset:72 sc1
    v_pk_mul_f32 v[44:45], v[36:37], v[76:77] op_sel_hi:[0,1]
    v_pk_mul_f32 v[62:63], v[54:55], v[88:89] op_sel_hi:[0,1]
    v_pk_mul_f32 v[46:47], v[78:79], v[76:77] op_sel_hi:[0,1]
    v_pk_mul_f32 v[64:65], v[90:91], v[88:89] op_sel_hi:[0,1]
    v_pk_mul_f32 v[48:49], v[40:41], v[80:81] op_sel_hi:[0,1]
    v_pk_mul_f32 v[66:67], v[58:59], v[92:93] op_sel_hi:[0,1]
    v_pk_fma_f32 v[36:37], v[36:37], v[76:77], v[44:45] op_sel:[1,1,0] op_sel_hi:[1,0,1] neg_lo:[1,0,0]
    v_pk_fma_f32 v[54:55], v[54:55], v[88:89], v[62:63] op_sel:[1,1,0] op_sel_hi:[1,0,1] neg_lo:[1,0,0]
    v_pk_fma_f32 v[78:79], v[78:79], v[76:77], v[46:47] op_sel:[1,1,0] op_sel_hi:[1,0,1] neg_lo:[1,0,0]
    v_pk_fma_f32 v[90:91], v[90:91], v[88:89], v[64:65] op_sel:[1,1,0] op_sel_hi:[1,0,1] neg_lo:[1,0,0]
    v_pk_fma_f32 v[40:41], v[40:41], v[80:81], v[48:49] op_sel:[1,1,0] op_sel_hi:[1,0,1] neg_lo:[1,0,0]
    v_pk_fma_f32 v[58:59], v[58:59], v[92:93], v[66:67] op_sel:[1,1,0] op_sel_hi:[1,0,1] neg_lo:[1,0,0]
    v_cvt_pk_bf16_f32 v20, v36, -v37
    v_cvt_pk_bf16_f32 v21, v54, -v55
    ds_write_b64 v97, v[20:21] offset:11616
    v_cvt_pk_bf16_f32 v22, v78, -v79
    v_cvt_pk_bf16_f32 v23, v90, -v91
    ds_write_b64 v97, v[22:23] offset:12672
    v_cvt_pk_bf16_f32 v16, v40, v41
    v_cvt_pk_bf16_f32 v17, v58, v59
    ds_write_b64 v97, v[16:17] offset:43296
    v_pk_mul_f32 v[44:45], v[34:35], v[76:77] op_sel_hi:[0,1]
    v_pk_mul_f32 v[62:63], v[52:53], v[88:89] op_sel_hi:[0,1]
    v_pk_mul_f32 v[46:47], v[42:43], v[80:81] op_sel_hi:[0,1]
    v_pk_mul_f32 v[64:65], v[60:61], v[92:93] op_sel_hi:[0,1]
    v_pk_mul_f32 v[48:49], v[40:41], v[80:81] op_sel_hi:[0,1]
    v_pk_mul_f32 v[66:67], v[58:59], v[92:93] op_sel_hi:[0,1]
    v_pk_fma_f32 v[34:35], v[34:35], v[76:77], v[44:45] op_sel:[1,1,0] op_sel_hi:[1,0,1] neg_lo:[1,0,0]
    v_pk_fma_f32 v[52:53], v[52:53], v[88:89], v[62:63] op_sel:[1,1,0] op_sel_hi:[1,0,1] neg_lo:[1,0,0]
    v_pk_fma_f32 v[42:43], v[42:43], v[80:81], v[46:47] op_sel:[1,1,0] op_sel_hi:[1,0,1] neg_lo:[1,0,0]
    v_pk_fma_f32 v[60:61], v[60:61], v[92:93], v[64:65] op_sel:[1,1,0] op_sel_hi:[1,0,1] neg_lo:[1,0,0]
    v_pk_fma_f32 v[40:41], v[40:41], v[80:81], v[48:49] op_sel:[1,1,0] op_sel_hi:[1,0,1] neg_lo:[1,0,0]
    v_pk_fma_f32 v[58:59], v[58:59], v[92:93], v[66:67] op_sel:[1,1,0] op_sel_hi:[1,0,1] neg_lo:[1,0,0]
    v_cvt_pk_bf16_f32 v18, v34, -v35
    v_cvt_pk_bf16_f32 v19, v52, -v53
    ds_write_b64 v97, v[18:19] offset:13728
    v_cvt_pk_bf16_f32 v20, v42, v43
    v_cvt_pk_bf16_f32 v21, v60, v61
    ds_write_b64 v97, v[20:21] offset:44352
    v_cvt_pk_bf16_f32 v22, v40, v41
    v_cvt_pk_bf16_f32 v23, v58, v59
    ds_write_b64 v97, v[22:23] offset:45408
    v_pk_mul_f32 v[44:45], v[78:79], v[76:77] op_sel_hi:[0,1]
    v_pk_mul_f32 v[62:63], v[90:91], v[88:89] op_sel_hi:[0,1]
    v_pk_mul_f32 v[46:47], v[34:35], v[76:77] op_sel_hi:[0,1]
    v_pk_mul_f32 v[64:65], v[52:53], v[88:89] op_sel_hi:[0,1]
    v_pk_mul_f32 v[48:49], v[42:43], v[80:81] op_sel_hi:[0,1]
    v_pk_mul_f32 v[66:67], v[60:61], v[92:93] op_sel_hi:[0,1]
    v_pk_fma_f32 v[78:79], v[78:79], v[76:77], v[44:45] op_sel:[1,1,0] op_sel_hi:[1,0,1] neg_lo:[1,0,0]
    v_pk_fma_f32 v[90:91], v[90:91], v[88:89], v[62:63] op_sel:[1,1,0] op_sel_hi:[1,0,1] neg_lo:[1,0,0]
    v_pk_fma_f32 v[34:35], v[34:35], v[76:77], v[46:47] op_sel:[1,1,0] op_sel_hi:[1,0,1] neg_lo:[1,0,0]
    v_pk_fma_f32 v[52:53], v[52:53], v[88:89], v[64:65] op_sel:[1,1,0] op_sel_hi:[1,0,1] neg_lo:[1,0,0]
    v_pk_fma_f32 v[42:43], v[42:43], v[80:81], v[48:49] op_sel:[1,1,0] op_sel_hi:[1,0,1] neg_lo:[1,0,0]
    v_pk_fma_f32 v[60:61], v[60:61], v[92:93], v[66:67] op_sel:[1,1,0] op_sel_hi:[1,0,1] neg_lo:[1,0,0]
    v_cvt_pk_bf16_f32 v16, v78, -v79
    v_cvt_pk_bf16_f32 v17, v90, -v91
    ds_write_b64 v97, v[16:17] offset:14784
    v_cvt_pk_bf16_f32 v18, v34, -v35
    v_cvt_pk_bf16_f32 v19, v52, -v53
    ds_write_b64 v97, v[18:19] offset:15840
    v_cvt_pk_bf16_f32 v20, v42, v43
    v_cvt_pk_bf16_f32 v21, v60, v61
    ds_write_b64 v97, v[20:21] offset:46464
    v_pk_mul_f32 v[44:45], v[78:79], v[76:77] op_sel_hi:[0,1]
    v_pk_mul_f32 v[62:63], v[90:91], v[88:89] op_sel_hi:[0,1]
    v_pk_mul_f32 v[46:47], v[40:41], v[80:81] op_sel_hi:[0,1]
    v_pk_mul_f32 v[64:65], v[58:59], v[92:93] op_sel_hi:[0,1]
    v_pk_mul_f32 v[48:49], v[42:43], v[80:81] op_sel_hi:[0,1]
    v_pk_mul_f32 v[66:67], v[60:61], v[92:93] op_sel_hi:[0,1]
    v_pk_fma_f32 v[78:79], v[78:79], v[76:77], v[44:45] op_sel:[1,1,0] op_sel_hi:[1,0,1] neg_lo:[1,0,0]
    v_pk_fma_f32 v[90:91], v[90:91], v[88:89], v[62:63] op_sel:[1,1,0] op_sel_hi:[1,0,1] neg_lo:[1,0,0]
    v_pk_fma_f32 v[40:41], v[40:41], v[80:81], v[46:47] op_sel:[1,1,0] op_sel_hi:[1,0,1] neg_lo:[1,0,0]
    v_pk_fma_f32 v[58:59], v[58:59], v[92:93], v[64:65] op_sel:[1,1,0] op_sel_hi:[1,0,1] neg_lo:[1,0,0]
    v_pk_fma_f32 v[42:43], v[42:43], v[80:81], v[48:49] op_sel:[1,1,0] op_sel_hi:[1,0,1] neg_lo:[1,0,0]
    v_pk_fma_f32 v[60:61], v[60:61], v[92:93], v[66:67] op_sel:[1,1,0] op_sel_hi:[1,0,1] neg_lo:[1,0,0]
    v_cvt_pk_bf16_f32 v22, v78, -v79
    v_cvt_pk_bf16_f32 v23, v90, -v91
    ds_write_b64 v97, v[22:23] offset:16896
    v_cvt_pk_bf16_f32 v16, v40, v41
    v_cvt_pk_bf16_f32 v17, v58, v59
    ds_write_b64 v97, v[16:17] offset:47520
    v_cvt_pk_bf16_f32 v18, v42, v43
    v_cvt_pk_bf16_f32 v19, v60, v61
    ds_write_b64 v97, v[18:19] offset:48576
    v_pk_mul_f32 v[44:45], v[78:79], v[76:77] op_sel_hi:[0,1]
    v_pk_mul_f32 v[62:63], v[90:91], v[88:89] op_sel_hi:[0,1]
    v_pk_mul_f32 v[46:47], v[40:41], v[80:81] op_sel_hi:[0,1]
    v_pk_mul_f32 v[64:65], v[58:59], v[92:93] op_sel_hi:[0,1]
    v_pk_mul_f32 v[48:49], v[42:43], v[80:81] op_sel_hi:[0,1]
    v_pk_mul_f32 v[66:67], v[60:61], v[92:93] op_sel_hi:[0,1]
    v_pk_fma_f32 v[78:79], v[78:79], v[76:77], v[44:45] op_sel:[1,1,0] op_sel_hi:[1,0,1] neg_lo:[1,0,0]
    v_pk_fma_f32 v[90:91], v[90:91], v[88:89], v[62:63] op_sel:[1,1,0] op_sel_hi:[1,0,1] neg_lo:[1,0,0]
    v_pk_fma_f32 v[40:41], v[40:41], v[80:81], v[46:47] op_sel:[1,1,0] op_sel_hi:[1,0,1] neg_lo:[1,0,0]
    v_pk_fma_f32 v[58:59], v[58:59], v[92:93], v[64:65] op_sel:[1,1,0] op_sel_hi:[1,0,1] neg_lo:[1,0,0]
    v_pk_fma_f32 v[42:43], v[42:43], v[80:81], v[48:49] op_sel:[1,1,0] op_sel_hi:[1,0,1] neg_lo:[1,0,0]
    v_pk_fma_f32 v[60:61], v[60:61], v[92:93], v[66:67] op_sel:[1,1,0] op_sel_hi:[1,0,1] neg_lo:[1,0,0]
    v_cvt_pk_bf16_f32 v20, v78, -v79
    v_cvt_pk_bf16_f32 v21, v90, -v91
    ds_write_b64 v97, v[20:21] offset:17952
    v_cvt_pk_bf16_f32 v22, v40, v41
    v_cvt_pk_bf16_f32 v23, v58, v59
    ds_write_b64 v97, v[22:23] offset:49632
    v_cvt_pk_bf16_f32 v16, v42, v43
    v_cvt_pk_bf16_f32 v17, v60, v61
    ds_write_b64 v97, v[16:17] offset:50688
    v_pk_mul_f32 v[44:45], v[78:79], v[76:77] op_sel_hi:[0,1]
    v_pk_mul_f32 v[62:63], v[90:91], v[88:89] op_sel_hi:[0,1]
    v_pk_mul_f32 v[46:47], v[40:41], v[80:81] op_sel_hi:[0,1]
    v_pk_mul_f32 v[64:65], v[58:59], v[92:93] op_sel_hi:[0,1]
    v_pk_mul_f32 v[48:49], v[42:43], v[80:81] op_sel_hi:[0,1]
    v_pk_mul_f32 v[66:67], v[60:61], v[92:93] op_sel_hi:[0,1]
    v_pk_fma_f32 v[78:79], v[78:79], v[76:77], v[44:45] op_sel:[1,1,0] op_sel_hi:[1,0,1] neg_lo:[1,0,0]
    v_pk_fma_f32 v[90:91], v[90:91], v[88:89], v[62:63] op_sel:[1,1,0] op_sel_hi:[1,0,1] neg_lo:[1,0,0]
    v_pk_fma_f32 v[40:41], v[40:41], v[80:81], v[46:47] op_sel:[1,1,0] op_sel_hi:[1,0,1] neg_lo:[1,0,0]
    v_pk_fma_f32 v[58:59], v[58:59], v[92:93], v[64:65] op_sel:[1,1,0] op_sel_hi:[1,0,1] neg_lo:[1,0,0]
    v_pk_fma_f32 v[42:43], v[42:43], v[80:81], v[48:49] op_sel:[1,1,0] op_sel_hi:[1,0,1] neg_lo:[1,0,0]
    v_pk_fma_f32 v[60:61], v[60:61], v[92:93], v[66:67] op_sel:[1,1,0] op_sel_hi:[1,0,1] neg_lo:[1,0,0]
    v_cvt_pk_bf16_f32 v18, v78, -v79
    v_cvt_pk_bf16_f32 v19, v90, -v91
    ds_write_b64 v97, v[18:19] offset:19008
    v_cvt_pk_bf16_f32 v20, v40, v41
    v_cvt_pk_bf16_f32 v21, v58, v59
    ds_write_b64 v97, v[20:21] offset:51744
    v_cvt_pk_bf16_f32 v22, v42, v43
    v_cvt_pk_bf16_f32 v23, v60, v61
    ds_write_b64 v97, v[22:23] offset:52800
    v_pk_mul_f32 v[44:45], v[78:79], v[76:77] op_sel_hi:[0,1]
    v_pk_mul_f32 v[62:63], v[90:91], v[88:89] op_sel_hi:[0,1]
    v_pk_mul_f32 v[46:47], v[40:41], v[80:81] op_sel_hi:[0,1]
    v_pk_mul_f32 v[64:65], v[58:59], v[92:93] op_sel_hi:[0,1]
    v_pk_mul_f32 v[48:49], v[42:43], v[80:81] op_sel_hi:[0,1]
    v_pk_mul_f32 v[66:67], v[60:61], v[92:93] op_sel_hi:[0,1]
    v_pk_fma_f32 v[78:79], v[78:79], v[76:77], v[44:45] op_sel:[1,1,0] op_sel_hi:[1,0,1] neg_lo:[1,0,0]
    v_pk_fma_f32 v[90:91], v[90:91], v[88:89], v[62:63] op_sel:[1,1,0] op_sel_hi:[1,0,1] neg_lo:[1,0,0]
    v_pk_fma_f32 v[40:41], v[40:41], v[80:81], v[46:47] op_sel:[1,1,0] op_sel_hi:[1,0,1] neg_lo:[1,0,0]
    v_pk_fma_f32 v[58:59], v[58:59], v[92:93], v[64:65] op_sel:[1,1,0] op_sel_hi:[1,0,1] neg_lo:[1,0,0]
    v_pk_fma_f32 v[42:43], v[42:43], v[80:81], v[48:49] op_sel:[1,1,0] op_sel_hi:[1,0,1] neg_lo:[1,0,0]
    v_pk_fma_f32 v[60:61], v[60:61], v[92:93], v[66:67] op_sel:[1,1,0] op_sel_hi:[1,0,1] neg_lo:[1,0,0]
    v_cvt_pk_bf16_f32 v16, v78, -v79
    v_cvt_pk_bf16_f32 v17, v90, -v91
    ds_write_b64 v97, v[16:17] offset:20064
    v_cvt_pk_bf16_f32 v18, v40, v41
    v_cvt_pk_bf16_f32 v19, v58, v59
    ds_write_b64 v97, v[18:19] offset:53856
    v_cvt_pk_bf16_f32 v20, v42, v43
    v_cvt_pk_bf16_f32 v21, v60, v61
    ds_write_b64 v97, v[20:21] offset:54912
    v_pk_mul_f32 v[44:45], v[78:79], v[76:77] op_sel_hi:[0,1]
    v_pk_mul_f32 v[62:63], v[90:91], v[88:89] op_sel_hi:[0,1]
    v_pk_fma_f32 v[78:79], v[78:79], v[76:77], v[44:45] op_sel:[1,1,0] op_sel_hi:[1,0,1] neg_lo:[1,0,0]
    v_pk_fma_f32 v[90:91], v[90:91], v[88:89], v[62:63] op_sel:[1,1,0] op_sel_hi:[1,0,1] neg_lo:[1,0,0]
    v_cvt_pk_bf16_f32 v22, v78, -v79
    v_cvt_pk_bf16_f32 v23, v90, -v91
    ds_write_b64 v97, v[22:23] offset:21120
    s_lshr_b32 s74, s50, 1
    s_mul_i32 s75, s74, 1328
    s_add_u32 s75, s75, 136128
    v_mov_b32 v16, 0
    v_mov_b32 v17, s75
    ds_write_b16 v17, v16 offset:1282
    s_mul_i32 s72, s74, 55968
    v_and_b32 v16, 15, v1
    v_lshrrev_b32 v17, 4, v1
    v_lshl_add_u32 v18, v17, 4, s72
    v_mul_u32_u24 v96, 1056, v16
    v_add_u32 v96, v96, v18
    v_min_u32 v97, 4, v16
    v_add_u32 v97, 16, v97
    v_mul_u32_u24 v97, 1056, v97
    v_add_u32 v97, v97, v18
    s_and_b32 s76, s50, 1
    s_lshl_b32 s77, s76, 4
    s_add_u32 s78, s77, 21
    s_mul_i32 s78, s78, 1056
    v_add_u32 v15, s78, v96
    s_waitcnt lgkmcnt(0)
    s_barrier
    ds_read_b128 v[32:35], v96 offset:0
    ds_read_b128 v[36:39], v15 offset:0
    ds_read_b128 v[40:43], v97 offset:0
    ds_read_b128 v[44:47], v96 offset:64
    ds_read_b128 v[48:51], v15 offset:64
    ds_read_b128 v[52:55], v97 offset:64
    ds_read_b128 v[56:59], v96 offset:128
    ds_read_b128 v[60:63], v15 offset:128
    ds_read_b128 v[64:67], v97 offset:128
    v_and_b32 v125, 0xfe, v0
    v_mul_u32_u24 v125, 7168, v125
    v_and_b32 v126, 1, v0
    v_lshl_add_u32 v125, v126, 4, v125
    s_mov_b32 s78, 2104320
    s_lshl_b32 s72, s60, 4
    v_add_u32 v125, s72, v125
    s_mov_b32 s74, 2097152
    v_and_b32 v126, 31, v1
    v_lshlrev_b32 v126, 7, v126
    s_mov_b32 s79, 65536
    s_lshl_b32 s72, s50, 13
    s_add_u32 s72, s72, s69
    s_add_u32 s73, s72, 4096
    s_waitcnt vmcnt(0)
Le_8:
    v_xor_b32 v123, s56, v123
    v_bitop3_b32 v123, v123, v124, s56 bitop3:0xf6
    v_cmp_ne_u32 s[82:83], 0, v123
    s_nop 0
    s_cmp_eq_u64 s[82:83], 0
    s_cbranch_scc1 Le_9
    s_add_u32 s71, s71, 1
    s_cmp_gt_u32 s71, 32768
    s_cbranch_scc1 Le_9
    s_sleep 1
    buffer_load_dword v123, v122, s[4:7], s90 offen offset:8 sc1
    buffer_load_dword v124, v122, s[4:7], s90 offen offset:72 sc1
    s_waitcnt vmcnt(0)
    s_branch Le_8
Le_9:
    buffer_load_dwordx4 v[80:83], v125, s[4:7], s74 offen sc1
    ds_read_b128 v[68:71], v96 offset:192
    ds_read_b128 v[72:75], v15 offset:192
    ds_read_b128 v[76:79], v97 offset:192
    s_waitcnt lgkmcnt(9)
    v_mfma_f32_16x16x32_bf16 v[16:19], v[32:35], v[36:39], 0
    v_mfma_f32_16x16x32_bf16 v[20:23], v[40:43], v[36:39], 0
    v_and_b32 v117, 15, v1
    v_lshrrev_b32 v118, 4, v1
    buffer_load_dwordx2 a[0:1], v2, s[4:7], s72 offen offset:0 sc1
    buffer_load_dwordx2 a[2:3], v2, s[4:7], s72 offen offset:1024 sc1
    ds_read_b128 v[32:35], v96 offset:256
    ds_read_b128 v[36:39], v15 offset:256
    ds_read_b128 v[40:43], v97 offset:256
    s_waitcnt lgkmcnt(9)
    v_mfma_f32_16x16x32_bf16 v[16:19], v[44:47], v[48:51], v[16:19]
    v_mfma_f32_16x16x32_bf16 v[20:23], v[52:55], v[48:51], v[20:23]
    v_add_u32 v117, s77, v117
    v_lshlrev_b32 v114, 3, v117
    buffer_load_dwordx2 a[4:5], v2, s[4:7], s72 offen offset:2048 sc1
    buffer_load_dwordx2 a[6:7], v2, s[4:7], s72 offen offset:3072 sc1
    ds_read_b128 v[44:47], v96 offset:320
    ds_read_b128 v[48:51], v15 offset:320
    ds_read_b128 v[52:55], v97 offset:320
    s_waitcnt lgkmcnt(9)
    v_mfma_f32_16x16x32_bf16 v[16:19], v[56:59], v[60:63], v[16:19]
    v_mfma_f32_16x16x32_bf16 v[20:23], v[64:67], v[60:63], v[20:23]
    v_lshl_add_u32 v114, v118, 2, v114
    v_lshlrev_b32 v115, 2, v117
    buffer_load_dwordx4 v[84:87], v125, s[4:7], s78 offen sc1
    ds_read_b128 v[56:59], v96 offset:384
    ds_read_b128 v[60:63], v15 offset:384
    ds_read_b128 v[64:67], v97 offset:384
    s_waitcnt lgkmcnt(9)
    v_mfma_f32_16x16x32_bf16 v[16:19], v[68:71], v[72:75], v[16:19]
    v_mfma_f32_16x16x32_bf16 v[20:23], v[76:79], v[72:75], v[20:23]
    v_add_u32 v115, 256, v115
    v_lshlrev_b32 v116, 1, v117
    buffer_load_dwordx2 a[8:9], v2, s[4:7], s73 offen offset:0 sc1
    buffer_load_dwordx2 a[10:11], v2, s[4:7], s73 offen offset:1024 sc1
    ds_read_b128 v[68:71], v96 offset:448
    ds_read_b128 v[72:75], v15 offset:448
    ds_read_b128 v[76:79], v97 offset:448
    s_waitcnt lgkmcnt(9)
    v_mfma_f32_16x16x32_bf16 v[16:19], v[32:35], v[36:39], v[16:19]
    v_mfma_f32_16x16x32_bf16 v[20:23], v[40:43], v[36:39], v[20:23]
    v_add_u32 v116, 384, v116
    v_cmp_eq_u32 vcc, 2, v118
    buffer_load_dwordx2 a[12:13], v2, s[4:7], s73 offen offset:2048 sc1
    buffer_load_dwordx2 a[14:15], v2, s[4:7], s73 offen offset:3072 sc1
    ds_read_b128 v[32:35], v96 offset:512
    ds_read_b128 v[36:39], v15 offset:512
    ds_read_b128 v[40:43], v97 offset:512
    s_waitcnt lgkmcnt(9)
    v_mfma_f32_16x16x32_bf16 v[16:19], v[44:47], v[48:51], v[16:19]
    v_mfma_f32_16x16x32_bf16 v[20:23], v[52:55], v[48:51], v[20:23]
    v_cndmask_b32 v114, v114, v115, vcc
    v_mov_b32 v115, 2
    buffer_load_dword v127, v126, s[4:7], s79 offen sc1
    ds_read_b128 v[44:47], v96 offset:576
    ds_read_b128 v[48:51], v15 offset:576
    ds_read_b128 v[52:55], v97 offset:576
    s_waitcnt lgkmcnt(9)
    v_mfma_f32_16x16x32_bf16 v[16:19], v[56:59], v[60:63], v[16:19]
    v_mfma_f32_16x16x32_bf16 v[20:23], v[64:67], v[60:63], v[20:23]
    v_cmp_eq_u32 vcc, 3, v118
    s_nop 1
    v_cndmask_b32 v114, v114, v116, vcc
    ds_read_b128 v[56:59], v96 offset:640
    ds_read_b128 v[60:63], v15 offset:640
    ds_read_b128 v[64:67], v97 offset:640
    s_waitcnt lgkmcnt(9)
    v_mfma_f32_16x16x32_bf16 v[16:19], v[68:71], v[72:75], v[16:19]
    v_mfma_f32_16x16x32_bf16 v[20:23], v[76:79], v[72:75], v[20:23]
    v_cndmask_b32 v115, v115, 64, vcc
    v_add_u32 v115, v114, v115
    ds_read_b128 v[68:71], v96 offset:704
    ds_read_b128 v[72:75], v15 offset:704
    ds_read_b128 v[76:79], v97 offset:704
    s_waitcnt lgkmcnt(9)
    v_mfma_f32_16x16x32_bf16 v[16:19], v[32:35], v[36:39], v[16:19]
    v_mfma_f32_16x16x32_bf16 v[20:23], v[40:43], v[36:39], v[20:23]
    v_lshl_add_u32 v114, v114, 1, s75
    v_lshl_add_u32 v115, v115, 1, s75
    ds_read_b128 v[32:35], v96 offset:768
    ds_read_b128 v[36:39], v15 offset:768
    ds_read_b128 v[40:43], v97 offset:768
    s_waitcnt lgkmcnt(9)
    v_mfma_f32_16x16x32_bf16 v[16:19], v[44:47], v[48:51], v[16:19]
    v_mfma_f32_16x16x32_bf16 v[20:23], v[52:55], v[48:51], v[20:23]
    v_add_u32 v116, 512, v117
    v_mov_b32 v119, 640
    ds_read_b128 v[44:47], v96 offset:832
    ds_read_b128 v[48:51], v15 offset:832
    ds_read_b128 v[52:55], v97 offset:832
    s_waitcnt lgkmcnt(9)
    v_mfma_f32_16x16x32_bf16 v[16:19], v[56:59], v[60:63], v[16:19]
    v_mfma_f32_16x16x32_bf16 v[20:23], v[64:67], v[60:63], v[20:23]
    v_cmp_eq_u32 vcc, 16, v1
    s_nop 1
    v_cndmask_b32 v116, v116, v119, vcc
    ds_read_b128 v[56:59], v96 offset:896
    ds_read_b128 v[60:63], v15 offset:896
    ds_read_b128 v[64:67], v97 offset:896
    s_waitcnt lgkmcnt(9)
    v_mfma_f32_16x16x32_bf16 v[16:19], v[68:71], v[72:75], v[16:19]
    v_mfma_f32_16x16x32_bf16 v[20:23], v[76:79], v[72:75], v[20:23]
    v_lshl_add_u32 v116, v116, 1, s75
    ds_read_b128 v[68:71], v96 offset:960
    ds_read_b128 v[72:75], v15 offset:960
    ds_read_b128 v[76:79], v97 offset:960
    s_waitcnt lgkmcnt(9)
    v_mfma_f32_16x16x32_bf16 v[16:19], v[32:35], v[36:39], v[16:19]
    v_mfma_f32_16x16x32_bf16 v[20:23], v[40:43], v[36:39], v[20:23]
    s_waitcnt lgkmcnt(6)
    v_mfma_f32_16x16x32_bf16 v[16:19], v[44:47], v[48:51], v[16:19]
    v_mfma_f32_16x16x32_bf16 v[20:23], v[52:55], v[48:51], v[20:23]
    s_waitcnt lgkmcnt(3)
    v_mfma_f32_16x16x32_bf16 v[16:19], v[56:59], v[60:63], v[16:19]
    v_mfma_f32_16x16x32_bf16 v[20:23], v[64:67], v[60:63], v[20:23]
    s_waitcnt lgkmcnt(0)
    v_mfma_f32_16x16x32_bf16 v[16:19], v[68:71], v[72:75], v[16:19]
    v_mfma_f32_16x16x32_bf16 v[20:23], v[76:79], v[72:75], v[20:23]
    v_mov_b32 v119, v126
    s_lshl_b32 s90, s58, 2
    s_add_u32 s90, s90, s50
    s_mul_i32 s90, s90, 7
    v_lshrrev_b32 v120, 2, v1
    v_add_u32 v120, s90, v120
    v_mul_u32_u24 v122, 342, v120
    v_lshrrev_b32 v122, 16, v122
    v_mul_u32_u24 v122, 320, v122
    v_add_u32 v120, v120, v122
    v_mul_u32_u24 v120, 3584, v120
    v_and_b32 v121, 3, v0
    v_lshlrev_b32 v121, 7, v121
    s_lshr_b32 s90, s57, 1
    s_mul_i32 s90, s90, 7
    s_and_b32 s91, s57, 1
    s_mul_i32 s91, s91, 3
    s_add_u32 s90, s90, s91
    s_lshl_b32 s90, s90, 7
    v_add3_u32 v120, v120, v121, s90
    s_mov_b32 s90, 0
    s_mov_b32 exec_hi, 0
    s_mov_b32 exec_lo, 268435455
    buffer_load_dword a253, v120, s[8:11], s90 offen
    s_mov_b64 exec, -1
Lt_10:
    v_cvt_pk_bf16_f32 v16, v16, v17
    v_cvt_pk_bf16_f32 v17, v18, v19
    v_cvt_pk_bf16_f32 v20, v20, v21
    v_cvt_pk_bf16_f32 v21, v22, v23
    ds_write_b32 v114, v16
    ds_write_b32 v115, v17
    s_lshr_b32 exec_lo, 0x1ffff, s76
    s_mov_b32 exec_hi, 0
    ds_write_b16 v116, v20
    s_mov_b32 exec_lo, 0xffff
    ds_write_b16_d16_hi v116, v20 offset:64
    ds_write_b16 v116, v21 offset:128
    ds_write_b16_d16_hi v116, v21 offset:192
    s_mov_b64 exec, -1
    v_lshlrev_b32 v15, 5, v0
    v_add_u32 v15, 98304, v15
    v_pk_mov_b32 v[44:45], 0, 0
    v_pk_mov_b32 v[46:47], 0, 0
    v_add_u32 v96, 114688, v2
    v_add_u32 v97, 131264, v2
    s_waitcnt lgkmcnt(0)
    s_barrier
    ds_read_u16 v16, v107 offset:0
    ds_read_u16 v17, v108 offset:0
    ds_read_u16 v18, v109 offset:0
    ds_read_u16 v19, v110 offset:0
    ds_read_u16 v20, v111 offset:0
    ds_read_u16 v21, v112 offset:0
    ds_read_u16 v22, v113 offset:0
    ds_read_u16 v88, v107 offset:1328
    ds_read_u16 v89, v108 offset:1328
    ds_read_u16 v90, v109 offset:1328
    ds_read_u16 v91, v110 offset:1328
    ds_read_u16 v92, v111 offset:1328
    ds_read_u16 v93, v112 offset:1328
    ds_read_u16 v94, v113 offset:1328
    ds_read_u16 v32, v100 offset:0
    ds_read_u16 v33, v101 offset:0
    ds_read_u16 v34, v102 offset:0
    ds_read_u16 v35, v103 offset:0
    ds_read_u16 v36, v104 offset:0
    ds_read_u16 v37, v105 offset:0
    ds_read_u16 v38, v106 offset:0
    s_cmp_lg_u32 s50, 0
    s_cbranch_scc1 Lk_11
    s_mov_b64 exec, 0x3f
    ds_write_b128 v96, v[44:47]
    ds_write_b128 v96, v[44:47] offset:16480
    s_mov_b64 exec, 0x3fffffff
    ds_write_b128 v97, v[44:47]
    ds_write_b128 v97, v[44:47] offset:7520
    s_mov_b64 exec, -1
Lk_11:
    s_waitcnt lgkmcnt(14)
    v_lshl_or_b32 v40, v17, 16, v16
    v_lshl_or_b32 v41, v19, 16, v18
    v_lshl_or_b32 v42, v18, 16, v17
    v_lshl_or_b32 v43, v20, 16, v19
    v_lshl_or_b32 v44, v19, 16, v18
    v_lshl_or_b32 v45, v21, 16, v20
    v_lshl_or_b32 v46, v20, 16, v19
    v_lshl_or_b32 v47, v22, 16, v21
    ds_write_b128 v15, v[40:43] offset:8192
    ds_write_b128 v15, v[44:47] offset:8208
    s_waitcnt lgkmcnt(9)
    v_lshl_or_b32 v108, v89, 16, v88
    v_lshl_or_b32 v109, v91, 16, v90
    v_lshl_or_b32 v110, v90, 16, v89
    v_lshl_or_b32 v111, v92, 16, v91
    v_lshl_or_b32 v112, v91, 16, v90
    v_lshl_or_b32 v113, v93, 16, v92
    v_lshl_or_b32 v114, v92, 16, v91
    v_lshl_or_b32 v115, v94, 16, v93
    ds_write_b128 v15, v[108:111] offset:24672
    ds_write_b128 v15, v[112:115] offset:24688
    s_waitcnt lgkmcnt(4)
    v_lshl_or_b32 v40, v33, 16, v32
    v_lshl_or_b32 v41, v35, 16, v34
    v_lshl_or_b32 v42, v34, 16, v33
    v_lshl_or_b32 v43, v36, 16, v35
    v_lshl_or_b32 v44, v35, 16, v34
    v_lshl_or_b32 v45, v37, 16, v36
    v_lshl_or_b32 v46, v36, 16, v35
    v_lshl_or_b32 v47, v38, 16, v37
    ds_write_b128 v98, v[40:43] offset:0
    ds_write_b128 v98, v[44:47] offset:16
    v_mov_b32 v22, 0x3b124925
    v_mov_b32 v23, 0x3b124925
    s_mov_b32 s80, 0
    s_mov_b32 s81, 0x3727c5ac
    s_waitcnt vmcnt(1)
Lc_12:
    v_cmp_ne_u32 vcc, s56, v127
    s_cbranch_vccz Lc_13
    s_add_u32 s71, s71, 1
    s_cmp_gt_u32 s71, 32768
    s_cbranch_scc1 Lc_13
    s_sleep 1
    buffer_load_dword v127, v119, s[4:7], s79 offen sc1
    s_waitcnt vmcnt(0)
    s_branch Lc_12
Lc_13:
    s_mov_b32 vcc_lo, 0x55555555
    s_mov_b32 vcc_hi, 0x55555555
    v_cndmask_b32_dpp v104, v84, v80, vcc quad_perm:[1,0,3,2] row_mask:0xf bank_mask:0xf
    v_cndmask_b32_dpp v105, v85, v81, vcc quad_perm:[1,0,3,2] row_mask:0xf bank_mask:0xf
    v_cndmask_b32_dpp v106, v86, v82, vcc quad_perm:[1,0,3,2] row_mask:0xf bank_mask:0xf
    v_cndmask_b32_dpp v107, v87, v83, vcc quad_perm:[1,0,3,2] row_mask:0xf bank_mask:0xf
    s_not_b64 vcc, vcc
    v_cndmask_b32_dpp v108, v80, v84, vcc quad_perm:[1,0,3,2] row_mask:0xf bank_mask:0xf
    v_cndmask_b32_dpp v109, v81, v85, vcc quad_perm:[1,0,3,2] row_mask:0xf bank_mask:0xf
    v_cndmask_b32_dpp v110, v82, v86, vcc quad_perm:[1,0,3,2] row_mask:0xf bank_mask:0xf
    v_cndmask_b32_dpp v111, v83, v87, vcc quad_perm:[1,0,3,2] row_mask:0xf bank_mask:0xf
    v_accvgpr_read_b32 v48, a0
    v_accvgpr_read_b32 v49, a1
    v_accvgpr_read_b32 v52, a2
    v_accvgpr_read_b32 v53, a3
    v_accvgpr_read_b32 v56, a4
    v_accvgpr_read_b32 v57, a5
    v_accvgpr_read_b32 v60, a6
    v_accvgpr_read_b32 v61, a7
    v_accvgpr_read_b32 v64, a8
    v_accvgpr_read_b32 v65, a9
    v_accvgpr_read_b32 v68, a10
    v_accvgpr_read_b32 v69, a11
    v_accvgpr_read_b32 v72, a12
    v_accvgpr_read_b32 v73, a13
    v_accvgpr_read_b32 v76, a14
    v_accvgpr_read_b32 v77, a15
    v_pk_fma_f32 v[48:49], v[48:49], v[22:23], s[80:81]
    s_mul_i32 s45, s50, 24576
    s_add_u32 m0, s45, 0
    s_mov_b32 s47, 0
    buffer_load_dwordx4 v9, s[8:11], s47 offen  lds
    v_pk_fma_f32 v[52:53], v[52:53], v[22:23], s[80:81]
    v_pk_fma_f32 v[56:57], v[56:57], v[22:23], s[80:81]
    v_pk_fma_f32 v[60:61], v[60:61], v[22:23], s[80:81]
    v_pk_fma_f32 v[64:65], v[64:65], v[22:23], s[80:81]
    v_pk_fma_f32 v[68:69], v[68:69], v[22:23], s[80:81]
    v_pk_fma_f32 v[72:73], v[72:73], v[22:23], s[80:81]
    v_pk_fma_f32 v[76:77], v[76:77], v[22:23], s[80:81]
    v_fma_f32 v49, -v48, v48, v49
    v_fma_f32 v53, -v52, v52, v53
    v_fma_f32 v57, -v56, v56, v57
    v_fma_f32 v61, -v60, v60, v61
    v_fma_f32 v65, -v64, v64, v65
    v_fma_f32 v69, -v68, v68, v69
    v_fma_f32 v73, -v72, v72, v73
    v_fma_f32 v77, -v76, v76, v77
    v_max_f32 v49, s81, v49
    v_max_f32 v53, s81, v53
    v_max_f32 v57, s81, v57
    v_max_f32 v61, s81, v61
    v_max_f32 v65, s81, v65
    v_max_f32 v69, s81, v69
    buffer_load_dwordx4 v10, s[8:11], s47 offen offset:1024  lds
    v_max_f32 v73, s81, v73
    v_max_f32 v77, s81, v77
    v_rsq_f32 v50, v49
    v_rsq_f32 v54, v53
    v_rsq_f32 v58, v57
    v_rsq_f32 v62, v61
    v_rsq_f32 v66, v65
    v_rsq_f32 v70, v69
    v_rsq_f32 v74, v73
    v_rsq_f32 v78, v77
    v_mul_f32 v51, -v48, v50
    ds_write_b64 v24, v[50:51] offset:0
    v_mul_f32 v55, -v52, v54
    ds_write_b64 v25, v[54:55] offset:512
    v_mul_f32 v59, -v56, v58
    ds_write_b64 v24, v[58:59] offset:1024
    s_add_u32 m0, s45, 2048
    s_mov_b32 s47, 57344
    buffer_load_dwordx4 v9, s[8:11], s47 offen  lds
    v_mul_f32 v63, -v60, v62
    ds_write_b64 v25, v[62:63] offset:1536
    v_mul_f32 v67, -v64, v66
    ds_write_b64 v24, v[66:67] offset:2048
    v_mul_f32 v71, -v68, v70
    ds_write_b64 v25, v[70:71] offset:2560
    v_mul_f32 v75, -v72, v74
    ds_write_b64 v24, v[74:75] offset:3072
    v_mul_f32 v79, -v76, v78
    ds_write_b64 v25, v[78:79] offset:3584
    ds_read_b128 v[48:51], v26
    ds_read_b128 v[52:55], v27
    ds_read_b128 v[56:59], v28
    ds_read_b128 v[60:63], v29
    v_lshlrev_b32 v88, 16, v104
    v_lshlrev_b32 v89, 16, v108
    v_and_b32 v90, 0xffff0000, v104
    v_and_b32 v91, 0xffff0000, v108
    v_lshlrev_b32 v92, 16, v105
    v_lshlrev_b32 v93, 16, v109
    v_and_b32 v94, 0xffff0000, v105
    v_and_b32 v95, 0xffff0000, v109
    v_lshlrev_b32 v96, 16, v106
    v_lshlrev_b32 v97, 16, v110
    buffer_load_dwordx4 v10, s[8:11], s47 offen offset:1024  lds
    v_and_b32 v98, 0xffff0000, v106
    v_and_b32 v99, 0xffff0000, v110
    v_lshlrev_b32 v100, 16, v107
    v_lshlrev_b32 v101, 16, v111
    v_and_b32 v102, 0xffff0000, v107
    v_and_b32 v103, 0xffff0000, v111
    s_waitcnt lgkmcnt(3)
    v_pk_fma_f32 v[64:65], v[88:89], v[48:49], v[48:49] op_sel:[0,0,1] op_sel_hi:[1,0,1]
    v_pk_fma_f32 v[66:67], v[90:91], v[50:51], v[50:51] op_sel:[0,0,1] op_sel_hi:[1,0,1]
    s_waitcnt lgkmcnt(2)
    v_pk_fma_f32 v[68:69], v[92:93], v[52:53], v[52:53] op_sel:[0,0,1] op_sel_hi:[1,0,1]
    v_pk_fma_f32 v[70:71], v[94:95], v[54:55], v[54:55] op_sel:[0,0,1] op_sel_hi:[1,0,1]
    s_waitcnt lgkmcnt(1)
    v_pk_fma_f32 v[72:73], v[96:97], v[56:57], v[56:57] op_sel:[0,0,1] op_sel_hi:[1,0,1]
    v_pk_fma_f32 v[74:75], v[98:99], v[58:59], v[58:59] op_sel:[0,0,1] op_sel_hi:[1,0,1]
    s_waitcnt lgkmcnt(0)
    v_pk_fma_f32 v[76:77], v[100:101], v[60:61], v[60:61] op_sel:[0,0,1] op_sel_hi:[1,0,1]
    v_pk_fma_f32 v[78:79], v[102:103], v[62:63], v[62:63] op_sel:[0,0,1] op_sel_hi:[1,0,1]
    v_cvt_pk_bf16_f32 v104, v64, v66
    v_cvt_pk_bf16_f32 v105, v68, v70
    v_cvt_pk_bf16_f32 v106, v72, v74
    v_cvt_pk_bf16_f32 v107, v76, v78
    s_add_u32 m0, s45, 4096
    s_mov_b32 s47, 114688
    buffer_load_dwordx4 v9, s[8:11], s47 offen  lds
    ds_write_b128 v31, v[104:107] offset:0
    v_cvt_pk_bf16_f32 v108, v65, v67
    v_cvt_pk_bf16_f32 v109, v69, v71
    v_cvt_pk_bf16_f32 v110, v73, v75
    v_cvt_pk_bf16_f32 v111, v77, v79
    ds_write_b128 v31, v[108:111] offset:7520
    v_fma_f32 v112, v64, s34, v88
    v_fma_f32 v113, v66, s34, v90
    v_fma_f32 v114, v68, s34, v92
    v_fma_f32 v115, v70, s34, v94
    v_fma_f32 v116, v72, s34, v96
    v_fma_f32 v117, v74, s34, v98
    v_fma_f32 v118, v76, s34, v100
    v_fma_f32 v119, v78, s34, v102
    ds_write_b128 v30, v[112:115] offset:0
    ds_write_b128 v30, v[116:119] offset:16
    v_fma_f32 v120, v65, s35, v89
    v_fma_f32 v121, v67, s35, v91
    v_fma_f32 v122, v69, s35, v93
    v_fma_f32 v123, v71, s35, v95
    v_fma_f32 v124, v73, s35, v97
    buffer_load_dwordx4 v10, s[8:11], s47 offen offset:1024  lds
    v_fma_f32 v125, v75, s35, v99
    v_fma_f32 v126, v77, s35, v101
    v_fma_f32 v127, v79, s35, v103
    ds_write_b128 v30, v[120:123] offset:2048
    ds_write_b128 v30, v[124:127] offset:2064
    s_lshl_b32 s90, s58, 2
    s_add_u32 s90, s90, s50
    s_mul_i32 s90, s90, 12
    v_lshrrev_b32 v114, 2, v1
    v_add_u32 v114, s90, v114
    v_mul_u32_u24 v116, 205, v114
    v_lshrrev_b32 v116, 16, v116
    v_mul_u32_u24 v116, 192, v116
    v_add_u32 v114, v114, v116
    v_mul_u32_u24 v114, 3584, v114
    v_and_b32 v115, 3, v0
    v_lshlrev_b32 v115, 7, v115
    s_lshr_b32 s90, s57, 1
    s_mul_i32 s90, s90, 7
    s_and_b32 s91, s57, 1
    s_mul_i32 s91, s91, 3
    s_add_u32 s90, s90, s91
    s_lshl_b32 s90, s90, 7
    v_add3_u32 v114, v114, v115, s90
    s_mov_b32 s90, 688128
    s_mov_b32 exec_hi, 65535
    s_mov_b32 exec_lo, 4294967295
    buffer_load_dword a252, v114, s[8:11], s90 offen
    s_mov_b64 exec, -1
Lt_14:
    v_lshrrev_b32 v114, 2, v0
    v_and_b32 v115, 3, v0
    v_lshlrev_b32 v115, 7, v115
    s_lshl_b32 s90, s58, 6
    v_add_u32 v114, s90, v114
    v_lshlrev_b32 v114, 12, v114
    s_lshl_b32 s90, s57, 9
    v_add3_u32 v15, v114, v115, s90
    s_waitcnt lgkmcnt(0)
    s_barrier
    s_cmp_eq_u32 s85, 0
    s_cbranch_scc0 Lc_15
    ds_read_b128 v[16:19], v6 offset:0
    ds_read_b128 v[20:23], v6 offset:1024
    ds_read_b128 v[24:27], v6 offset:4096
    ds_read_b128 v[28:31], v6 offset:5120
    v_pk_mov_b32 v[32:33], 0, 0
    v_pk_mov_b32 v[34:35], 0, 0
    v_pk_mov_b32 v[36:37], 0, 0
    v_pk_mov_b32 v[38:39], 0, 0
    v_pk_mov_b32 v[40:41], 0, 0
    v_pk_mov_b32 v[42:43], 0, 0
    v_pk_mov_b32 v[44:45], 0, 0
    v_pk_mov_b32 v[46:47], 0, 0
    s_branch Lc_16
Lc_15:
    ds_read_b128 v[32:35], v6 offset:0
    ds_read_b128 v[36:39], v6 offset:1024
    ds_read_b128 v[40:43], v6 offset:4096
    ds_read_b128 v[44:47], v6 offset:5120
    v_pk_mov_b32 v[16:17], 0, 0
    v_pk_mov_b32 v[18:19], 0, 0
    v_pk_mov_b32 v[20:21], 0, 0
    v_pk_mov_b32 v[22:23], 0, 0
    v_pk_mov_b32 v[24:25], 0, 0
    v_pk_mov_b32 v[26:27], 0, 0
    v_pk_mov_b32 v[28:29], 0, 0
    v_pk_mov_b32 v[30:31], 0, 0
Lc_16:
    v_add_u32 v6, s87, v2
    ds_read_b64 v[100:101], v5 offset:16128
    ds_read_b64 v[102:103], v5 offset:16160
    ds_read_b128 v[48:51], v4 offset:448
    ds_read_b128 v[52:55], v4 offset:960
    ds_read_b128 v[56:59], v4 offset:1472
    ds_read_b128 v[60:63], v4 offset:1984
    ds_read_b128 v[64:67], v4 offset:2496
    ds_read_b128 v[68:71], v4 offset:3008
    ds_read_b128 v[72:75], v4 offset:3520
    ds_read_b128 v[76:79], v4 offset:4032
    ds_read_b64 v[104:105], v5 offset:7936
    ds_read_b64 v[106:107], v5 offset:7968
    s_waitcnt lgkmcnt(12)
    s_waitcnt lgkmcnt(10)
    s_waitcnt lgkmcnt(9)
    v_mfma_f32_16x16x32_bf16 v[16:19], v[100:103], v[48:51], v[16:19]
    ds_read_b64 v[108:109], v5 offset:9984
    s_add_u32 m0, s45, 6144
    s_mov_b32 s47, 172032
    buffer_load_dwordx4 v9, s[8:11], s47 offen  lds
    s_waitcnt lgkmcnt(9)
    v_mfma_f32_16x16x32_bf16 v[20:23], v[100:103], v[52:55], v[20:23]
    ds_read_b64 v[110:111], v5 offset:10016
    s_waitcnt lgkmcnt(9)
    v_mfma_f32_16x16x32_bf16 v[24:27], v[100:103], v[56:59], v[24:27]
    ds_read_b128 v[80:83], v4 offset:384
    s_waitcnt lgkmcnt(9)
    v_mfma_f32_16x16x32_bf16 v[28:31], v[100:103], v[60:63], v[28:31]
    ds_read_b128 v[84:87], v4 offset:896
    s_waitcnt lgkmcnt(9)
    v_mfma_f32_16x16x32_bf16 v[32:35], v[100:103], v[64:67], v[32:35]
    ds_read_b128 v[88:91], v4 offset:1408
    s_waitcnt lgkmcnt(9)
    v_mfma_f32_16x16x32_bf16 v[36:39], v[100:103], v[68:71], v[36:39]
    ds_read_b128 v[92:95], v4 offset:1920
    s_waitcnt lgkmcnt(9)
    v_mfma_f32_16x16x32_bf16 v[40:43], v[100:103], v[72:75], v[40:43]
    ds_read_b128 v[96:99], v4 offset:2432
    buffer_load_dwordx4 v10, s[8:11], s47 offen offset:1024  lds
    s_waitcnt lgkmcnt(9)
    v_mfma_f32_16x16x32_bf16 v[44:47], v[100:103], v[76:79], v[44:47]
    s_waitcnt lgkmcnt(7)
    v_mfma_f32_16x16x32_bf16 v[32:35], v[104:107], v[48:51], v[32:35]
    ds_read_b64 v[100:101], v5 offset:14080
    v_mfma_f32_16x16x32_bf16 v[36:39], v[104:107], v[52:55], v[36:39]
    ds_read_b64 v[102:103], v5 offset:14112
    v_mfma_f32_16x16x32_bf16 v[40:43], v[104:107], v[56:59], v[40:43]
    ds_read_b128 v[76:79], v4 offset:2944
    v_mfma_f32_16x16x32_bf16 v[44:47], v[104:107], v[60:63], v[44:47]
    s_waitcnt lgkmcnt(8)
    v_mfma_f32_16x16x32_bf16 v[28:31], v[108:111], v[48:51], v[28:31]
    ds_read_b64 v[104:105], v5 offset:12032
    s_add_u32 m0, s45, 8192
    s_mov_b32 s47, 229376
    buffer_load_dwordx4 v9, s[8:11], s47 offen  lds
    v_mfma_f32_16x16x32_bf16 v[32:35], v[108:111], v[52:55], v[32:35]
    ds_read_b64 v[106:107], v5 offset:12064
    v_mfma_f32_16x16x32_bf16 v[36:39], v[108:111], v[56:59], v[36:39]
    v_mfma_f32_16x16x32_bf16 v[40:43], v[108:111], v[60:63], v[40:43]
    v_mfma_f32_16x16x32_bf16 v[44:47], v[108:111], v[64:67], v[44:47]
    s_waitcnt lgkmcnt(3)
    v_mfma_f32_16x16x32_bf16 v[20:23], v[100:103], v[48:51], v[20:23]
    ds_read_b64 v[108:109], v5 offset:15872
    v_mfma_f32_16x16x32_bf16 v[24:27], v[100:103], v[52:55], v[24:27]
    ds_read_b64 v[110:111], v5 offset:15904
    buffer_load_dwordx4 v10, s[8:11], s47 offen offset:1024  lds
    v_mfma_f32_16x16x32_bf16 v[28:31], v[100:103], v[56:59], v[28:31]
    v_mfma_f32_16x16x32_bf16 v[32:35], v[100:103], v[60:63], v[32:35]
    v_mfma_f32_16x16x32_bf16 v[36:39], v[100:103], v[64:67], v[36:39]
    v_mfma_f32_16x16x32_bf16 v[40:43], v[100:103], v[68:71], v[40:43]
    v_mfma_f32_16x16x32_bf16 v[44:47], v[100:103], v[72:75], v[44:47]
    s_waitcnt lgkmcnt(2)
    v_mfma_f32_16x16x32_bf16 v[24:27], v[104:107], v[48:51], v[24:27]
    ds_read_b64 v[100:101], v5 offset:9728
    s_add_u32 m0, s45, 10240
    s_mov_b32 s47, 286720
    buffer_load_dwordx4 v9, s[8:11], s47 offen  lds
    v_mfma_f32_16x16x32_bf16 v[28:31], v[104:107], v[52:55], v[28:31]
    ds_read_b64 v[102:103], v5 offset:9760
    v_mfma_f32_16x16x32_bf16 v[32:35], v[104:107], v[56:59], v[32:35]
    ds_read_b128 v[72:75], v4 offset:3456
    v_mfma_f32_16x16x32_bf16 v[36:39], v[104:107], v[60:63], v[36:39]
    v_mfma_f32_16x16x32_bf16 v[40:43], v[104:107], v[64:67], v[40:43]
    v_mfma_f32_16x16x32_bf16 v[44:47], v[104:107], v[68:71], v[44:47]
    s_waitcnt lgkmcnt(3)
    v_mfma_f32_16x16x32_bf16 v[16:19], v[108:111], v[80:83], v[16:19]
    ds_read_b128 v[48:51], v4 offset:3968
    buffer_load_dwordx4 v10, s[8:11], s47 offen offset:1024  lds
    v_mfma_f32_16x16x32_bf16 v[20:23], v[108:111], v[84:87], v[20:23]
    ds_read_b64 v[104:105], v5 offset:13824
    v_mfma_f32_16x16x32_bf16 v[24:27], v[108:111], v[88:91], v[24:27]
    ds_read_b64 v[106:107], v5 offset:13856
    v_mfma_f32_16x16x32_bf16 v[28:31], v[108:111], v[92:95], v[28:31]
    ds_read_b128 v[52:55], v4 offset:320
    v_mfma_f32_16x16x32_bf16 v[32:35], v[108:111], v[96:99], v[32:35]
    ds_read_b128 v[56:59], v4 offset:832
    v_mfma_f32_16x16x32_bf16 v[36:39], v[108:111], v[76:79], v[36:39]
    ds_read_b128 v[60:63], v4 offset:1344
    s_waitcnt lgkmcnt(6)
    v_mfma_f32_16x16x32_bf16 v[40:43], v[108:111], v[72:75], v[40:43]
    ds_read_b128 v[64:67], v4 offset:1856
    s_add_u32 m0, s45, 12288
    s_mov_b32 s47, 344064
    buffer_load_dwordx4 v9, s[8:11], s47 offen  lds
    s_waitcnt lgkmcnt(6)
    v_mfma_f32_16x16x32_bf16 v[44:47], v[108:111], v[48:51], v[44:47]
    ds_read_b128 v[68:71], v4 offset:2368
    v_mfma_f32_16x16x32_bf16 v[28:31], v[100:103], v[80:83], v[28:31]
    ds_read_b64 v[108:109], v5 offset:11776
    v_mfma_f32_16x16x32_bf16 v[32:35], v[100:103], v[84:87], v[32:35]
    ds_read_b64 v[110:111], v5 offset:11808
    v_mfma_f32_16x16x32_bf16 v[36:39], v[100:103], v[88:91], v[36:39]
    ds_read_b128 v[48:51], v4 offset:2880
    v_mfma_f32_16x16x32_bf16 v[40:43], v[100:103], v[92:95], v[40:43]
    s_lshl_b32 s90, s85, 10
    v_mfma_f32_16x16x32_bf16 v[44:47], v[100:103], v[96:99], v[44:47]
    s_add_u32 s90, s90, 116832
    buffer_load_dwordx4 v10, s[8:11], s47 offen offset:1024  lds
    s_waitcnt lgkmcnt(8)
    v_mfma_f32_16x16x32_bf16 v[20:23], v[104:107], v[80:83], v[20:23]
    ds_read_b64 v[100:101], v5 offset:15616
    v_mfma_f32_16x16x32_bf16 v[24:27], v[104:107], v[84:87], v[24:27]
    ds_read_b64 v[102:103], v5 offset:15648
    v_mfma_f32_16x16x32_bf16 v[28:31], v[104:107], v[88:91], v[28:31]
    v_add_u32 v126, s90, v2
    v_mfma_f32_16x16x32_bf16 v[32:35], v[104:107], v[92:95], v[32:35]
    ds_read_b128 v[122:125], v126
    v_mfma_f32_16x16x32_bf16 v[36:39], v[104:107], v[96:99], v[36:39]
    s_mul_i32 s90, s85, 240
    v_mfma_f32_16x16x32_bf16 v[40:43], v[104:107], v[76:79], v[40:43]
    s_add_u32 s90, s90, 432
    s_add_u32 m0, s45, 14336
    s_mov_b32 s47, 401408
    buffer_load_dwordx4 v9, s[8:11], s47 offen  lds
    v_mfma_f32_16x16x32_bf16 v[44:47], v[104:107], v[72:75], v[44:47]
    v_add_u32 v126, s90, v4
    s_waitcnt lgkmcnt(4)
    v_mfma_f32_16x16x32_bf16 v[24:27], v[108:111], v[80:83], v[24:27]
    ds_read_b64 v[104:105], v5 offset:9472
    v_mfma_f32_16x16x32_bf16 v[28:31], v[108:111], v[84:87], v[28:31]
    ds_read_b64 v[106:107], v5 offset:9504
    v_mfma_f32_16x16x32_bf16 v[32:35], v[108:111], v[88:91], v[32:35]
    ds_read_b128 v[72:75], v4 offset:3392
    v_mfma_f32_16x16x32_bf16 v[36:39], v[108:111], v[92:95], v[36:39]
    s_mul_i32 s90, s85, 1792
    v_mfma_f32_16x16x32_bf16 v[40:43], v[108:111], v[96:99], v[40:43]
    v_lshrrev_b32 v127, 4, v1
    buffer_load_dwordx4 v10, s[8:11], s47 offen offset:1024  lds
    v_mfma_f32_16x16x32_bf16 v[44:47], v[108:111], v[76:79], v[44:47]
    v_lshlrev_b32 v127, 5, v127
    s_waitcnt lgkmcnt(4)
    v_mfma_f32_16x16x32_bf16 v[16:19], v[100:103], v[52:55], v[16:19]
    ds_read_b128 v[80:83], v4 offset:3904
    v_mfma_f32_16x16x32_bf16 v[20:23], v[100:103], v[56:59], v[20:23]
    ds_read_b64 v[108:109], v5 offset:13568
    v_mfma_f32_16x16x32_bf16 v[24:27], v[100:103], v[60:63], v[24:27]
    ds_read_b64 v[110:111], v5 offset:13600
    v_mfma_f32_16x16x32_bf16 v[28:31], v[100:103], v[64:67], v[28:31]
    ds_read_b128 v[84:87], v4 offset:256
    v_mfma_f32_16x16x32_bf16 v[32:35], v[100:103], v[68:71], v[32:35]
    ds_read_b128 v[88:91], v4 offset:768
    s_add_u32 m0, s45, 16384
    s_mov_b32 s47, 458752
    buffer_load_dwordx4 v9, s[8:11], s47 offen  lds
    v_mfma_f32_16x16x32_bf16 v[36:39], v[100:103], v[48:51], v[36:39]
    ds_read_b128 v[92:95], v4 offset:1280
    s_waitcnt lgkmcnt(6)
    v_mfma_f32_16x16x32_bf16 v[40:43], v[100:103], v[72:75], v[40:43]
    ds_read_b128 v[96:99], v4 offset:1792
    s_waitcnt lgkmcnt(6)
    v_mfma_f32_16x16x32_bf16 v[44:47], v[100:103], v[80:83], v[44:47]
    ds_read_b128 v[76:79], v4 offset:2304
    v_mfma_f32_16x16x32_bf16 v[28:31], v[104:107], v[52:55], v[28:31]
    ds_read_b64 v[100:101], v5 offset:11520
    v_mfma_f32_16x16x32_bf16 v[32:35], v[104:107], v[56:59], v[32:35]
    ds_read_b64 v[102:103], v5 offset:11552
    v_mfma_f32_16x16x32_bf16 v[36:39], v[104:107], v[60:63], v[36:39]
    ds_read_b128 v[80:83], v4 offset:2816
    buffer_load_dwordx4 v10, s[8:11], s47 offen offset:1024  lds
    v_mfma_f32_16x16x32_bf16 v[40:43], v[104:107], v[64:67], v[40:43]
    v_sub_u32 v127, v5, v127
    v_mfma_f32_16x16x32_bf16 v[44:47], v[104:107], v[68:71], v[44:47]
    v_add_u32 v127, s90, v127
    s_waitcnt lgkmcnt(8)
    v_mfma_f32_16x16x32_bf16 v[20:23], v[108:111], v[52:55], v[20:23]
    ds_read_b64 v[104:105], v5 offset:15360
    v_mfma_f32_16x16x32_bf16 v[24:27], v[108:111], v[56:59], v[24:27]
    ds_read_b64 v[106:107], v5 offset:15392
    v_mfma_f32_16x16x32_bf16 v[28:31], v[108:111], v[60:63], v[28:31]
    v_mfma_f32_16x16x32_bf16 v[32:35], v[108:111], v[64:67], v[32:35]
    s_add_u32 m0, s45, 18432
    s_mov_b32 s47, 516096
    buffer_load_dwordx4 v9, s[8:11], s47 offen  lds
    v_mfma_f32_16x16x32_bf16 v[36:39], v[108:111], v[68:71], v[36:39]
    v_mfma_f32_16x16x32_bf16 v[40:43], v[108:111], v[48:51], v[40:43]
    v_mfma_f32_16x16x32_bf16 v[44:47], v[108:111], v[72:75], v[44:47]
    s_waitcnt lgkmcnt(3)
    v_mfma_f32_16x16x32_bf16 v[24:27], v[100:103], v[52:55], v[24:27]
    ds_read_b64 v[108:109], v5 offset:9216
    v_mfma_f32_16x16x32_bf16 v[28:31], v[100:103], v[56:59], v[28:31]
    ds_read_b64 v[110:111], v5 offset:9248
    v_mfma_f32_16x16x32_bf16 v[32:35], v[100:103], v[60:63], v[32:35]
    ds_read_b128 v[72:75], v4 offset:3328
    buffer_load_dwordx4 v10, s[8:11], s47 offen offset:1024  lds
    v_mfma_f32_16x16x32_bf16 v[36:39], v[100:103], v[64:67], v[36:39]
    v_mfma_f32_16x16x32_bf16 v[40:43], v[100:103], v[68:71], v[40:43]
    v_mfma_f32_16x16x32_bf16 v[44:47], v[100:103], v[48:51], v[44:47]
    s_waitcnt lgkmcnt(3)
    v_mfma_f32_16x16x32_bf16 v[16:19], v[104:107], v[84:87], v[16:19]
    ds_read_b128 v[52:55], v4 offset:3840
    v_mfma_f32_16x16x32_bf16 v[20:23], v[104:107], v[88:91], v[20:23]
    ds_read_b64 v[100:101], v5 offset:13312
    v_mfma_f32_16x16x32_bf16 v[24:27], v[104:107], v[92:95], v[24:27]
    ds_read_b64 v[102:103], v5 offset:13344
    s_add_u32 m0, s45, 20480
    s_mov_b32 s47, 573440
    buffer_load_dwordx4 v9, s[8:11], s47 offen  lds
    v_mfma_f32_16x16x32_bf16 v[28:31], v[104:107], v[96:99], v[28:31]
    ds_read_b128 v[56:59], v126 offset:0
    v_mfma_f32_16x16x32_bf16 v[32:35], v[104:107], v[76:79], v[32:35]
    ds_read_b128 v[60:63], v126 offset:512
    v_mfma_f32_16x16x32_bf16 v[36:39], v[104:107], v[80:83], v[36:39]
    ds_read_b128 v[64:67], v126 offset:1024
    s_waitcnt lgkmcnt(6)
    v_mfma_f32_16x16x32_bf16 v[40:43], v[104:107], v[72:75], v[40:43]
    ds_read_b128 v[68:71], v126 offset:1536
    s_waitcnt lgkmcnt(6)
    v_mfma_f32_16x16x32_bf16 v[44:47], v[104:107], v[52:55], v[44:47]
    ds_read_b64 v[112:113], v127 offset:32
    s_waitcnt lgkmcnt(3)
    v_mfma_f32_16x16x32_bf16 v[48:51], v[56:59], v[122:125], 0
    ds_read_b64 v[104:105], v5 offset:11264
    buffer_load_dwordx4 v10, s[8:11], s47 offen offset:1024  lds
    v_mfma_f32_16x16x32_bf16 v[52:55], v[60:63], v[122:125], 0
    ds_read_b64 v[106:107], v5 offset:11296
    v_mfma_f32_16x16x32_bf16 v[28:31], v[108:111], v[84:87], v[28:31]
    ds_read_b64 v[114:115], v127 offset:160
    v_mfma_f32_16x16x32_bf16 v[32:35], v[108:111], v[88:91], v[32:35]
    ds_read_b64 v[116:117], v127 offset:288
    v_mfma_f32_16x16x32_bf16 v[36:39], v[108:111], v[92:95], v[36:39]
    ds_read_b64 v[118:119], v127 offset:416
    v_mfma_f32_16x16x32_bf16 v[40:43], v[108:111], v[96:99], v[40:43]
    ds_read_b64 v[120:121], v127 offset:544
    v_mfma_f32_16x16x32_bf16 v[44:47], v[108:111], v[76:79], v[44:47]
    s_add_u32 m0, s45, 22528
    s_mov_b32 s47, 630784
    buffer_load_dwordx4 v9, s[8:11], s47 offen  lds
    v_mfma_f32_16x16x32_bf16 v[20:23], v[100:103], v[84:87], v[20:23]
    v_cvt_pk_bf16_f32 v56, v48, v49
    v_mfma_f32_16x16x32_bf16 v[24:27], v[100:103], v[88:91], v[24:27]
    v_cvt_pk_bf16_f32 v57, v50, v51
    v_mfma_f32_16x16x32_bf16 v[28:31], v[100:103], v[92:95], v[28:31]
    v_cvt_pk_bf16_f32 v58, v52, v53
    v_cvt_pk_bf16_f32 v59, v54, v55
    s_waitcnt lgkmcnt(7)
    v_mfma_f32_16x16x32_bf16 v[48:51], v[64:67], v[122:125], 0
    v_mfma_f32_16x16x32_bf16 v[52:55], v[68:71], v[122:125], 0
    v_mfma_f32_16x16x32_bf16 v[32:35], v[100:103], v[96:99], v[32:35]
    buffer_load_dwordx4 v10, s[8:11], s47 offen offset:1024  lds
    v_mfma_f32_16x16x32_bf16 v[36:39], v[100:103], v[76:79], v[36:39]
    v_mfma_f32_16x16x32_bf16 v[40:43], v[100:103], v[80:83], v[40:43]
    v_mfma_f32_16x16x32_bf16 v[44:47], v[100:103], v[72:75], v[44:47]
    s_waitcnt lgkmcnt(4)
    v_mfma_f32_16x16x32_bf16 v[24:27], v[104:107], v[84:87], v[24:27]
    v_cvt_pk_bf16_f32 v60, v48, v49
    v_mfma_f32_16x16x32_bf16 v[28:31], v[104:107], v[88:91], v[28:31]
    v_cvt_pk_bf16_f32 v61, v50, v51
    v_mfma_f32_16x16x32_bf16 v[32:35], v[104:107], v[92:95], v[32:35]
    v_cvt_pk_bf16_f32 v62, v52, v53
    v_mfma_f32_16x16x32_bf16 v[36:39], v[104:107], v[96:99], v[36:39]
    v_cvt_pk_bf16_f32 v63, v54, v55
    v_mfma_f32_16x16x32_bf16 v[40:43], v[104:107], v[76:79], v[40:43]
    v_mfma_f32_16x16x32_bf16 v[44:47], v[104:107], v[80:83], v[44:47]
    s_waitcnt lgkmcnt(0)
    v_mfma_f32_16x16x32_bf16 v[32:35], v[56:59], v[118:121], v[32:35]
    v_mfma_f32_16x16x32_bf16 v[36:39], v[56:59], v[116:119], v[36:39]
    v_mfma_f32_16x16x32_bf16 v[40:43], v[56:59], v[114:117], v[40:43]
    v_mfma_f32_16x16x32_bf16 v[44:47], v[56:59], v[112:115], v[44:47]
    v_mfma_f32_16x16x32_bf16 v[40:43], v[60:63], v[118:121], v[40:43]
    buffer_load_dword a255, v15, s[12:15], 0 offen
    v_mfma_f32_16x16x32_bf16 v[44:47], v[60:63], v[116:119], v[44:47]
    s_cmp_eq_u32 s85, 0
    s_cbranch_scc0 Lc_17
    ds_write_b128 v6, v[32:35] offset:0
    ds_write_b128 v6, v[36:39] offset:1024
    s_nop 1
    ds_write_b128 v6, v[40:43] offset:4096
    s_nop 0
    ds_write_b128 v6, v[44:47] offset:5120
    s_waitcnt lgkmcnt(0)
    s_barrier
    ds_read_b128 v[48:51], v7 offset:0
    ds_read_b128 v[52:55], v7 offset:1024
    ds_read_b128 v[56:59], v7 offset:4096
    ds_read_b128 v[60:63], v7 offset:5120
    s_waitcnt lgkmcnt(3)
    v_pk_add_f32 v[48:49], v[48:49], v[16:17]
    v_pk_add_f32 v[50:51], v[50:51], v[18:19]
    s_waitcnt lgkmcnt(2)
    v_pk_add_f32 v[52:53], v[52:53], v[20:21]
    v_pk_add_f32 v[54:55], v[54:55], v[22:23]
    s_waitcnt lgkmcnt(1)
    v_pk_add_f32 v[56:57], v[56:57], v[24:25]
    v_pk_add_f32 v[58:59], v[58:59], v[26:27]
    s_waitcnt lgkmcnt(0)
    v_pk_add_f32 v[60:61], v[60:61], v[28:29]
    v_pk_add_f32 v[62:63], v[62:63], v[30:31]
    s_branch Lc_18
Lc_17:
    ds_write_b128 v6, v[16:19] offset:0
    ds_write_b128 v6, v[20:23] offset:1024
    ds_write_b128 v6, v[24:27] offset:4096
    ds_write_b128 v6, v[28:31] offset:5120
    s_waitcnt lgkmcnt(0)
    s_barrier
    ds_read_b128 v[48:51], v7 offset:0
    ds_read_b128 v[52:55], v7 offset:1024
    ds_read_b128 v[56:59], v7 offset:4096
    ds_read_b128 v[60:63], v7 offset:5120
    s_waitcnt lgkmcnt(3)
    v_pk_add_f32 v[48:49], v[48:49], v[32:33]
    v_pk_add_f32 v[50:51], v[50:51], v[34:35]
    s_waitcnt lgkmcnt(2)
    v_pk_add_f32 v[52:53], v[52:53], v[36:37]
    v_pk_add_f32 v[54:55], v[54:55], v[38:39]
    s_waitcnt lgkmcnt(1)
    v_pk_add_f32 v[56:57], v[56:57], v[40:41]
    v_pk_add_f32 v[58:59], v[58:59], v[42:43]
    s_waitcnt lgkmcnt(0)
    v_pk_add_f32 v[60:61], v[60:61], v[44:45]
    v_pk_add_f32 v[62:63], v[62:63], v[46:47]
Lc_18:
    v_cvt_pk_bf16_f32 v64, v48, v49
    v_cvt_pk_bf16_f32 v65, v50, v51
    v_cvt_pk_bf16_f32 v66, v52, v53
    v_cvt_pk_bf16_f32 v67, v54, v55
    v_cvt_pk_bf16_f32 v68, v56, v57
    v_cvt_pk_bf16_f32 v69, v58, v59
    v_cvt_pk_bf16_f32 v70, v60, v61
    v_cvt_pk_bf16_f32 v71, v62, v63
    v_permlane16_swap_b32 v64, v66
    v_permlane16_swap_b32 v65, v67
    v_permlane16_swap_b32 v68, v70
    v_permlane16_swap_b32 v69, v71
    buffer_store_dwordx4 v[64:67], v8, s[4:7], s86 offen sc1
    buffer_store_dwordx4 v[68:71], v8, s[4:7], s86 offen offset:1024 sc1
    s_waitcnt vmcnt(24)
    ds_read_b64_tr_b16 a[0:1], v11 offset:0
    ds_read_b64_tr_b16 a[2:3], v11 offset:512
    ds_read_b64_tr_b16 a[4:5], v12 offset:0
    ds_read_b64_tr_b16 a[6:7], v12 offset:512
    ds_read_b64_tr_b16 a[8:9], v11 offset:2048
    ds_read_b64_tr_b16 a[10:11], v11 offset:2560
    ds_read_b64_tr_b16 a[12:13], v12 offset:2048
    ds_read_b64_tr_b16 a[14:15], v12 offset:2560
    s_waitcnt vmcnt(19)
    ds_read_b64_tr_b16 a[16:17], v11 offset:4096
    ds_read_b64_tr_b16 a[18:19], v11 offset:4608
    ds_read_b64_tr_b16 a[20:21], v12 offset:4096
    ds_read_b64_tr_b16 a[22:23], v12 offset:4608
    ds_read_b64_tr_b16 a[24:25], v11 offset:6144
    ds_read_b64_tr_b16 a[26:27], v11 offset:6656
    ds_read_b64_tr_b16 a[28:29], v12 offset:6144
    ds_read_b64_tr_b16 a[30:31], v12 offset:6656
    s_waitcnt vmcnt(15)
    ds_read_b64_tr_b16 a[32:33], v11 offset:8192
    ds_read_b64_tr_b16 a[34:35], v11 offset:8704
    ds_read_b64_tr_b16 a[36:37], v12 offset:8192
    ds_read_b64_tr_b16 a[38:39], v12 offset:8704
    ds_read_b64_tr_b16 a[40:41], v11 offset:10240
    ds_read_b64_tr_b16 a[42:43], v11 offset:10752
    ds_read_b64_tr_b16 a[44:45], v12 offset:10240
    ds_read_b64_tr_b16 a[46:47], v12 offset:10752
    s_waitcnt vmcnt(11)
    ds_read_b64_tr_b16 a[48:49], v11 offset:12288
    ds_read_b64_tr_b16 a[50:51], v11 offset:12800
    ds_read_b64_tr_b16 a[52:53], v12 offset:12288
    ds_read_b64_tr_b16 a[54:55], v12 offset:12800
    ds_read_b64_tr_b16 a[56:57], v11 offset:14336
    ds_read_b64_tr_b16 a[58:59], v11 offset:14848
    ds_read_b64_tr_b16 a[60:61], v12 offset:14336
    ds_read_b64_tr_b16 a[62:63], v12 offset:14848
    s_waitcnt vmcnt(7)
    ds_read_b64_tr_b16 a[64:65], v11 offset:16384
    ds_read_b64_tr_b16 a[66:67], v11 offset:16896
    ds_read_b64_tr_b16 a[68:69], v12 offset:16384
    ds_read_b64_tr_b16 a[70:71], v12 offset:16896
    ds_read_b64_tr_b16 a[72:73], v11 offset:18432
    ds_read_b64_tr_b16 a[74:75], v11 offset:18944
    ds_read_b64_tr_b16 a[76:77], v12 offset:18432
    ds_read_b64_tr_b16 a[78:79], v12 offset:18944
    s_waitcnt vmcnt(3)
    ds_read_b64_tr_b16 a[80:81], v11 offset:20480
    ds_read_b64_tr_b16 a[82:83], v11 offset:20992
    ds_read_b64_tr_b16 a[84:85], v12 offset:20480
    ds_read_b64_tr_b16 a[86:87], v12 offset:20992
    ds_read_b64_tr_b16 a[88:89], v11 offset:22528
    ds_read_b64_tr_b16 a[90:91], v11 offset:23040
    ds_read_b64_tr_b16 a[92:93], v12 offset:22528
    ds_read_b64_tr_b16 a[94:95], v12 offset:23040
    s_waitcnt lgkmcnt(0)
    s_mul_i32 s45, s50, 24576
    s_add_u32 m0, s45, 0
    s_mov_b32 s47, 688128
    buffer_load_dwordx4 v9, s[8:11], s47 offen  lds
    buffer_load_dwordx4 v10, s[8:11], s47 offen offset:1024  lds
    s_add_u32 m0, s45, 2048
    s_mov_b32 s47, 745472
    buffer_load_dwordx4 v9, s[8:11], s47 offen  lds
    buffer_load_dwordx4 v10, s[8:11], s47 offen offset:1024  lds
    s_add_u32 m0, s45, 4096
    s_mov_b32 s47, 802816
    buffer_load_dwordx4 v9, s[8:11], s47 offen  lds
    buffer_load_dwordx4 v10, s[8:11], s47 offen offset:1024  lds
    s_add_u32 m0, s45, 6144
    s_mov_b32 s47, 860160
    buffer_load_dwordx4 v9, s[8:11], s47 offen  lds
    buffer_load_dwordx4 v10, s[8:11], s47 offen offset:1024  lds
    s_add_u32 m0, s45, 8192
    s_mov_b32 s47, 917504
    buffer_load_dwordx4 v9, s[8:11], s47 offen  lds
    buffer_load_dwordx4 v10, s[8:11], s47 offen offset:1024  lds
    s_add_u32 m0, s45, 10240
    s_mov_b32 s47, 974848
    buffer_load_dwordx4 v9, s[8:11], s47 offen  lds
    buffer_load_dwordx4 v10, s[8:11], s47 offen offset:1024  lds
    s_add_u32 m0, s45, 12288
    s_mov_b32 s47, 1032192
    buffer_load_dwordx4 v9, s[8:11], s47 offen  lds
    buffer_load_dwordx4 v10, s[8:11], s47 offen offset:1024  lds
    s_add_u32 m0, s45, 14336
    s_mov_b32 s47, 1089536
    buffer_load_dwordx4 v9, s[8:11], s47 offen  lds
    buffer_load_dwordx4 v10, s[8:11], s47 offen offset:1024  lds
    s_add_u32 m0, s45, 16384
    s_mov_b32 s47, 1146880
    buffer_load_dwordx4 v9, s[8:11], s47 offen  lds
    buffer_load_dwordx4 v10, s[8:11], s47 offen offset:1024  lds
    s_add_u32 m0, s45, 18432
    s_mov_b32 s47, 1204224
    buffer_load_dwordx4 v9, s[8:11], s47 offen  lds
    buffer_load_dwordx4 v10, s[8:11], s47 offen offset:1024  lds
    s_add_u32 m0, s45, 20480
    s_mov_b32 s47, 1261568
    buffer_load_dwordx4 v9, s[8:11], s47 offen  lds
    buffer_load_dwordx4 v10, s[8:11], s47 offen offset:1024  lds
    s_add_u32 m0, s45, 22528
    s_mov_b32 s47, 1318912
    buffer_load_dwordx4 v9, s[8:11], s47 offen  lds
    buffer_load_dwordx4 v10, s[8:11], s47 offen offset:1024  lds
    v_lshrrev_b32 v6, 5, v1
    v_lshlrev_b32 v5, 4, v6
    s_lshl_b32 s72, s62, 7
    s_lshl_b32 s73, s50, 5
    s_add_u32 s72, s72, s73
    v_add_u32 v5, s72, v5
    global_load_dwordx4 v[16:19], v5, s[38:39]
    v_lshlrev_b32 v4, 12, v1
    s_lshl_b32 s72, s50, 18
    s_add_u32 s72, s72, s66
    s_lshl_b32 s73, s59, 4
    s_add_u32 s73, s73, s72
    s_add_u32 s73, s73, 4194304
    s_add_u32 s74, s73, 0x100000
    s_mov_b32 s71, 0
    s_lshl_b32 s75, s59, 9
    s_add_u32 s75, s75, s72
    s_add_u32 s75, s75, 6029312
    s_add_u32 s76, s75, 0x100000
    s_mov_b32 s77, 73728
    v_pk_mov_b32 v[76:77], 0, 0
    v_pk_mov_b32 v[78:79], 0, 0
    v_mov_b32 v20, s56
    v_lshlrev_b32 v6, 17, v6
    v_and_b32 v7, 31, v1
    v_lshl_add_u32 v6, v7, 4, v6
    v_lshlrev_b32 v7, 7, v7
    buffer_load_dwordx4 v[72:75], v4, s[4:7], s73 offen sc1
    s_cmp_eq_u32 s50, 3
    s_cbranch_scc1 Ln_21
    buffer_load_dwordx4 v[76:79], v4, s[4:7], s74 offen sc1
    s_branch Ln_22
Ln_21:
    buffer_load_dword v20, v7, s[4:7], s77 offen sc1
Ln_22:
    s_waitcnt vmcnt(23)
    ds_read_b64_tr_b16 a[96:97], v11 offset:0
    ds_read_b64_tr_b16 a[98:99], v11 offset:512
    ds_read_b64_tr_b16 a[100:101], v12 offset:0
    ds_read_b64_tr_b16 a[102:103], v12 offset:512
    ds_read_b64_tr_b16 a[104:105], v11 offset:2048
    ds_read_b64_tr_b16 a[106:107], v11 offset:2560
    ds_read_b64_tr_b16 a[108:109], v12 offset:2048
    ds_read_b64_tr_b16 a[110:111], v12 offset:2560
    s_waitcnt vmcnt(19)
    ds_read_b64_tr_b16 a[112:113], v11 offset:4096
    ds_read_b64_tr_b16 a[114:115], v11 offset:4608
    ds_read_b64_tr_b16 a[116:117], v12 offset:4096
    ds_read_b64_tr_b16 a[118:119], v12 offset:4608
    ds_read_b64_tr_b16 a[120:121], v11 offset:6144
    ds_read_b64_tr_b16 a[122:123], v11 offset:6656
    ds_read_b64_tr_b16 a[124:125], v12 offset:6144
    ds_read_b64_tr_b16 a[126:127], v12 offset:6656
    s_waitcnt vmcnt(15)
    ds_read_b64_tr_b16 a[128:129], v11 offset:8192
    ds_read_b64_tr_b16 a[130:131], v11 offset:8704
    ds_read_b64_tr_b16 a[132:133], v12 offset:8192
    ds_read_b64_tr_b16 a[134:135], v12 offset:8704
    ds_read_b64_tr_b16 a[136:137], v11 offset:10240
    ds_read_b64_tr_b16 a[138:139], v11 offset:10752
    ds_read_b64_tr_b16 a[140:141], v12 offset:10240
    ds_read_b64_tr_b16 a[142:143], v12 offset:10752
    s_waitcnt vmcnt(11)
    ds_read_b64_tr_b16 a[144:145], v11 offset:12288
    ds_read_b64_tr_b16 a[146:147], v11 offset:12800
    ds_read_b64_tr_b16 a[148:149], v12 offset:12288
    ds_read_b64_tr_b16 a[150:151], v12 offset:12800
    ds_read_b64_tr_b16 a[152:153], v11 offset:14336
    ds_read_b64_tr_b16 a[154:155], v11 offset:14848
    ds_read_b64_tr_b16 a[156:157], v12 offset:14336
    ds_read_b64_tr_b16 a[158:159], v12 offset:14848
    s_waitcnt vmcnt(7)
    ds_read_b64_tr_b16 a[160:161], v11 offset:16384
    ds_read_b64_tr_b16 a[162:163], v11 offset:16896
    ds_read_b64_tr_b16 a[164:165], v12 offset:16384
    ds_read_b64_tr_b16 a[166:167], v12 offset:16896
    ds_read_b64_tr_b16 a[168:169], v11 offset:18432
    ds_read_b64_tr_b16 a[170:171], v11 offset:18944
    ds_read_b64_tr_b16 a[172:173], v12 offset:18432
    ds_read_b64_tr_b16 a[174:175], v12 offset:18944
    s_waitcnt vmcnt(3)
    ds_read_b64_tr_b16 a[176:177], v11 offset:20480
    ds_read_b64_tr_b16 a[178:179], v11 offset:20992
    ds_read_b64_tr_b16 a[180:181], v12 offset:20480
    ds_read_b64_tr_b16 a[182:183], v12 offset:20992
    ds_read_b64_tr_b16 a[184:185], v11 offset:22528
    ds_read_b64_tr_b16 a[186:187], v11 offset:23040
    ds_read_b64_tr_b16 a[188:189], v12 offset:22528
    ds_read_b64_tr_b16 a[190:191], v12 offset:23040
    s_waitcnt lgkmcnt(0)
    s_waitcnt vmcnt(0)
Ln_19:
    v_max_u32 v5, v72, v76
    v_cmp_eq_u32 vcc, -1, v5
    v_cmp_ne_u32 s[82:83], s56, v20
    s_nop 0
    s_or_b64 vcc, vcc, s[82:83]
    s_cbranch_vccz Ln_20
    s_add_u32 s71, s71, 1
    s_cmp_gt_u32 s71, 32768
    s_cbranch_scc1 Ln_20
    s_sleep 1
    buffer_load_dwordx4 v[72:75], v4, s[4:7], s73 offen sc1
    s_cmp_eq_u32 s50, 3
    s_cbranch_scc1 Ln_23
    buffer_load_dwordx4 v[76:79], v4, s[4:7], s74 offen sc1
    s_branch Ln_24
Ln_23:
    buffer_load_dword v20, v7, s[4:7], s77 offen sc1
Ln_24:
    s_waitcnt vmcnt(0)
    s_branch Ln_19
Ln_20:
    v_lshlrev_b32 v32, 16, v72
    s_mul_i32 s45, s50, 24576
    s_add_u32 m0, s45, 0
    s_mov_b32 s47, 1376256
    buffer_load_dwordx4 v9, s[8:11], s47 offen  lds
    v_and_b32 v33, 0xffff0000, v72
    v_lshlrev_b32 v34, 16, v73
    v_and_b32 v35, 0xffff0000, v73
    v_lshlrev_b32 v36, 16, v74
    v_and_b32 v37, 0xffff0000, v74
    v_lshlrev_b32 v38, 16, v75
    v_and_b32 v39, 0xffff0000, v75
    v_lshlrev_b32 v40, 16, v76
    v_and_b32 v41, 0xffff0000, v76
    v_lshlrev_b32 v42, 16, v77
    v_and_b32 v43, 0xffff0000, v77
    v_lshlrev_b32 v44, 16, v78
    v_and_b32 v45, 0xffff0000, v78
    v_lshlrev_b32 v46, 16, v79
    v_and_b32 v47, 0xffff0000, v79
    v_pk_add_f32 v[48:49], v[32:33], v[40:41]
    v_pk_mul_f32 v[56:57], v[32:33], v[32:33]
    v_pk_add_f32 v[50:51], v[34:35], v[42:43]
    v_pk_mul_f32 v[58:59], v[34:35], v[34:35]
    v_pk_add_f32 v[52:53], v[36:37], v[44:45]
    v_pk_mul_f32 v[60:61], v[36:37], v[36:37]
    v_pk_add_f32 v[54:55], v[38:39], v[46:47]
    v_pk_mul_f32 v[62:63], v[38:39], v[38:39]
    buffer_load_dwordx4 v10, s[8:11], s47 offen offset:1024  lds
    v_pk_fma_f32 v[56:57], v[40:41], v[40:41], v[56:57]
    v_pk_fma_f32 v[58:59], v[42:43], v[42:43], v[58:59]
    v_pk_fma_f32 v[60:61], v[44:45], v[44:45], v[60:61]
    v_pk_fma_f32 v[62:63], v[46:47], v[46:47], v[62:63]
    v_add_f32_dpp v64, v48, v48 row_shl:4 row_mask:0xf bank_mask:0x5
    v_add_f32_dpp v65, v50, v50 row_shl:4 row_mask:0xf bank_mask:0x5
    v_add_f32_dpp v66, v52, v52 row_shl:4 row_mask:0xf bank_mask:0x5
    v_add_f32_dpp v67, v54, v54 row_shl:4 row_mask:0xf bank_mask:0x5
    v_add_f32_dpp v68, v56, v56 row_shl:4 row_mask:0xf bank_mask:0x5
    v_add_f32_dpp v69, v58, v58 row_shl:4 row_mask:0xf bank_mask:0x5
    v_add_f32_dpp v70, v60, v60 row_shl:4 row_mask:0xf bank_mask:0x5
    v_add_f32_dpp v71, v62, v62 row_shl:4 row_mask:0xf bank_mask:0x5
    v_add_f32_dpp v64, v49, v49 row_shr:4 row_mask:0xf bank_mask:0xa
    v_add_f32_dpp v65, v51, v51 row_shr:4 row_mask:0xf bank_mask:0xa
    v_add_f32_dpp v66, v53, v53 row_shr:4 row_mask:0xf bank_mask:0xa
    v_add_f32_dpp v67, v55, v55 row_shr:4 row_mask:0xf bank_mask:0xa
    v_add_f32_dpp v68, v57, v57 row_shr:4 row_mask:0xf bank_mask:0xa
    v_add_f32_dpp v69, v59, v59 row_shr:4 row_mask:0xf bank_mask:0xa
    v_add_f32_dpp v70, v61, v61 row_shr:4 row_mask:0xf bank_mask:0xa
    v_add_f32_dpp v71, v63, v63 row_shr:4 row_mask:0xf bank_mask:0xa
    v_add_f32_dpp v48, v64, v64 row_shl:8 row_mask:0xf bank_mask:0x3
    v_add_f32_dpp v49, v66, v66 row_shl:8 row_mask:0xf bank_mask:0x3
    v_add_f32_dpp v50, v68, v68 row_shl:8 row_mask:0xf bank_mask:0x3
    s_add_u32 m0, s45, 2048
    s_mov_b32 s47, 1433600
    buffer_load_dwordx4 v9, s[8:11], s47 offen  lds
    v_add_f32_dpp v51, v70, v70 row_shl:8 row_mask:0xf bank_mask:0x3
    v_add_f32_dpp v48, v65, v65 row_shr:8 row_mask:0xf bank_mask:0xc
    v_add_f32_dpp v49, v67, v67 row_shr:8 row_mask:0xf bank_mask:0xc
    v_add_f32_dpp v50, v69, v69 row_shr:8 row_mask:0xf bank_mask:0xc
    v_add_f32_dpp v51, v71, v71 row_shr:8 row_mask:0xf bank_mask:0xc
    v_permlane16_swap_b32 v48, v49
    s_nop 0
    v_permlane16_swap_b32 v50, v51
    v_add_f32 v64, v48, v49
    v_add_f32 v66, v50, v51
    s_nop 1
    v_permlane32_swap_b32 v64, v66
    v_add_f32 v64, v64, v66
    s_nop 1
    v_add_f32_dpp v64, v64, v64 quad_perm:[1,0,3,2] row_mask:0xf bank_mask:0xf
    s_nop 1
    v_add_f32_dpp v64, v64, v64 quad_perm:[2,3,0,1] row_mask:0xf bank_mask:0xf
    s_lshl_b32 s72, s50, 2
    s_add_u32 s72, s72, 135872
    v_lshrrev_b32 v5, 2, v1
    v_lshl_add_u32 v5, v5, 4, s72
    ds_write_b32 v5, v64
    v_and_b32 v5, 7, v1
    v_lshlrev_b32 v5, 4, v5
    v_add_u32 v5, 135872, v5
    s_waitcnt lgkmcnt(0)
    s_barrier
    ds_read_b128 v[48:51], v5
    buffer_load_dwordx4 v10, s[8:11], s47 offen offset:1024  lds
    ds_read_b128 v[52:55], v5 offset:128
    s_waitcnt lgkmcnt(0)
    v_add_f32 v48, v48, v49
    v_add_f32 v52, v52, v53
    v_add_f32 v50, v50, v51
    v_add_f32 v54, v54, v55
    v_add_f32 v48, v48, v50
    v_add_f32 v52, v52, v54
    v_mul_f32 v48, 0x3b124925, v48
    v_mul_f32 v52, 0x3b124925, v52
    v_fma_f32 v52, -v48, v48, v52
    v_max_f32 v52, 0, v52
    v_add_f32 v49, 0x3727c5ac, v52
    v_rsq_f32 v49, v49
    v_sub_f32 v48, 0, v48
    v_mov_b32 v51, 0x3727c5ac
    v_mul_f32 v50, v49, v49
    v_fma_f32 v50, v52, v50, v51
    v_rsq_f32 v50, v50
    v_readlane_b32 s84, v48, 0
    v_readlane_b32 s85, v48, 1
    v_readlane_b32 s86, v48, 2
    s_add_u32 m0, s45, 4096
    s_mov_b32 s47, 1490944
    buffer_load_dwordx4 v9, s[8:11], s47 offen  lds
    v_readlane_b32 s87, v48, 3
    v_readlane_b32 s88, v48, 4
    v_readlane_b32 s89, v48, 5
    v_readlane_b32 s90, v48, 6
    v_readlane_b32 s91, v48, 7
    v_mul_f32 v49, v49, v50
    v_pk_add_f32 v[32:33], v[32:33], s[84:85]
    v_pk_add_f32 v[34:35], v[34:35], s[86:87]
    v_pk_add_f32 v[36:37], v[36:37], s[88:89]
    v_pk_add_f32 v[38:39], v[38:39], s[90:91]
    v_pk_add_f32 v[40:41], v[40:41], s[84:85]
    v_pk_add_f32 v[42:43], v[42:43], s[86:87]
    v_pk_add_f32 v[44:45], v[44:45], s[88:89]
    v_pk_add_f32 v[46:47], v[46:47], s[90:91]
    v_readlane_b32 s92, v49, 0
    v_readlane_b32 s93, v49, 1
    v_readlane_b32 s94, v49, 2
    v_readlane_b32 s95, v49, 3
    v_readlane_b32 s96, v49, 4
    v_readlane_b32 s97, v49, 5
    v_readlane_b32 s98, v49, 6
    v_readlane_b32 s99, v49, 7
    buffer_load_dwordx4 v10, s[8:11], s47 offen offset:1024  lds
    v_pk_mul_f32 v[32:33], v[32:33], s[92:93]
    v_pk_mul_f32 v[34:35], v[34:35], s[94:95]
    v_pk_mul_f32 v[36:37], v[36:37], s[96:97]
    v_pk_mul_f32 v[38:39], v[38:39], s[98:99]
    v_cvt_pk_bf16_f32 v72, v32, v33
    v_cvt_pk_bf16_f32 v73, v34, v35
    v_cvt_pk_bf16_f32 v74, v36, v37
    v_cvt_pk_bf16_f32 v75, v38, v39
    buffer_store_dwordx4 v[72:75], v6, s[4:7], s75 offen sc1
    s_cmp_eq_u32 s50, 3
    s_cbranch_scc1 Ln_25
    v_pk_mul_f32 v[40:41], v[40:41], s[92:93]
    v_pk_mul_f32 v[42:43], v[42:43], s[94:95]
    v_pk_mul_f32 v[44:45], v[44:45], s[96:97]
    v_pk_mul_f32 v[46:47], v[46:47], s[98:99]
    v_cvt_pk_bf16_f32 v76, v40, v41
    v_cvt_pk_bf16_f32 v77, v42, v43
    v_cvt_pk_bf16_f32 v78, v44, v45
    v_cvt_pk_bf16_f32 v79, v46, v47
    buffer_store_dwordx4 v[76:79], v6, s[4:7], s76 offen sc1
Ln_25:
    s_add_u32 m0, s45, 6144
    s_mov_b32 s47, 1548288
    buffer_load_dwordx4 v9, s[8:11], s47 offen  lds
    buffer_load_dwordx4 v10, s[8:11], s47 offen offset:1024  lds
    s_add_u32 m0, s45, 8192
    s_mov_b32 s47, 1605632
    buffer_load_dwordx4 v9, s[8:11], s47 offen  lds
    buffer_load_dwordx4 v10, s[8:11], s47 offen offset:1024  lds
    s_add_u32 m0, s45, 10240
    s_mov_b32 s47, 1662976
    buffer_load_dwordx4 v9, s[8:11], s47 offen  lds
    buffer_load_dwordx4 v10, s[8:11], s47 offen offset:1024  lds
    s_add_u32 m0, s45, 12288
    s_mov_b32 s47, 1720320
    buffer_load_dwordx4 v9, s[8:11], s47 offen  lds
    buffer_load_dwordx4 v10, s[8:11], s47 offen offset:1024  lds
    s_add_u32 m0, s45, 14336
    s_mov_b32 s47, 1777664
    buffer_load_dwordx4 v9, s[8:11], s47 offen  lds
    buffer_load_dwordx4 v10, s[8:11], s47 offen offset:1024  lds
    s_add_u32 m0, s45, 16384
    s_mov_b32 s47, 0
    buffer_load_dwordx4 v13, s[12:15], s47 offen  lds
    buffer_load_dwordx4 v14, s[12:15], s47 offen offset:1024  lds
    s_add_u32 m0, s45, 18432
    s_mov_b32 s47, 65536
    buffer_load_dwordx4 v13, s[12:15], s47 offen  lds
    buffer_load_dwordx4 v14, s[12:15], s47 offen offset:1024  lds
    s_add_u32 m0, s45, 20480
    s_mov_b32 s47, 131072
    buffer_load_dwordx4 v13, s[12:15], s47 offen  lds
    buffer_load_dwordx4 v14, s[12:15], s47 offen offset:1024  lds
    s_add_u32 m0, s45, 22528
    s_mov_b32 s47, 196608
    buffer_load_dwordx4 v13, s[12:15], s47 offen  lds
    buffer_load_dwordx4 v14, s[12:15], s47 offen offset:1024  lds
    v_lshrrev_b32 v8, 5, v1
    v_lshlrev_b32 v8, 3, v8
    v_bfe_u32 v9, v1, 2, 2
    v_add_u32 v8, v8, v9
    v_lshlrev_b32 v8, 7, v8
    s_mul_i32 s78, s50, 24576
    v_add_u32 v8, s78, v8
    v_and_b32 v9, 1, v1
    v_lshlrev_b32 v9, 4, v9
    v_bfe_u32 v10, v1, 1, 1
    v_lshl_add_u32 v9, v10, 3, v9
    v_add_u32 v8, v8, v9
    v_bfe_u32 v9, v1, 4, 1
    v_add_u32 v9, s50, v9
    v_bfe_u32 v10, v1, 3, 1
    v_lshl_add_u32 v9, v10, 1, v9
    v_and_b32 v9, 3, v9
    v_lshl_add_u32 v6, v9, 5, v8
    v_xor_b32 v9, 2, v9
    v_lshl_add_u32 v7, v9, 5, v8
    s_add_u32 s76, s50, 1
    s_and_b32 s76, s76, 3
    s_mul_i32 s76, s76, 6144
    s_add_u32 s76, s76, 139264
    v_add_u32 v8, s76, v2
    s_add_u32 s76, s50, 2
    s_and_b32 s76, s76, 3
    s_mul_i32 s76, s76, 6144
    s_add_u32 s76, s76, 141312
    v_add_u32 v9, s76, v2
    s_add_u32 s76, s50, 3
    s_and_b32 s76, s76, 3
    s_mul_i32 s76, s76, 6144
    s_add_u32 s76, s76, 143360
    v_add_u32 v10, s76, v2
    s_mul_i32 s76, s50, 6144
    s_add_u32 s76, s76, 139264
    v_add_u32 v11, s76, v2
    s_cmp_eq_u32 s61, 0
    s_cbranch_scc1 Lm_26
    s_mov_b32 s71, 0
    s_mul_i32 s72, s63, 262144
    s_mul_i32 s73, s50, 32768
    s_add_u32 s72, s72, s73
    s_add_u32 s72, s72, s66
    s_add_u32 s72, s72, 6029312
    v_and_b32 v23, 0xffff0000, v19
    v_lshlrev_b32 v22, 16, v19
    v_and_b32 v21, 0xffff0000, v18
    v_lshlrev_b32 v20, 16, v18
    v_and_b32 v19, 0xffff0000, v17
    v_lshlrev_b32 v18, 16, v17
    v_and_b32 v17, 0xffff0000, v16
    v_lshlrev_b32 v16, 16, v16
    v_pk_mov_b32 v[48:49], v[16:17], v[16:17] op_sel:[0,1]
    v_pk_mov_b32 v[50:51], v[18:19], v[18:19] op_sel:[0,1]
    v_pk_mov_b32 v[52:53], v[20:21], v[20:21] op_sel:[0,1]
    v_pk_mov_b32 v[54:55], v[22:23], v[22:23] op_sel:[0,1]
    v_pk_mov_b32 v[24:25], 0, 0
    v_pk_mov_b32 v[26:27], 0, 0
    v_pk_mov_b32 v[28:29], 0, 0
    v_pk_mov_b32 v[30:31], 0, 0
    v_pk_mov_b32 v[56:57], 0, 0
    v_pk_mov_b32 v[58:59], 0, 0
    v_pk_mov_b32 v[60:61], 0, 0
    v_pk_mov_b32 v[62:63], 0, 0
    s_mov_b32 s80, 0xbdd2d3e8
    s_mov_b32 s81, 0xc0135761
    v_mov_b32 v4, s80
    s_mul_i32 s77, s63, 229376
    s_lshl_b32 s76, s62, 2
    s_add_u32 s76, s76, s50
    s_lshl_b32 s76, s76, 10
    s_add_u32 s77, s77, s76
    s_add_u32 s77, s77, s66
    s_add_u32 s77, s77, 7864320
    s_add_u32 s78, s77, 114688
    s_add_u32 s73, s72, 0
    buffer_load_dwordx4 v[80:83], v2, s[4:7], s73 offen offset:0 sc1
    buffer_load_dwordx4 v[84:87], v2, s[4:7], s73 offen offset:1024 sc1
    buffer_load_dwordx4 v[88:91], v2, s[4:7], s73 offen offset:2048 sc1
    buffer_load_dwordx4 v[92:95], v2, s[4:7], s73 offen offset:3072 sc1
    s_add_u32 s73, s72, 4096
    buffer_load_dwordx4 v[96:99], v2, s[4:7], s73 offen offset:0 sc1
    buffer_load_dwordx4 v[100:103], v2, s[4:7], s73 offen offset:1024 sc1
    buffer_load_dwordx4 v[104:107], v2, s[4:7], s73 offen offset:2048 sc1
    buffer_load_dwordx4 v[108:111], v2, s[4:7], s73 offen offset:3072 sc1
    s_add_u32 s73, s72, 8192
    buffer_load_dwordx4 v[112:115], v2, s[4:7], s73 offen offset:0 sc1
    buffer_load_dwordx4 v[116:119], v2, s[4:7], s73 offen offset:1024 sc1
    buffer_load_dwordx4 v[120:123], v2, s[4:7], s73 offen offset:2048 sc1
    buffer_load_dwordx4 v[124:127], v2, s[4:7], s73 offen offset:3072 sc1
    s_add_u32 s73, s72, 12288
    buffer_load_dwordx4 v[64:67], v2, s[4:7], s73 offen offset:0 sc1
    buffer_load_dwordx4 v[68:71], v2, s[4:7], s73 offen offset:1024 sc1
    buffer_load_dwordx4 v[72:75], v2, s[4:7], s73 offen offset:2048 sc1
    buffer_load_dwordx4 v[76:79], v2, s[4:7], s73 offen offset:3072 sc1
    s_waitcnt vmcnt(12)
    v_max3_u32 v5, v80, v84, v88
    v_max_u32 v5, v5, v92
    v_cmp_eq_u32 vcc, -1, v5
    s_cbranch_vccnz Ls_28
Lq_27:
    v_mfma_f32_32x32x16_bf16 v[16:31], a[0:3], v[80:83], v[16:31]
    v_mfma_f32_32x32x16_bf16 v[32:47], a[4:7], v[80:83], 0
    s_add_u32 s73, s72, 16384
    buffer_load_dwordx4 v[80:83], v2, s[4:7], s73 offen offset:0 sc1
    v_mfma_f32_32x32x16_bf16 v[16:31], a[8:11], v[84:87], v[16:31]
    ds_read_b64_tr_b16 a[192:193], v6 offset:0
    v_mfma_f32_32x32x16_bf16 v[32:47], a[12:15], v[84:87], v[32:47]
    ds_read_b64_tr_b16 a[194:195], v6 offset:512
    buffer_load_dwordx4 v[84:87], v2, s[4:7], s73 offen offset:1024 sc1
    v_mfma_f32_32x32x16_bf16 v[16:31], a[16:19], v[88:91], v[16:31]
    ds_read_b64_tr_b16 a[196:197], v7 offset:0
    v_mfma_f32_32x32x16_bf16 v[32:47], a[20:23], v[88:91], v[32:47]
    ds_read_b64_tr_b16 a[198:199], v7 offset:512
    buffer_load_dwordx4 v[88:91], v2, s[4:7], s73 offen offset:2048 sc1
    s_waitcnt vmcnt(11)
    v_max3_u32 v5, v96, v100, v104
    v_max_u32 v5, v5, v108
    v_cmp_eq_u32 vcc, -1, v5
    v_mfma_f32_32x32x16_bf16 v[16:31], a[24:27], v[92:95], v[16:31]
    ds_read_b64_tr_b16 a[200:201], v6 offset:2048
    v_mfma_f32_32x32x16_bf16 v[32:47], a[28:31], v[92:95], v[32:47]
    ds_read_b64_tr_b16 a[202:203], v6 offset:2560
    buffer_load_dwordx4 v[92:95], v2, s[4:7], s73 offen offset:3072 sc1
    s_cbranch_vccnz Ls_30
Lq_29:
    v_mfma_f32_32x32x16_bf16 v[16:31], a[32:35], v[96:99], v[16:31]
    ds_read_b64_tr_b16 a[204:205], v7 offset:2048
    v_mfma_f32_32x32x16_bf16 v[32:47], a[36:39], v[96:99], v[32:47]
    ds_read_b64_tr_b16 a[206:207], v7 offset:2560
    s_add_u32 s73, s72, 20480
    buffer_load_dwordx4 v[96:99], v2, s[4:7], s73 offen offset:0 sc1
    v_mfma_f32_32x32x16_bf16 v[16:31], a[40:43], v[100:103], v[16:31]
    ds_read_b64_tr_b16 a[208:209], v6 offset:4096
    v_mfma_f32_32x32x16_bf16 v[32:47], a[44:47], v[100:103], v[32:47]
    ds_read_b64_tr_b16 a[210:211], v6 offset:4608
    buffer_load_dwordx4 v[100:103], v2, s[4:7], s73 offen offset:1024 sc1
    v_mfma_f32_32x32x16_bf16 v[16:31], a[48:51], v[104:107], v[16:31]
    ds_read_b64_tr_b16 a[212:213], v7 offset:4096
    v_mfma_f32_32x32x16_bf16 v[32:47], a[52:55], v[104:107], v[32:47]
    ds_read_b64_tr_b16 a[214:215], v7 offset:4608
    buffer_load_dwordx4 v[104:107], v2, s[4:7], s73 offen offset:2048 sc1
    s_waitcnt vmcnt(11)
    v_max3_u32 v5, v112, v116, v120
    v_max_u32 v5, v5, v124
    v_cmp_eq_u32 vcc, -1, v5
    v_mfma_f32_32x32x16_bf16 v[16:31], a[56:59], v[108:111], v[16:31]
    ds_read_b64_tr_b16 a[216:217], v6 offset:6144
    v_mfma_f32_32x32x16_bf16 v[32:47], a[60:63], v[108:111], v[32:47]
    ds_read_b64_tr_b16 a[218:219], v6 offset:6656
    buffer_load_dwordx4 v[108:111], v2, s[4:7], s73 offen offset:3072 sc1
    s_cbranch_vccnz Ls_32
Lq_31:
    v_mfma_f32_32x32x16_bf16 v[16:31], a[64:67], v[112:115], v[16:31]
    ds_read_b64_tr_b16 a[220:221], v7 offset:6144
    v_mfma_f32_32x32x16_bf16 v[32:47], a[68:71], v[112:115], v[32:47]
    ds_read_b64_tr_b16 a[222:223], v7 offset:6656
    s_add_u32 s73, s72, 24576
    buffer_load_dwordx4 v[112:115], v2, s[4:7], s73 offen offset:0 sc1
    v_mfma_f32_32x32x16_bf16 v[16:31], a[72:75], v[116:119], v[16:31]
    ds_read_b64_tr_b16 a[224:225], v6 offset:8192
    v_mfma_f32_32x32x16_bf16 v[32:47], a[76:79], v[116:119], v[32:47]
    ds_read_b64_tr_b16 a[226:227], v6 offset:8704
    buffer_load_dwordx4 v[116:119], v2, s[4:7], s73 offen offset:1024 sc1
    v_mfma_f32_32x32x16_bf16 v[16:31], a[80:83], v[120:123], v[16:31]
    ds_read_b64_tr_b16 a[228:229], v7 offset:8192
    v_mfma_f32_32x32x16_bf16 v[32:47], a[84:87], v[120:123], v[32:47]
    ds_read_b64_tr_b16 a[230:231], v7 offset:8704
    buffer_load_dwordx4 v[120:123], v2, s[4:7], s73 offen offset:2048 sc1
    s_waitcnt vmcnt(11)
    v_max3_u32 v5, v64, v68, v72
    v_max_u32 v5, v5, v76
    v_cmp_eq_u32 vcc, -1, v5
    v_mfma_f32_32x32x16_bf16 v[16:31], a[88:91], v[124:127], v[16:31]
    ds_read_b64_tr_b16 a[232:233], v6 offset:10240
    v_mfma_f32_32x32x16_bf16 v[32:47], a[92:95], v[124:127], v[32:47]
    ds_read_b64_tr_b16 a[234:235], v6 offset:10752
    buffer_load_dwordx4 v[124:127], v2, s[4:7], s73 offen offset:3072 sc1
    s_cbranch_vccnz Ls_34
Lq_33:
    v_mfma_f32_32x32x16_bf16 v[16:31], a[96:99], v[64:67], v[16:31]
    ds_read_b64_tr_b16 a[236:237], v7 offset:10240
    v_mfma_f32_32x32x16_bf16 v[32:47], a[100:103], v[64:67], v[32:47]
    ds_read_b64_tr_b16 a[238:239], v7 offset:10752
    s_add_u32 s73, s72, 28672
    buffer_load_dwordx4 v[64:67], v2, s[4:7], s73 offen offset:0 sc1
    v_mfma_f32_32x32x16_bf16 v[16:31], a[104:107], v[68:71], v[16:31]
    ds_read_b64_tr_b16 a[240:241], v6 offset:12288
    v_mfma_f32_32x32x16_bf16 v[32:47], a[108:111], v[68:71], v[32:47]
    ds_read_b64_tr_b16 a[242:243], v6 offset:12800
    buffer_load_dwordx4 v[68:71], v2, s[4:7], s73 offen offset:1024 sc1
    v_mfma_f32_32x32x16_bf16 v[16:31], a[112:115], v[72:75], v[16:31]
    ds_read_b64_tr_b16 a[244:245], v7 offset:12288
    v_mfma_f32_32x32x16_bf16 v[32:47], a[116:119], v[72:75], v[32:47]
    ds_read_b64_tr_b16 a[246:247], v7 offset:12800
    buffer_load_dwordx4 v[72:75], v2, s[4:7], s73 offen offset:2048 sc1
    s_waitcnt vmcnt(11)
    v_max3_u32 v5, v80, v84, v88
    v_max_u32 v5, v5, v92
    v_cmp_eq_u32 vcc, -1, v5
    v_mfma_f32_32x32x16_bf16 v[16:31], a[120:123], v[76:79], v[16:31]
    ds_read_b64_tr_b16 a[248:249], v6 offset:14336
    v_mfma_f32_32x32x16_bf16 v[32:47], a[124:127], v[76:79], v[32:47]
    ds_read_b64_tr_b16 a[250:251], v6 offset:14848
    buffer_load_dwordx4 v[76:79], v2, s[4:7], s73 offen offset:3072 sc1
    s_cbranch_vccnz Ls_36
Lq_35:
    v_mfma_f32_32x32x16_bf16 v[16:31], a[128:131], v[80:83], v[16:31]
    ds_read_b64_tr_b16 a[252:253], v7 offset:14336
    v_mfma_f32_32x32x16_bf16 v[32:47], a[132:135], v[80:83], v[32:47]
    ds_read_b64_tr_b16 a[254:255], v7 offset:14848
    s_add_u32 s73, s72, 131072
    buffer_load_dwordx4 v[80:83], v2, s[4:7], s73 offen offset:0 sc1
    v_mfma_f32_32x32x16_bf16 v[16:31], a[136:139], v[84:87], v[16:31]
    ds_read_b64_tr_b16 v[128:129], v6 offset:16384
    v_mfma_f32_32x32x16_bf16 v[32:47], a[140:143], v[84:87], v[32:47]
    ds_read_b64_tr_b16 v[130:131], v6 offset:16896
    buffer_load_dwordx4 v[84:87], v2, s[4:7], s73 offen offset:1024 sc1
    v_mfma_f32_32x32x16_bf16 v[16:31], a[144:147], v[88:91], v[16:31]
    ds_read_b64_tr_b16 v[132:133], v7 offset:16384
    v_mfma_f32_32x32x16_bf16 v[32:47], a[148:151], v[88:91], v[32:47]
    ds_read_b64_tr_b16 v[134:135], v7 offset:16896
    buffer_load_dwordx4 v[88:91], v2, s[4:7], s73 offen offset:2048 sc1
    s_waitcnt vmcnt(11)
    v_max3_u32 v5, v96, v100, v104
    v_max_u32 v5, v5, v108
    v_cmp_eq_u32 vcc, -1, v5
    v_mfma_f32_32x32x16_bf16 v[16:31], a[152:155], v[92:95], v[16:31]
    ds_read_b64_tr_b16 v[136:137], v6 offset:18432
    v_mfma_f32_32x32x16_bf16 v[32:47], a[156:159], v[92:95], v[32:47]
    ds_read_b64_tr_b16 v[138:139], v6 offset:18944
    buffer_load_dwordx4 v[92:95], v2, s[4:7], s73 offen offset:3072 sc1
    s_cbranch_vccnz Ls_38
Lq_37:
    v_mfma_f32_32x32x16_bf16 v[16:31], a[160:163], v[96:99], v[16:31]
    ds_read_b64_tr_b16 v[140:141], v7 offset:18432
    v_mfma_f32_32x32x16_bf16 v[32:47], a[164:167], v[96:99], v[32:47]
    ds_read_b64_tr_b16 v[142:143], v7 offset:18944
    s_add_u32 s73, s72, 135168
    buffer_load_dwordx4 v[96:99], v2, s[4:7], s73 offen offset:0 sc1
    v_mfma_f32_32x32x16_bf16 v[16:31], a[168:171], v[100:103], v[16:31]
    ds_read_b64_tr_b16 v[144:145], v6 offset:20480
    v_mfma_f32_32x32x16_bf16 v[32:47], a[172:175], v[100:103], v[32:47]
    ds_read_b64_tr_b16 v[146:147], v6 offset:20992
    buffer_load_dwordx4 v[100:103], v2, s[4:7], s73 offen offset:1024 sc1
    v_mfma_f32_32x32x16_bf16 v[16:31], a[176:179], v[104:107], v[16:31]
    ds_read_b64_tr_b16 v[148:149], v7 offset:20480
    v_mfma_f32_32x32x16_bf16 v[32:47], a[180:183], v[104:107], v[32:47]
    ds_read_b64_tr_b16 v[150:151], v7 offset:20992
    buffer_load_dwordx4 v[104:107], v2, s[4:7], s73 offen offset:2048 sc1
    s_waitcnt vmcnt(11)
    v_max3_u32 v5, v112, v116, v120
    v_max_u32 v5, v5, v124
    v_cmp_eq_u32 vcc, -1, v5
    v_mfma_f32_32x32x16_bf16 v[16:31], a[184:187], v[108:111], v[16:31]
    ds_read_b64_tr_b16 v[152:153], v6 offset:22528
    v_mfma_f32_32x32x16_bf16 v[32:47], a[188:191], v[108:111], v[32:47]
    ds_read_b64_tr_b16 v[154:155], v6 offset:23040
    buffer_load_dwordx4 v[108:111], v2, s[4:7], s73 offen offset:3072 sc1
    s_cbranch_vccnz Ls_40
Lq_39:
    s_waitcnt lgkmcnt(14)
    v_mfma_f32_32x32x16_bf16 v[16:31], a[192:195], v[112:115], v[16:31]
    ds_read_b64_tr_b16 v[156:157], v7 offset:22528
    v_mfma_f32_32x32x16_bf16 v[32:47], a[196:199], v[112:115], v[32:47]
    ds_read_b64_tr_b16 v[158:159], v7 offset:23040
    s_add_u32 s73, s72, 139264
    buffer_load_dwordx4 v[112:115], v2, s[4:7], s73 offen offset:0 sc1
    v_mfma_f32_32x32x16_bf16 v[16:31], a[200:203], v[116:119], v[16:31]
    v_mfma_f32_32x32x16_bf16 v[32:47], a[204:207], v[116:119], v[32:47]
    buffer_load_dwordx4 v[116:119], v2, s[4:7], s73 offen offset:1024 sc1
    v_mfma_f32_32x32x16_bf16 v[16:31], a[208:211], v[120:123], v[16:31]
    v_mfma_f32_32x32x16_bf16 v[32:47], a[212:215], v[120:123], v[32:47]
    buffer_load_dwordx4 v[120:123], v2, s[4:7], s73 offen offset:2048 sc1
    s_waitcnt vmcnt(11)
    v_max3_u32 v5, v64, v68, v72
    v_max_u32 v5, v5, v76
    v_cmp_eq_u32 vcc, -1, v5
    v_mfma_f32_32x32x16_bf16 v[16:31], a[216:219], v[124:127], v[16:31]
    v_mfma_f32_32x32x16_bf16 v[32:47], a[220:223], v[124:127], v[32:47]
    buffer_load_dwordx4 v[124:127], v2, s[4:7], s73 offen offset:3072 sc1
    s_cbranch_vccnz Ls_42
Lq_41:
    v_mfma_f32_32x32x16_bf16 v[16:31], a[224:227], v[64:67], v[16:31]
    v_mfma_f32_32x32x16_bf16 v[32:47], a[228:231], v[64:67], v[32:47]
    v_mfma_f32_32x32x16_bf16 v[16:31], a[232:235], v[68:71], v[16:31]
    v_mfma_f32_32x32x16_bf16 v[32:47], a[236:239], v[68:71], v[32:47]
    v_mfma_f32_32x32x16_bf16 v[16:31], a[240:243], v[72:75], v[16:31]
    v_mfma_f32_32x32x16_bf16 v[32:47], a[244:247], v[72:75], v[32:47]
    s_waitcnt vmcnt(8)
    v_max3_u32 v5, v80, v84, v88
    v_max_u32 v5, v5, v92
    v_cmp_eq_u32 vcc, -1, v5
    v_mfma_f32_32x32x16_bf16 v[16:31], a[248:251], v[76:79], v[16:31]
    v_mfma_f32_32x32x16_bf16 v[32:47], a[252:255], v[76:79], v[32:47]
    s_cbranch_vccnz Ls_44
Lq_43:
    v_mfma_f32_32x32x16_bf16 v[48:63], a[0:3], v[80:83], v[48:63]
    v_mfma_f32_32x32x16_bf16 v[64:79], a[4:7], v[80:83], 0
    s_add_u32 s73, s72, 143360
    buffer_load_dwordx4 v[80:83], v2, s[4:7], s73 offen offset:0 sc1
    v_mfma_f32_32x32x16_bf16 v[48:63], a[8:11], v[84:87], v[48:63]
    s_nop 4
    ds_write_b128 v8, v[24:27] offset:0
    v_mfma_f32_32x32x16_bf16 v[64:79], a[12:15], v[84:87], v[64:79]
    ds_write_b128 v8, v[28:31] offset:1024
    buffer_load_dwordx4 v[84:87], v2, s[4:7], s73 offen offset:1024 sc1
    v_mfma_f32_32x32x16_bf16 v[48:63], a[16:19], v[88:91], v[48:63]
    ds_write_b128 v9, v[32:35] offset:0
    v_mfma_f32_32x32x16_bf16 v[64:79], a[20:23], v[88:91], v[64:79]
    ds_write_b128 v9, v[36:39] offset:1024
    s_waitcnt lgkmcnt(0)
    s_mul_i32 s45, s50, 24576
    s_add_u32 m0, s45, 0
    s_mov_b32 s47, 262144
    buffer_load_dwordx4 v13, s[12:15], s47 offen  lds
    buffer_load_dwordx4 v[88:91], v2, s[4:7], s73 offen offset:2048 sc1
    s_waitcnt vmcnt(8)
    v_max3_u32 v5, v96, v100, v104
    v_max_u32 v5, v5, v108
    v_cmp_eq_u32 vcc, -1, v5
    v_mfma_f32_32x32x16_bf16 v[48:63], a[24:27], v[92:95], v[48:63]
    ds_write_b128 v10, v[40:43] offset:0
    v_mfma_f32_32x32x16_bf16 v[64:79], a[28:31], v[92:95], v[64:79]
    ds_write_b128 v10, v[44:47] offset:1024
    buffer_load_dwordx4 v14, s[12:15], s47 offen offset:1024  lds
    buffer_load_dwordx4 v[92:95], v2, s[4:7], s73 offen offset:3072 sc1
    s_cbranch_vccnz Ls_46
Lq_45:
    v_mfma_f32_32x32x16_bf16 v[48:63], a[32:35], v[96:99], v[48:63]
    v_mfma_f32_32x32x16_bf16 v[64:79], a[36:39], v[96:99], v[64:79]
    s_add_u32 m0, s45, 2048
    s_mov_b32 s47, 393216
    buffer_load_dwordx4 v13, s[12:15], s47 offen  lds
    s_add_u32 s73, s72, 147456
    buffer_load_dwordx4 v[96:99], v2, s[4:7], s73 offen offset:0 sc1
    v_mfma_f32_32x32x16_bf16 v[48:63], a[40:43], v[100:103], v[48:63]
    v_mfma_f32_32x32x16_bf16 v[64:79], a[44:47], v[100:103], v[64:79]
    buffer_load_dwordx4 v14, s[12:15], s47 offen offset:1024  lds
    buffer_load_dwordx4 v[100:103], v2, s[4:7], s73 offen offset:1024 sc1
    v_mfma_f32_32x32x16_bf16 v[48:63], a[48:51], v[104:107], v[48:63]
    v_mfma_f32_32x32x16_bf16 v[64:79], a[52:55], v[104:107], v[64:79]
    s_add_u32 m0, s45, 4096
    s_mov_b32 s47, 524288
    buffer_load_dwordx4 v13, s[12:15], s47 offen  lds
    buffer_load_dwordx4 v[104:107], v2, s[4:7], s73 offen offset:2048 sc1
    s_waitcnt lgkmcnt(0)
    s_barrier
    buffer_load_dwordx4 v[32:35], v2, s[4:7], s73 offen offset:3072 sc1
    s_add_u32 s73, s72, 151552
    buffer_load_dwordx4 v[36:39], v2, s[4:7], s73 offen offset:0 sc1
    buffer_load_dwordx4 v[40:43], v2, s[4:7], s73 offen offset:1024 sc1
    buffer_load_dwordx4 v[44:47], v2, s[4:7], s73 offen offset:2048 sc1
    s_waitcnt vmcnt(16)
    v_max3_u32 v5, v112, v116, v120
    v_max_u32 v5, v5, v124
    v_cmp_eq_u32 vcc, -1, v5
    v_mfma_f32_32x32x16_bf16 v[48:63], a[56:59], v[108:111], v[48:63]
    ds_read_b128 v[24:27], v11 offset:0
    ds_read_b128 v[28:31], v11 offset:1024
    v_mfma_f32_32x32x16_bf16 v[64:79], a[60:63], v[108:111], v[64:79]
    buffer_load_dwordx4 v14, s[12:15], s47 offen offset:1024  lds
    buffer_load_dwordx4 v[108:111], v2, s[4:7], s73 offen offset:3072 sc1
    s_cbranch_vccnz Ls_48
Lq_47:
    v_mfma_f32_32x32x16_bf16 v[48:63], a[64:67], v[112:115], v[48:63]
    v_mfma_f32_32x32x16_bf16 v[64:79], a[68:71], v[112:115], v[64:79]
    s_waitcnt lgkmcnt(0)
    v_add_f32 v16, v16, v24
    v_add_f32 v17, v17, v25
    s_add_u32 m0, s45, 6144
    s_mov_b32 s47, 655360
    buffer_load_dwordx4 v13, s[12:15], s47 offen  lds
    s_add_u32 s73, s72, 155648
    buffer_load_dwordx4 v[112:115], v2, s[4:7], s73 offen offset:0 sc1
    v_mfma_f32_32x32x16_bf16 v[48:63], a[72:75], v[116:119], v[48:63]
    v_add_f32 v18, v18, v26
    v_add_f32 v19, v19, v27
    v_add_f32 v20, v20, v28
    v_mfma_f32_32x32x16_bf16 v[64:79], a[76:79], v[116:119], v[64:79]
    v_add_f32 v21, v21, v29
    v_add_f32 v22, v22, v30
    buffer_load_dwordx4 v14, s[12:15], s47 offen offset:1024  lds
    buffer_load_dwordx4 v[116:119], v2, s[4:7], s73 offen offset:1024 sc1
    v_mfma_f32_32x32x16_bf16 v[48:63], a[80:83], v[120:123], v[48:63]
    v_add_f32 v23, v23, v31
    ds_read_b128 v[24:27], v11 offset:2048
    ds_read_b128 v[28:31], v11 offset:3072
    v_mfma_f32_32x32x16_bf16 v[64:79], a[84:87], v[120:123], v[64:79]
    s_add_u32 m0, s45, 8192
    s_mov_b32 s47, 786432
    buffer_load_dwordx4 v13, s[12:15], s47 offen  lds
    buffer_load_dwordx4 v[120:123], v2, s[4:7], s73 offen offset:2048 sc1
    s_waitcnt vmcnt(18)
    v_max3_u32 v5, v80, v84, v88
    v_max_u32 v5, v5, v92
    v_cmp_eq_u32 vcc, -1, v5
    v_mfma_f32_32x32x16_bf16 v[48:63], a[88:91], v[124:127], v[48:63]
    v_mfma_f32_32x32x16_bf16 v[64:79], a[92:95], v[124:127], v[64:79]
    buffer_load_dwordx4 v14, s[12:15], s47 offen offset:1024  lds
    buffer_load_dwordx4 v[124:127], v2, s[4:7], s73 offen offset:3072 sc1
    s_cbranch_vccnz Ls_50
Lq_49:
    v_mfma_f32_32x32x16_bf16 v[48:63], a[96:99], v[80:83], v[48:63]
    s_waitcnt lgkmcnt(0)
    v_add_f32 v16, v16, v24
    v_add_f32 v17, v17, v25
    v_add_f32 v18, v18, v26
    v_mfma_f32_32x32x16_bf16 v[64:79], a[100:103], v[80:83], v[64:79]
    v_add_f32 v19, v19, v27
    v_add_f32 v20, v20, v28
    s_add_u32 m0, s45, 10240
    s_mov_b32 s47, 917504
    buffer_load_dwordx4 v13, s[12:15], s47 offen  lds
    s_add_u32 s73, s72, 159744
    buffer_load_dwordx4 v[80:83], v2, s[4:7], s73 offen offset:0 sc1
    v_mfma_f32_32x32x16_bf16 v[48:63], a[104:107], v[84:87], v[48:63]
    v_add_f32 v21, v21, v29
    v_add_f32 v22, v22, v30
    v_add_f32 v23, v23, v31
    v_mfma_f32_32x32x16_bf16 v[64:79], a[108:111], v[84:87], v[64:79]
    ds_read_b128 v[24:27], v11 offset:4096
    ds_read_b128 v[28:31], v11 offset:5120
    buffer_load_dwordx4 v14, s[12:15], s47 offen offset:1024  lds
    buffer_load_dwordx4 v[84:87], v2, s[4:7], s73 offen offset:1024 sc1
    v_mfma_f32_32x32x16_bf16 v[48:63], a[112:115], v[88:91], v[48:63]
    v_mfma_f32_32x32x16_bf16 v[64:79], a[116:119], v[88:91], v[64:79]
    s_add_u32 m0, s45, 12288
    s_mov_b32 s47, 1048576
    buffer_load_dwordx4 v13, s[12:15], s47 offen  lds
    buffer_load_dwordx4 v[88:91], v2, s[4:7], s73 offen offset:2048 sc1
    s_waitcnt vmcnt(19)
    v_max3_u32 v5, v96, v100, v104
    v_max_u32 v5, v5, v32
    v_cmp_eq_u32 vcc, -1, v5
    v_mfma_f32_32x32x16_bf16 v[48:63], a[120:123], v[92:95], v[48:63]
    v_mfma_f32_32x32x16_bf16 v[64:79], a[124:127], v[92:95], v[64:79]
    s_waitcnt lgkmcnt(0)
    v_add_f32 v16, v16, v24
    v_add_f32 v17, v17, v25
    buffer_load_dwordx4 v14, s[12:15], s47 offen offset:1024  lds
    buffer_load_dwordx4 v[92:95], v2, s[4:7], s73 offen offset:3072 sc1
    s_cbranch_vccnz Ls_52
Lq_51:
    v_mfma_f32_32x32x16_bf16 v[48:63], a[128:131], v[96:99], v[48:63]
    v_add_f32 v18, v18, v26
    v_add_f32 v19, v19, v27
    v_add_f32 v20, v20, v28
    v_mfma_f32_32x32x16_bf16 v[64:79], a[132:135], v[96:99], v[64:79]
    v_add_f32 v21, v21, v29
    v_add_f32 v22, v22, v30
    s_add_u32 m0, s45, 14336
    s_mov_b32 s47, 1179648
    buffer_load_dwordx4 v13, s[12:15], s47 offen  lds
    v_mfma_f32_32x32x16_bf16 v[48:63], a[136:139], v[100:103], v[48:63]
    v_add_f32 v23, v23, v31
    v_mul_f32 v24, v16, v16
    v_mul_f32 v25, v17, v17
    v_mfma_f32_32x32x16_bf16 v[64:79], a[140:143], v[100:103], v[64:79]
    v_mul_f32 v26, v18, v18
    v_mul_f32 v27, v19, v19
    buffer_load_dwordx4 v14, s[12:15], s47 offen offset:1024  lds
    v_mfma_f32_32x32x16_bf16 v[48:63], a[144:147], v[104:107], v[48:63]
    v_mul_f32 v28, v20, v20
    v_mul_f32 v29, v21, v21
    v_mul_f32 v30, v22, v22
    v_mfma_f32_32x32x16_bf16 v[64:79], a[148:151], v[104:107], v[64:79]
    v_mul_f32 v31, v23, v23
    v_fma_f32 v24, v24, v4, s81
    s_add_u32 m0, s45, 16384
    s_mov_b32 s47, 1310720
    buffer_load_dwordx4 v13, s[12:15], s47 offen  lds
    s_waitcnt vmcnt(19)
    v_max3_u32 v5, v36, v40, v44
    v_max_u32 v5, v5, v108
    v_cmp_eq_u32 vcc, -1, v5
    v_mfma_f32_32x32x16_bf16 v[48:63], a[152:155], v[32:35], v[48:63]
    v_fma_f32 v25, v25, v4, s81
    v_fma_f32 v26, v26, v4, s81
    v_fma_f32 v27, v27, v4, s81
    v_mfma_f32_32x32x16_bf16 v[64:79], a[156:159], v[32:35], v[64:79]
    v_fma_f32 v28, v28, v4, s81
    v_fma_f32 v29, v29, v4, s81
    buffer_load_dwordx4 v14, s[12:15], s47 offen offset:1024  lds
    s_cbranch_vccnz Ls_54
Lq_53:
    v_mfma_f32_32x32x16_bf16 v[48:63], a[160:163], v[36:39], v[48:63]
    v_fma_f32 v30, v30, v4, s81
    v_fma_f32 v31, v31, v4, s81
    v_mul_f32 v24, v24, v16
    v_mfma_f32_32x32x16_bf16 v[64:79], a[164:167], v[36:39], v[64:79]
    v_mul_f32 v25, v25, v17
    v_mul_f32 v26, v26, v18
    s_add_u32 m0, s45, 18432
    s_mov_b32 s47, 1441792
    buffer_load_dwordx4 v13, s[12:15], s47 offen  lds
    v_mfma_f32_32x32x16_bf16 v[48:63], a[168:171], v[40:43], v[48:63]
    v_mul_f32 v27, v27, v19
    v_mul_f32 v28, v28, v20
    v_mul_f32 v29, v29, v21
    v_mfma_f32_32x32x16_bf16 v[64:79], a[172:175], v[40:43], v[64:79]
    v_mul_f32 v30, v30, v22
    v_mul_f32 v31, v31, v23
    buffer_load_dwordx4 v14, s[12:15], s47 offen offset:1024  lds
    v_mfma_f32_32x32x16_bf16 v[48:63], a[176:179], v[44:47], v[48:63]
    v_exp_f32 v24, v24
    v_mfma_f32_32x32x16_bf16 v[64:79], a[180:183], v[44:47], v[64:79]
    v_exp_f32 v25, v25
    s_add_u32 m0, s45, 20480
    s_mov_b32 s47, 1572864
    buffer_load_dwordx4 v13, s[12:15], s47 offen  lds
    s_waitcnt vmcnt(15)
    v_max3_u32 v5, v112, v116, v120
    v_max_u32 v5, v5, v124
    v_cmp_eq_u32 vcc, -1, v5
    v_mfma_f32_32x32x16_bf16 v[48:63], a[184:187], v[108:111], v[48:63]
    v_exp_f32 v26, v26
    v_mfma_f32_32x32x16_bf16 v[64:79], a[188:191], v[108:111], v[64:79]
    v_exp_f32 v27, v27
    buffer_load_dwordx4 v14, s[12:15], s47 offen offset:1024  lds
    v_lshrrev_b32 v12, 5, v1
    v_lshlrev_b32 v12, 4, v12
    s_lshl_b32 s84, s64, 7
    s_lshl_b32 s85, s50, 5
    s_add_u32 s84, s84, s85
    v_add_u32 v15, s84, v12
    global_load_dwordx4 v[96:99], v15, s[42:43]
    v_and_b32 v12, 31, v1
    v_lshl_add_u32 v15, v12, 12, v15
    s_lshl_b32 s84, s65, 18
    s_add_u32 s84, s84, s66
    s_add_u32 s84, s84, 4194304
    s_add_u32 s85, s84, 0x20000
    v_lshlrev_b32 v12, 7, v12
    s_mov_b32 s86, 81920
    buffer_load_dword v108, v12, s[4:7], s86 offen sc1
    buffer_load_dwordx4 v[100:103], v15, s[4:7], s84 offen sc1
    buffer_load_dwordx4 v[104:107], v15, s[4:7], s85 offen sc1
    s_cbranch_vccnz Ls_56
Lq_55:
    v_mfma_f32_32x32x16_bf16 v[48:63], a[192:195], v[112:115], v[48:63]
    v_exp_f32 v28, v28
    v_mfma_f32_32x32x16_bf16 v[64:79], a[196:199], v[112:115], v[64:79]
    v_exp_f32 v29, v29
    s_add_u32 m0, s45, 22528
    s_mov_b32 s47, 1703936
    buffer_load_dwordx4 v13, s[12:15], s47 offen  lds
    v_mfma_f32_32x32x16_bf16 v[48:63], a[200:203], v[116:119], v[48:63]
    v_exp_f32 v30, v30
    v_mfma_f32_32x32x16_bf16 v[64:79], a[204:207], v[116:119], v[64:79]
    v_exp_f32 v31, v31
    buffer_load_dwordx4 v14, s[12:15], s47 offen offset:1024  lds
    v_mfma_f32_32x32x16_bf16 v[48:63], a[208:211], v[120:123], v[48:63]
    v_add_f32 v24, 1.0, v24
    v_add_f32 v25, 1.0, v25
    v_add_f32 v26, 1.0, v26
    v_mfma_f32_32x32x16_bf16 v[64:79], a[212:215], v[120:123], v[64:79]
    v_add_f32 v27, 1.0, v27
    v_add_f32 v28, 1.0, v28
    s_waitcnt vmcnt(14)
    v_max3_u32 v5, v80, v84, v88
    v_max_u32 v5, v5, v92
    v_cmp_eq_u32 vcc, -1, v5
    v_mfma_f32_32x32x16_bf16 v[48:63], a[216:219], v[124:127], v[48:63]
    v_add_f32 v29, 1.0, v29
    v_add_f32 v30, 1.0, v30
    v_add_f32 v31, 1.0, v31
    v_mfma_f32_32x32x16_bf16 v[64:79], a[220:223], v[124:127], v[64:79]
    v_rcp_f32 v24, v24
    s_cbranch_vccnz Ls_58
Lq_57:
    v_rcp_f32 v25, v25
    v_rcp_f32 v26, v26
    v_rcp_f32 v27, v27
    v_rcp_f32 v28, v28
    v_rcp_f32 v29, v29
    v_rcp_f32 v30, v30
    v_rcp_f32 v31, v31
    v_mul_f32 v16, v16, v24
    v_mul_f32 v17, v17, v25
    v_mul_f32 v18, v18, v26
    v_mul_f32 v19, v19, v27
    v_mul_f32 v20, v20, v28
    v_mul_f32 v21, v21, v29
    v_mul_f32 v22, v22, v30
    v_mul_f32 v23, v23, v31
    v_cvt_pk_bf16_f32 v24, v16, v17
    v_cvt_pk_bf16_f32 v25, v18, v19
    v_cvt_pk_bf16_f32 v26, v20, v21
    v_cvt_pk_bf16_f32 v27, v22, v23
    buffer_store_dwordx4 v[24:27], v2, s[4:7], s77 offen sc1
    s_barrier
    v_mfma_f32_32x32x16_bf16 v[64:79], a[228:231], v[80:83], v[64:79]
    v_mfma_f32_32x32x16_bf16 v[64:79], a[236:239], v[84:87], v[64:79]
    v_mfma_f32_32x32x16_bf16 v[64:79], a[244:247], v[88:91], v[64:79]
    v_mfma_f32_32x32x16_bf16 v[64:79], a[252:255], v[92:95], v[64:79]
    v_mfma_f32_32x32x16_bf16 v[48:63], a[224:227], v[80:83], v[48:63]
    v_mfma_f32_32x32x16_bf16 v[48:63], a[232:235], v[84:87], v[48:63]
    v_mfma_f32_32x32x16_bf16 v[48:63], a[240:243], v[88:91], v[48:63]
    s_nop 8
    ds_write_b128 v9, v[64:67] offset:0
    ds_write_b128 v9, v[68:71] offset:1024
    v_mfma_f32_32x32x16_bf16 v[48:63], a[248:251], v[92:95], v[48:63]
    ds_write_b128 v10, v[72:75] offset:0
    ds_write_b128 v10, v[76:79] offset:1024
    s_nop 9
    ds_write_b128 v8, v[56:59] offset:0
    ds_write_b128 v8, v[60:63] offset:1024
    s_waitcnt lgkmcnt(0)
    s_barrier
    ds_read_b128 v[56:59], v11 offset:0
    ds_read_b128 v[60:63], v11 offset:1024
    ds_read_b128 v[64:67], v11 offset:2048
    ds_read_b128 v[68:71], v11 offset:3072
    ds_read_b128 v[72:75], v11 offset:4096
    ds_read_b128 v[76:79], v11 offset:5120
    s_waitcnt lgkmcnt(4)
    v_pk_add_f32 v[48:49], v[48:49], v[56:57]
    v_pk_add_f32 v[50:51], v[50:51], v[58:59]
    v_pk_add_f32 v[52:53], v[52:53], v[60:61]
    v_pk_add_f32 v[54:55], v[54:55], v[62:63]
    s_waitcnt lgkmcnt(2)
    v_pk_add_f32 v[48:49], v[48:49], v[64:65]
    v_pk_add_f32 v[50:51], v[50:51], v[66:67]
    v_pk_add_f32 v[52:53], v[52:53], v[68:69]
    v_pk_add_f32 v[54:55], v[54:55], v[70:71]
    s_waitcnt lgkmcnt(0)
    v_pk_add_f32 v[48:49], v[48:49], v[72:73]
    v_pk_add_f32 v[50:51], v[50:51], v[74:75]
    v_pk_add_f32 v[52:53], v[52:53], v[76:77]
    v_pk_add_f32 v[54:55], v[54:55], v[78:79]
    v_pk_mul_f32 v[56:57], v[48:49], v[48:49]
    v_pk_mul_f32 v[58:59], v[50:51], v[50:51]
    v_pk_mul_f32 v[60:61], v[52:53], v[52:53]
    v_pk_mul_f32 v[62:63], v[54:55], v[54:55]
    v_pk_fma_f32 v[56:57], v[56:57], s[80:81], s[80:81] op_sel:[0,0,1] op_sel_hi:[1,0,1]
    v_pk_fma_f32 v[58:59], v[58:59], s[80:81], s[80:81] op_sel:[0,0,1] op_sel_hi:[1,0,1]
    v_pk_fma_f32 v[60:61], v[60:61], s[80:81], s[80:81] op_sel:[0,0,1] op_sel_hi:[1,0,1]
    v_pk_fma_f32 v[62:63], v[62:63], s[80:81], s[80:81] op_sel:[0,0,1] op_sel_hi:[1,0,1]
    v_pk_mul_f32 v[56:57], v[56:57], v[48:49]
    v_pk_mul_f32 v[58:59], v[58:59], v[50:51]
    v_pk_mul_f32 v[60:61], v[60:61], v[52:53]
    v_pk_mul_f32 v[62:63], v[62:63], v[54:55]
    v_exp_f32 v56, v56
    v_exp_f32 v57, v57
    v_exp_f32 v58, v58
    v_exp_f32 v59, v59
    v_exp_f32 v60, v60
    v_exp_f32 v61, v61
    v_exp_f32 v62, v62
    v_exp_f32 v63, v63
    v_pk_add_f32 v[56:57], v[56:57], 1.0 op_sel_hi:[1,0]
    v_pk_add_f32 v[58:59], v[58:59], 1.0 op_sel_hi:[1,0]
    v_pk_add_f32 v[60:61], v[60:61], 1.0 op_sel_hi:[1,0]
    v_pk_add_f32 v[62:63], v[62:63], 1.0 op_sel_hi:[1,0]
    v_rcp_f32 v56, v56
    v_rcp_f32 v57, v57
    v_rcp_f32 v58, v58
    v_rcp_f32 v59, v59
    v_rcp_f32 v60, v60
    v_rcp_f32 v61, v61
    v_rcp_f32 v62, v62
    v_rcp_f32 v63, v63
    v_pk_mul_f32 v[48:49], v[48:49], v[56:57]
    v_pk_mul_f32 v[50:51], v[50:51], v[58:59]
    v_pk_mul_f32 v[52:53], v[52:53], v[60:61]
    v_pk_mul_f32 v[54:55], v[54:55], v[62:63]
    v_cvt_pk_bf16_f32 v56, v48, v49
    v_cvt_pk_bf16_f32 v57, v50, v51
    v_cvt_pk_bf16_f32 v58, v52, v53
    v_cvt_pk_bf16_f32 v59, v54, v55
    buffer_store_dwordx4 v[56:59], v2, s[4:7], s78 offen sc1
    s_waitcnt vmcnt(2)
    ds_read_b64_tr_b16 v[160:161], v6 offset:0
    ds_read_b64_tr_b16 v[162:163], v6 offset:512
    ds_read_b64_tr_b16 v[164:165], v7 offset:0
    ds_read_b64_tr_b16 v[166:167], v7 offset:512
    ds_read_b64_tr_b16 v[168:169], v6 offset:2048
    ds_read_b64_tr_b16 v[170:171], v6 offset:2560
    ds_read_b64_tr_b16 v[172:173], v7 offset:2048
    ds_read_b64_tr_b16 v[174:175], v7 offset:2560
    ds_read_b64_tr_b16 v[176:177], v6 offset:4096
    ds_read_b64_tr_b16 v[178:179], v6 offset:4608
    ds_read_b64_tr_b16 v[180:181], v7 offset:4096
    ds_read_b64_tr_b16 v[182:183], v7 offset:4608
    ds_read_b64_tr_b16 v[184:185], v6 offset:6144
    ds_read_b64_tr_b16 v[186:187], v6 offset:6656
    ds_read_b64_tr_b16 v[188:189], v7 offset:6144
    ds_read_b64_tr_b16 v[190:191], v7 offset:6656
    ds_read_b64_tr_b16 v[192:193], v6 offset:8192
    ds_read_b64_tr_b16 v[194:195], v6 offset:8704
    ds_read_b64_tr_b16 v[196:197], v7 offset:8192
    ds_read_b64_tr_b16 v[198:199], v7 offset:8704
    ds_read_b64_tr_b16 v[200:201], v6 offset:10240
    ds_read_b64_tr_b16 v[202:203], v6 offset:10752
    ds_read_b64_tr_b16 v[204:205], v7 offset:10240
    ds_read_b64_tr_b16 v[206:207], v7 offset:10752
    ds_read_b64_tr_b16 v[208:209], v6 offset:12288
    ds_read_b64_tr_b16 v[210:211], v6 offset:12800
    ds_read_b64_tr_b16 v[212:213], v7 offset:12288
    ds_read_b64_tr_b16 v[214:215], v7 offset:12800
    ds_read_b64_tr_b16 v[216:217], v6 offset:14336
    ds_read_b64_tr_b16 v[218:219], v6 offset:14848
    ds_read_b64_tr_b16 v[220:221], v7 offset:14336
    ds_read_b64_tr_b16 v[222:223], v7 offset:14848
    ds_read_b64_tr_b16 v[224:225], v6 offset:16384
    ds_read_b64_tr_b16 v[226:227], v6 offset:16896
    ds_read_b64_tr_b16 v[228:229], v7 offset:16384
    ds_read_b64_tr_b16 v[230:231], v7 offset:16896
    ds_read_b64_tr_b16 v[232:233], v6 offset:18432
    ds_read_b64_tr_b16 v[234:235], v6 offset:18944
    ds_read_b64_tr_b16 v[236:237], v7 offset:18432
    ds_read_b64_tr_b16 v[238:239], v7 offset:18944
    ds_read_b64_tr_b16 v[240:241], v6 offset:20480
    ds_read_b64_tr_b16 v[242:243], v6 offset:20992
    ds_read_b64_tr_b16 v[244:245], v7 offset:20480
    ds_read_b64_tr_b16 v[246:247], v7 offset:20992
    ds_read_b64_tr_b16 v[248:249], v6 offset:22528
    ds_read_b64_tr_b16 v[250:251], v6 offset:23040
    ds_read_b64_tr_b16 v[252:253], v7 offset:22528
    ds_read_b64_tr_b16 v[254:255], v7 offset:23040
    s_waitcnt lgkmcnt(0)
    s_mul_i32 s45, s50, 24576
    s_add_u32 m0, s45, 0
    s_mov_b32 s47, 327680
    buffer_load_dwordx4 v13, s[12:15], s47 offen  lds
    buffer_load_dwordx4 v14, s[12:15], s47 offen offset:1024  lds
    s_add_u32 m0, s45, 2048
    s_mov_b32 s47, 458752
    buffer_load_dwordx4 v13, s[12:15], s47 offen  lds
    buffer_load_dwordx4 v14, s[12:15], s47 offen offset:1024  lds
    s_add_u32 m0, s45, 4096
    s_mov_b32 s47, 589824
    buffer_load_dwordx4 v13, s[12:15], s47 offen  lds
    buffer_load_dwordx4 v14, s[12:15], s47 offen offset:1024  lds
    s_add_u32 m0, s45, 6144
    s_mov_b32 s47, 720896
    buffer_load_dwordx4 v13, s[12:15], s47 offen  lds
    buffer_load_dwordx4 v14, s[12:15], s47 offen offset:1024  lds
    s_branch L_g2
Lm_26:
    s_waitcnt vmcnt(0)
    ds_read_b64_tr_b16 a[192:193], v6 offset:0
    ds_read_b64_tr_b16 a[194:195], v6 offset:512
    ds_read_b64_tr_b16 a[196:197], v7 offset:0
    ds_read_b64_tr_b16 a[198:199], v7 offset:512
    ds_read_b64_tr_b16 a[200:201], v6 offset:2048
    ds_read_b64_tr_b16 a[202:203], v6 offset:2560
    ds_read_b64_tr_b16 a[204:205], v7 offset:2048
    ds_read_b64_tr_b16 a[206:207], v7 offset:2560
    ds_read_b64_tr_b16 a[208:209], v6 offset:4096
    ds_read_b64_tr_b16 a[210:211], v6 offset:4608
    ds_read_b64_tr_b16 a[212:213], v7 offset:4096
    ds_read_b64_tr_b16 a[214:215], v7 offset:4608
    ds_read_b64_tr_b16 a[216:217], v6 offset:6144
    ds_read_b64_tr_b16 a[218:219], v6 offset:6656
    ds_read_b64_tr_b16 a[220:221], v7 offset:6144
    ds_read_b64_tr_b16 a[222:223], v7 offset:6656
    ds_read_b64_tr_b16 a[224:225], v6 offset:8192
    ds_read_b64_tr_b16 a[226:227], v6 offset:8704
    ds_read_b64_tr_b16 a[228:229], v7 offset:8192
    ds_read_b64_tr_b16 a[230:231], v7 offset:8704
    ds_read_b64_tr_b16 a[232:233], v6 offset:10240
    ds_read_b64_tr_b16 a[234:235], v6 offset:10752
    ds_read_b64_tr_b16 a[236:237], v7 offset:10240
    ds_read_b64_tr_b16 a[238:239], v7 offset:10752
    ds_read_b64_tr_b16 a[240:241], v6 offset:12288
    ds_read_b64_tr_b16 a[242:243], v6 offset:12800
    ds_read_b64_tr_b16 a[244:245], v7 offset:12288
    ds_read_b64_tr_b16 a[246:247], v7 offset:12800
    ds_read_b64_tr_b16 a[248:249], v6 offset:14336
    ds_read_b64_tr_b16 a[250:251], v6 offset:14848
    ds_read_b64_tr_b16 a[252:253], v7 offset:14336
    ds_read_b64_tr_b16 a[254:255], v7 offset:14848
    ds_read_b64_tr_b16 v[128:129], v6 offset:16384
    ds_read_b64_tr_b16 v[130:131], v6 offset:16896
    ds_read_b64_tr_b16 v[132:133], v7 offset:16384
    ds_read_b64_tr_b16 v[134:135], v7 offset:16896
    ds_read_b64_tr_b16 v[136:137], v6 offset:18432
    ds_read_b64_tr_b16 v[138:139], v6 offset:18944
    ds_read_b64_tr_b16 v[140:141], v7 offset:18432
    ds_read_b64_tr_b16 v[142:143], v7 offset:18944
    ds_read_b64_tr_b16 v[144:145], v6 offset:20480
    ds_read_b64_tr_b16 v[146:147], v6 offset:20992
    ds_read_b64_tr_b16 v[148:149], v7 offset:20480
    ds_read_b64_tr_b16 v[150:151], v7 offset:20992
    ds_read_b64_tr_b16 v[152:153], v6 offset:22528
    ds_read_b64_tr_b16 v[154:155], v6 offset:23040
    ds_read_b64_tr_b16 v[156:157], v7 offset:22528
    ds_read_b64_tr_b16 v[158:159], v7 offset:23040
    s_waitcnt lgkmcnt(0)
    s_mul_i32 s45, s50, 24576
    s_add_u32 m0, s45, 0
    s_mov_b32 s47, 262144
    buffer_load_dwordx4 v13, s[12:15], s47 offen  lds
    buffer_load_dwordx4 v14, s[12:15], s47 offen offset:1024  lds
    s_add_u32 m0, s45, 2048
    s_mov_b32 s47, 393216
    buffer_load_dwordx4 v13, s[12:15], s47 offen  lds
    buffer_load_dwordx4 v14, s[12:15], s47 offen offset:1024  lds
    s_add_u32 m0, s45, 4096
    s_mov_b32 s47, 524288
    buffer_load_dwordx4 v13, s[12:15], s47 offen  lds
    buffer_load_dwordx4 v14, s[12:15], s47 offen offset:1024  lds
    s_add_u32 m0, s45, 6144
    s_mov_b32 s47, 655360
    buffer_load_dwordx4 v13, s[12:15], s47 offen  lds
    buffer_load_dwordx4 v14, s[12:15], s47 offen offset:1024  lds
    s_add_u32 m0, s45, 8192
    s_mov_b32 s47, 786432
    buffer_load_dwordx4 v13, s[12:15], s47 offen  lds
    buffer_load_dwordx4 v14, s[12:15], s47 offen offset:1024  lds
    s_add_u32 m0, s45, 10240
    s_mov_b32 s47, 917504
    buffer_load_dwordx4 v13, s[12:15], s47 offen  lds
    buffer_load_dwordx4 v14, s[12:15], s47 offen offset:1024  lds
    s_add_u32 m0, s45, 12288
    s_mov_b32 s47, 1048576
    buffer_load_dwordx4 v13, s[12:15], s47 offen  lds
    buffer_load_dwordx4 v14, s[12:15], s47 offen offset:1024  lds
    s_add_u32 m0, s45, 14336
    s_mov_b32 s47, 1179648
    buffer_load_dwordx4 v13, s[12:15], s47 offen  lds
    buffer_load_dwordx4 v14, s[12:15], s47 offen offset:1024  lds
    s_add_u32 m0, s45, 16384
    s_mov_b32 s47, 1310720
    buffer_load_dwordx4 v13, s[12:15], s47 offen  lds
    buffer_load_dwordx4 v14, s[12:15], s47 offen offset:1024  lds
    s_add_u32 m0, s45, 18432
    s_mov_b32 s47, 1441792
    buffer_load_dwordx4 v13, s[12:15], s47 offen  lds
    buffer_load_dwordx4 v14, s[12:15], s47 offen offset:1024  lds
    s_add_u32 m0, s45, 20480
    s_mov_b32 s47, 1572864
    buffer_load_dwordx4 v13, s[12:15], s47 offen  lds
    buffer_load_dwordx4 v14, s[12:15], s47 offen offset:1024  lds
    s_add_u32 m0, s45, 22528
    s_mov_b32 s47, 1703936
    buffer_load_dwordx4 v13, s[12:15], s47 offen  lds
    buffer_load_dwordx4 v14, s[12:15], s47 offen offset:1024  lds
    s_waitcnt vmcnt(20)
    ds_read_b64_tr_b16 v[160:161], v6 offset:0
    ds_read_b64_tr_b16 v[162:163], v6 offset:512
    ds_read_b64_tr_b16 v[164:165], v7 offset:0
    ds_read_b64_tr_b16 v[166:167], v7 offset:512
    ds_read_b64_tr_b16 v[168:169], v6 offset:2048
    ds_read_b64_tr_b16 v[170:171], v6 offset:2560
    ds_read_b64_tr_b16 v[172:173], v7 offset:2048
    ds_read_b64_tr_b16 v[174:175], v7 offset:2560
    s_waitcnt vmcnt(16)
    ds_read_b64_tr_b16 v[176:177], v6 offset:4096
    ds_read_b64_tr_b16 v[178:179], v6 offset:4608
    ds_read_b64_tr_b16 v[180:181], v7 offset:4096
    ds_read_b64_tr_b16 v[182:183], v7 offset:4608
    ds_read_b64_tr_b16 v[184:185], v6 offset:6144
    ds_read_b64_tr_b16 v[186:187], v6 offset:6656
    ds_read_b64_tr_b16 v[188:189], v7 offset:6144
    ds_read_b64_tr_b16 v[190:191], v7 offset:6656
    s_waitcnt vmcnt(12)
    ds_read_b64_tr_b16 v[192:193], v6 offset:8192
    ds_read_b64_tr_b16 v[194:195], v6 offset:8704
    ds_read_b64_tr_b16 v[196:197], v7 offset:8192
    ds_read_b64_tr_b16 v[198:199], v7 offset:8704
    ds_read_b64_tr_b16 v[200:201], v6 offset:10240
    ds_read_b64_tr_b16 v[202:203], v6 offset:10752
    ds_read_b64_tr_b16 v[204:205], v7 offset:10240
    ds_read_b64_tr_b16 v[206:207], v7 offset:10752
    s_waitcnt vmcnt(8)
    ds_read_b64_tr_b16 v[208:209], v6 offset:12288
    ds_read_b64_tr_b16 v[210:211], v6 offset:12800
    ds_read_b64_tr_b16 v[212:213], v7 offset:12288
    ds_read_b64_tr_b16 v[214:215], v7 offset:12800
    ds_read_b64_tr_b16 v[216:217], v6 offset:14336
    ds_read_b64_tr_b16 v[218:219], v6 offset:14848
    ds_read_b64_tr_b16 v[220:221], v7 offset:14336
    ds_read_b64_tr_b16 v[222:223], v7 offset:14848
    s_waitcnt vmcnt(4)
    ds_read_b64_tr_b16 v[224:225], v6 offset:16384
    ds_read_b64_tr_b16 v[226:227], v6 offset:16896
    ds_read_b64_tr_b16 v[228:229], v7 offset:16384
    ds_read_b64_tr_b16 v[230:231], v7 offset:16896
    ds_read_b64_tr_b16 v[232:233], v6 offset:18432
    ds_read_b64_tr_b16 v[234:235], v6 offset:18944
    ds_read_b64_tr_b16 v[236:237], v7 offset:18432
    ds_read_b64_tr_b16 v[238:239], v7 offset:18944
    s_waitcnt vmcnt(0)
    ds_read_b64_tr_b16 v[240:241], v6 offset:20480
    ds_read_b64_tr_b16 v[242:243], v6 offset:20992
    ds_read_b64_tr_b16 v[244:245], v7 offset:20480
    ds_read_b64_tr_b16 v[246:247], v7 offset:20992
    ds_read_b64_tr_b16 v[248:249], v6 offset:22528
    ds_read_b64_tr_b16 v[250:251], v6 offset:23040
    ds_read_b64_tr_b16 v[252:253], v7 offset:22528
    ds_read_b64_tr_b16 v[254:255], v7 offset:23040
    s_waitcnt lgkmcnt(0)
    s_mul_i32 s45, s50, 24576
    s_add_u32 m0, s45, 0
    s_mov_b32 s47, 327680
    buffer_load_dwordx4 v13, s[12:15], s47 offen  lds
    buffer_load_dwordx4 v14, s[12:15], s47 offen offset:1024  lds
    s_add_u32 m0, s45, 2048
    s_mov_b32 s47, 458752
    buffer_load_dwordx4 v13, s[12:15], s47 offen  lds
    buffer_load_dwordx4 v14, s[12:15], s47 offen offset:1024  lds
    s_add_u32 m0, s45, 4096
    s_mov_b32 s47, 589824
    buffer_load_dwordx4 v13, s[12:15], s47 offen  lds
    buffer_load_dwordx4 v14, s[12:15], s47 offen offset:1024  lds
    s_add_u32 m0, s45, 6144
    s_mov_b32 s47, 720896
    buffer_load_dwordx4 v13, s[12:15], s47 offen  lds
    buffer_load_dwordx4 v14, s[12:15], s47 offen offset:1024  lds
    v_lshrrev_b32 v12, 5, v1
    v_lshlrev_b32 v12, 4, v12
    s_lshl_b32 s84, s64, 7
    s_lshl_b32 s85, s50, 5
    s_add_u32 s84, s84, s85
    v_add_u32 v15, s84, v12
    global_load_dwordx4 v[96:99], v15, s[42:43]
    v_and_b32 v12, 31, v1
    v_lshl_add_u32 v15, v12, 12, v15
    s_lshl_b32 s84, s65, 18
    s_add_u32 s84, s84, s66
    s_add_u32 s84, s84, 4194304
    s_add_u32 s85, s84, 0x20000
    v_lshlrev_b32 v12, 7, v12
    s_mov_b32 s86, 81920
    buffer_load_dword v108, v12, s[4:7], s86 offen sc1
    buffer_load_dwordx4 v[100:103], v15, s[4:7], s84 offen sc1
    buffer_load_dwordx4 v[104:107], v15, s[4:7], s85 offen sc1
    s_waitcnt vmcnt(0)
L_g2:
    s_mov_b32 s71, 0
    s_mul_i32 s72, s65, 229376
    s_mul_i32 s73, s50, 28672
    s_add_u32 s72, s72, s73
    s_add_u32 s72, s72, s66
    s_add_u32 s72, s72, 7864320
    s_cmp_eq_u32 s61, 1
    s_cbranch_scc1 Lw_60
    s_mov_b64 exec, 1
Lw_59:
    buffer_load_dword v5, v2, s[4:7], s72 offen offset:0 sc1
    s_waitcnt vmcnt(0)
    v_cmp_eq_u32 vcc, -1, v5
    s_cbranch_vccz Lr_61
    s_add_u32 s71, s71, 1
    s_cmp_gt_u32 s71, 32768
    s_cbranch_scc1 Lr_61
    s_sleep 8
    s_branch Lw_59
Lr_61:
    s_mov_b64 exec, -1
Lw_60:
    s_add_u32 s73, s72, 0
    buffer_load_dwordx4 v[80:83], v2, s[4:7], s73 offen offset:0 sc1
    buffer_load_dwordx4 v[84:87], v2, s[4:7], s73 offen offset:1024 sc1
    buffer_load_dwordx4 v[88:91], v2, s[4:7], s73 offen offset:2048 sc1
    buffer_load_dwordx4 v[92:95], v2, s[4:7], s73 offen offset:3072 sc1
    s_add_u32 s73, s72, 4096
    buffer_load_dwordx4 v[112:115], v2, s[4:7], s73 offen offset:0 sc1
    buffer_load_dwordx4 v[116:119], v2, s[4:7], s73 offen offset:1024 sc1
    buffer_load_dwordx4 v[120:123], v2, s[4:7], s73 offen offset:2048 sc1
    buffer_load_dwordx4 v[124:127], v2, s[4:7], s73 offen offset:3072 sc1
Lg_62:
    v_max_u32 v5, v100, v104
    v_cmp_eq_u32 vcc, -1, v5
    v_cmp_ne_u32 s[82:83], s56, v108
    s_nop 0
    s_or_b64 vcc, vcc, s[82:83]
    s_cbranch_vccz Lg_63
    s_add_u32 s71, s71, 1
    s_cmp_gt_u32 s71, 32768
    s_cbranch_scc1 Lg_63
    s_sleep 4
    buffer_load_dword v108, v12, s[4:7], s86 offen sc1
    buffer_load_dwordx4 v[100:103], v15, s[4:7], s84 offen sc1
    buffer_load_dwordx4 v[104:107], v15, s[4:7], s85 offen sc1
    s_waitcnt vmcnt(0)
    s_branch Lg_62
Lg_63:
    v_lshlrev_b32 v64, 16, v96
    v_and_b32 v65, 0xffff0000, v96
    v_lshlrev_b32 v16, 16, v100
    v_and_b32 v17, 0xffff0000, v100
    v_pk_add_f32 v[16:17], v[16:17], v[64:65]
    v_lshlrev_b32 v48, 16, v104
    v_and_b32 v49, 0xffff0000, v104
    v_pk_add_f32 v[48:49], v[48:49], v[64:65]
    v_lshlrev_b32 v66, 16, v97
    v_and_b32 v67, 0xffff0000, v97
    v_lshlrev_b32 v18, 16, v101
    v_and_b32 v19, 0xffff0000, v101
    v_pk_add_f32 v[18:19], v[18:19], v[66:67]
    v_lshlrev_b32 v50, 16, v105
    v_and_b32 v51, 0xffff0000, v105
    v_pk_add_f32 v[50:51], v[50:51], v[66:67]
    v_lshlrev_b32 v68, 16, v98
    v_and_b32 v69, 0xffff0000, v98
    v_lshlrev_b32 v20, 16, v102
    v_and_b32 v21, 0xffff0000, v102
    v_pk_add_f32 v[20:21], v[20:21], v[68:69]
    v_lshlrev_b32 v52, 16, v106
    v_and_b32 v53, 0xffff0000, v106
    v_pk_add_f32 v[52:53], v[52:53], v[68:69]
    v_lshlrev_b32 v70, 16, v99
    v_and_b32 v71, 0xffff0000, v99
    v_lshlrev_b32 v22, 16, v103
    v_and_b32 v23, 0xffff0000, v103
    v_pk_add_f32 v[22:23], v[22:23], v[70:71]
    v_lshlrev_b32 v54, 16, v107
    v_and_b32 v55, 0xffff0000, v107
    v_pk_add_f32 v[54:55], v[54:55], v[70:71]
    v_lshrrev_b32 v4, 5, v1
    v_lshlrev_b32 v4, 4, v4
    v_pk_mov_b32 v[24:25], 0, 0
    v_pk_mov_b32 v[26:27], 0, 0
    v_pk_mov_b32 v[28:29], 0, 0
    v_pk_mov_b32 v[30:31], 0, 0
    v_pk_mov_b32 v[56:57], 0, 0
    v_pk_mov_b32 v[58:59], 0, 0
    v_pk_mov_b32 v[60:61], 0, 0
    v_pk_mov_b32 v[62:63], 0, 0
    s_add_u32 s73, s72, 8192
    buffer_load_dwordx4 v[96:99], v2, s[4:7], s73 offen offset:0 sc1
    buffer_load_dwordx4 v[100:103], v2, s[4:7], s73 offen offset:1024 sc1
    buffer_load_dwordx4 v[104:107], v2, s[4:7], s73 offen offset:2048 sc1
    buffer_load_dwordx4 v[108:111], v2, s[4:7], s73 offen offset:3072 sc1
    s_add_u32 s73, s72, 12288
    buffer_load_dwordx4 v[72:75], v2, s[4:7], s73 offen offset:0 sc1
    buffer_load_dwordx4 v[76:79], v2, s[4:7], s73 offen offset:1024 sc1
    s_cmp_lg_u32 s51, 0
    s_cbranch_scc1 Lh_64
    s_add_u32 m0, s45, 8192
    s_mov_b32 s47, 851968
    buffer_load_dwordx4 v13, s[12:15], s47 offen  lds
    buffer_load_dwordx4 v14, s[12:15], s47 offen offset:1024  lds
    s_add_u32 m0, s45, 10240
    s_mov_b32 s47, 983040
    buffer_load_dwordx4 v13, s[12:15], s47 offen  lds
    buffer_load_dwordx4 v14, s[12:15], s47 offen offset:1024  lds
    s_add_u32 m0, s45, 12288
    s_mov_b32 s47, 1114112
    buffer_load_dwordx4 v13, s[12:15], s47 offen  lds
    buffer_load_dwordx4 v14, s[12:15], s47 offen offset:1024  lds
    s_add_u32 m0, s45, 14336
    s_mov_b32 s47, 1245184
    buffer_load_dwordx4 v13, s[12:15], s47 offen  lds
    buffer_load_dwordx4 v14, s[12:15], s47 offen offset:1024  lds
    s_add_u32 m0, s45, 16384
    s_mov_b32 s47, 1376256
    buffer_load_dwordx4 v13, s[12:15], s47 offen  lds
    buffer_load_dwordx4 v14, s[12:15], s47 offen offset:1024  lds
    s_add_u32 m0, s45, 18432
    s_mov_b32 s47, 1507328
    buffer_load_dwordx4 v13, s[12:15], s47 offen  lds
    buffer_load_dwordx4 v14, s[12:15], s47 offen offset:1024  lds
    s_add_u32 m0, s45, 20480
    s_mov_b32 s47, 1638400
    buffer_load_dwordx4 v13, s[12:15], s47 offen  lds
    buffer_load_dwordx4 v14, s[12:15], s47 offen offset:1024  lds
    s_add_u32 m0, s45, 22528
    s_mov_b32 s47, 1769472
    buffer_load_dwordx4 v13, s[12:15], s47 offen  lds
    buffer_load_dwordx4 v14, s[12:15], s47 offen offset:1024  lds
Lh_64:
    s_waitcnt vmcnt(10)
    v_max3_u32 v5, v80, v84, v88
    v_max_u32 v5, v5, v92
    v_cmp_eq_u32 vcc, -1, v5
    s_cbranch_vccnz Ls_67
Lq_66:
    v_mfma_f32_32x32x16_bf16 v[16:31], v[128:131], v[80:83], v[16:31]
    v_mfma_f32_32x32x16_bf16 v[32:47], v[132:135], v[80:83], 0
    buffer_load_dwordx4 v[80:83], v2, s[4:7], s73 offen offset:2048 sc1
    v_mfma_f32_32x32x16_bf16 v[16:31], v[136:139], v[84:87], v[16:31]
    v_mfma_f32_32x32x16_bf16 v[32:47], v[140:143], v[84:87], v[32:47]
    buffer_load_dwordx4 v[84:87], v2, s[4:7], s73 offen offset:3072 sc1
    v_mfma_f32_32x32x16_bf16 v[16:31], v[144:147], v[88:91], v[16:31]
    v_mfma_f32_32x32x16_bf16 v[32:47], v[148:151], v[88:91], v[32:47]
    s_add_u32 s73, s72, 16384
    buffer_load_dwordx4 v[88:91], v2, s[4:7], s73 offen offset:0 sc1
    s_waitcnt vmcnt(9)
    v_max3_u32 v5, v112, v116, v120
    v_max_u32 v5, v5, v124
    v_cmp_eq_u32 vcc, -1, v5
    v_mfma_f32_32x32x16_bf16 v[16:31], v[152:155], v[92:95], v[16:31]
    v_mfma_f32_32x32x16_bf16 v[32:47], v[156:159], v[92:95], v[32:47]
    buffer_load_dwordx4 v[92:95], v2, s[4:7], s73 offen offset:1024 sc1
    s_cbranch_vccnz Ls_69
Lq_68:
    ds_read_b64_tr_b16 v[64:65], v6 offset:0
    ds_read_b64_tr_b16 v[66:67], v6 offset:512
    ds_read_b64_tr_b16 v[68:69], v7 offset:0
    ds_read_b64_tr_b16 v[70:71], v7 offset:512
    v_mfma_f32_32x32x16_bf16 v[16:31], v[160:163], v[112:115], v[16:31]
    v_mfma_f32_32x32x16_bf16 v[32:47], v[164:167], v[112:115], v[32:47]
    buffer_load_dwordx4 v[112:115], v2, s[4:7], s73 offen offset:2048 sc1
    s_cmp_lg_u32 s51, 0
    s_cbranch_scc1 Lh_70
    s_lshl_b32 s76, s64, 2
    s_add_u32 s76, s76, s50
    s_mul_i32 s77, s76, 14336
    s_lshl_b32 s78, s65, 11
    s_add_u32 s77, s77, s78
    s_add_u32 s77, s77, 9469952
    s_add_u32 s78, s77, 1024
    v_and_b32 v13, 31, v1
    v_lshl_add_u32 v12, v13, 5, v4
    s_lshl_b32 s79, s76, 8
    s_add_u32 s79, s79, 1114112
    s_branch Lh_71
Lh_70:
    s_lshl_b32 s76, s64, 2
    s_add_u32 s76, s76, s50
    s_mul_i32 s77, s76, 14336
    s_lshl_b32 s78, s65, 7
    s_add_u32 s77, s77, s78
    s_add_u32 s78, s77, 64
    v_and_b32 v12, 15, v1
    v_mul_u32_u24 v12, 896, v12
    v_lshrrev_b32 v13, 4, v1
    v_lshl_add_u32 v12, v13, 4, v12
    s_lshl_b32 s79, s50, 10
    s_add_u32 s79, s79, 98304
    v_and_b32 v14, 31, v1
    v_lshlrev_b32 v14, 5, v14
    v_add_u32 v14, v14, v4
    v_add_u32 v14, s79, v14
    v_lshlrev_b32 v13, 8, v13
    v_bfe_u32 v15, v1, 2, 2
    v_lshl_add_u32 v13, v15, 5, v13
    v_and_b32 v15, 3, v1
    v_lshl_add_u32 v13, v15, 3, v13
    v_add_u32 v13, s79, v13
Lh_71:
    s_waitcnt lgkmcnt(0)
    v_mfma_f32_32x32x16_bf16 v[16:31], v[64:67], v[116:119], v[16:31]
    v_mfma_f32_32x32x16_bf16 v[32:47], v[68:71], v[116:119], v[32:47]
    ds_read_b64_tr_b16 v[64:65], v6 offset:2048
    ds_read_b64_tr_b16 v[66:67], v6 offset:2560
    ds_read_b64_tr_b16 v[68:69], v7 offset:2048
    ds_read_b64_tr_b16 v[70:71], v7 offset:2560
    buffer_load_dwordx4 v[116:119], v2, s[4:7], s73 offen offset:3072 sc1
    v_mfma_f32_32x32x16_bf16 v[16:31], v[168:171], v[120:123], v[16:31]
    v_mfma_f32_32x32x16_bf16 v[32:47], v[172:175], v[120:123], v[32:47]
    s_add_u32 s73, s72, 20480
    buffer_load_dwordx4 v[120:123], v2, s[4:7], s73 offen offset:0 sc1
    s_waitcnt lgkmcnt(0)
    s_waitcnt vmcnt(9)
    v_max3_u32 v5, v96, v100, v104
    v_max_u32 v5, v5, v108
    v_cmp_eq_u32 vcc, -1, v5
    v_mfma_f32_32x32x16_bf16 v[16:31], v[64:67], v[124:127], v[16:31]
    v_mfma_f32_32x32x16_bf16 v[32:47], v[68:71], v[124:127], v[32:47]
    ds_read_b64_tr_b16 v[64:65], v6 offset:4096
    ds_read_b64_tr_b16 v[66:67], v6 offset:4608
    ds_read_b64_tr_b16 v[68:69], v7 offset:4096
    ds_read_b64_tr_b16 v[70:71], v7 offset:4608
    buffer_load_dwordx4 v[124:127], v2, s[4:7], s73 offen offset:1024 sc1
    s_cbranch_vccnz Ls_73
Lq_72:
    s_barrier
    v_mfma_f32_32x32x16_bf16 v[16:31], v[176:179], v[96:99], v[16:31]
    v_mfma_f32_32x32x16_bf16 v[32:47], v[180:183], v[96:99], v[32:47]
    buffer_load_dwordx4 v[96:99], v2, s[4:7], s73 offen offset:2048 sc1
    s_waitcnt lgkmcnt(0)
    v_mfma_f32_32x32x16_bf16 v[16:31], v[64:67], v[100:103], v[16:31]
    v_mfma_f32_32x32x16_bf16 v[32:47], v[68:71], v[100:103], v[32:47]
    ds_read_b64_tr_b16 v[64:65], v6 offset:6144
    ds_read_b64_tr_b16 v[66:67], v6 offset:6656
    ds_read_b64_tr_b16 v[68:69], v7 offset:6144
    ds_read_b64_tr_b16 v[70:71], v7 offset:6656
    buffer_load_dwordx4 v[100:103], v2, s[4:7], s73 offen offset:3072 sc1
    v_mfma_f32_32x32x16_bf16 v[16:31], v[184:187], v[104:107], v[16:31]
    v_mfma_f32_32x32x16_bf16 v[32:47], v[188:191], v[104:107], v[32:47]
    s_add_u32 s73, s72, 24576
    buffer_load_dwordx4 v[104:107], v2, s[4:7], s73 offen offset:0 sc1
    s_waitcnt lgkmcnt(0)
    s_waitcnt vmcnt(9)
    v_max3_u32 v5, v72, v76, v80
    v_max_u32 v5, v5, v84
    v_cmp_eq_u32 vcc, -1, v5
    v_mfma_f32_32x32x16_bf16 v[16:31], v[64:67], v[108:111], v[16:31]
    v_mfma_f32_32x32x16_bf16 v[32:47], v[68:71], v[108:111], v[32:47]
    ds_read_b64_tr_b16 v[64:65], v6 offset:8192
    ds_read_b64_tr_b16 v[66:67], v6 offset:8704
    ds_read_b64_tr_b16 v[68:69], v7 offset:8192
    ds_read_b64_tr_b16 v[70:71], v7 offset:8704
    buffer_load_dwordx4 v[108:111], v2, s[4:7], s73 offen offset:1024 sc1
    s_cbranch_vccnz Ls_75
Lq_74:
    v_mfma_f32_32x32x16_bf16 v[16:31], v[192:195], v[72:75], v[16:31]
    v_mfma_f32_32x32x16_bf16 v[32:47], v[196:199], v[72:75], v[32:47]
    buffer_load_dwordx4 v[72:75], v2, s[4:7], s73 offen offset:2048 sc1
    s_waitcnt lgkmcnt(0)
    v_mfma_f32_32x32x16_bf16 v[16:31], v[64:67], v[76:79], v[16:31]
    v_mfma_f32_32x32x16_bf16 v[32:47], v[68:71], v[76:79], v[32:47]
    ds_read_b64_tr_b16 v[64:65], v6 offset:10240
    ds_read_b64_tr_b16 v[66:67], v6 offset:10752
    ds_read_b64_tr_b16 v[68:69], v7 offset:10240
    ds_read_b64_tr_b16 v[70:71], v7 offset:10752
    buffer_load_dwordx4 v[76:79], v2, s[4:7], s73 offen offset:3072 sc1
    v_mfma_f32_32x32x16_bf16 v[16:31], v[200:203], v[80:83], v[16:31]
    v_mfma_f32_32x32x16_bf16 v[32:47], v[204:207], v[80:83], v[32:47]
    s_add_u32 s73, s72, 114688
    buffer_load_dwordx4 v[80:83], v2, s[4:7], s73 offen offset:0 sc1
    s_waitcnt lgkmcnt(0)
    s_waitcnt vmcnt(9)
    v_max3_u32 v5, v88, v92, v112
    v_max_u32 v5, v5, v116
    v_cmp_eq_u32 vcc, -1, v5
    v_mfma_f32_32x32x16_bf16 v[16:31], v[64:67], v[84:87], v[16:31]
    v_mfma_f32_32x32x16_bf16 v[32:47], v[68:71], v[84:87], v[32:47]
    ds_read_b64_tr_b16 v[64:65], v6 offset:12288
    ds_read_b64_tr_b16 v[66:67], v6 offset:12800
    ds_read_b64_tr_b16 v[68:69], v7 offset:12288
    ds_read_b64_tr_b16 v[70:71], v7 offset:12800
    buffer_load_dwordx4 v[84:87], v2, s[4:7], s73 offen offset:1024 sc1
    s_cbranch_vccnz Ls_77
Lq_76:
    v_mfma_f32_32x32x16_bf16 v[16:31], v[208:211], v[88:91], v[16:31]
    v_mfma_f32_32x32x16_bf16 v[32:47], v[212:215], v[88:91], v[32:47]
    buffer_load_dwordx4 v[88:91], v2, s[4:7], s73 offen offset:2048 sc1
    s_waitcnt lgkmcnt(0)
    v_mfma_f32_32x32x16_bf16 v[16:31], v[64:67], v[92:95], v[16:31]
    v_mfma_f32_32x32x16_bf16 v[32:47], v[68:71], v[92:95], v[32:47]
    ds_read_b64_tr_b16 v[64:65], v6 offset:14336
    ds_read_b64_tr_b16 v[66:67], v6 offset:14848
    ds_read_b64_tr_b16 v[68:69], v7 offset:14336
    ds_read_b64_tr_b16 v[70:71], v7 offset:14848
    buffer_load_dwordx4 v[92:95], v2, s[4:7], s73 offen offset:3072 sc1
    v_mfma_f32_32x32x16_bf16 v[16:31], v[216:219], v[112:115], v[16:31]
    v_mfma_f32_32x32x16_bf16 v[32:47], v[220:223], v[112:115], v[32:47]
    s_add_u32 s73, s72, 118784
    buffer_load_dwordx4 v[112:115], v2, s[4:7], s73 offen offset:0 sc1
    s_waitcnt lgkmcnt(0)
    s_waitcnt vmcnt(9)
    v_max3_u32 v5, v120, v124, v96
    v_max_u32 v5, v5, v100
    v_cmp_eq_u32 vcc, -1, v5
    v_mfma_f32_32x32x16_bf16 v[16:31], v[64:67], v[116:119], v[16:31]
    v_mfma_f32_32x32x16_bf16 v[32:47], v[68:71], v[116:119], v[32:47]
    ds_read_b64_tr_b16 v[64:65], v6 offset:16384
    ds_read_b64_tr_b16 v[66:67], v6 offset:16896
    ds_read_b64_tr_b16 v[68:69], v7 offset:16384
    ds_read_b64_tr_b16 v[70:71], v7 offset:16896
    buffer_load_dwordx4 v[116:119], v2, s[4:7], s73 offen offset:1024 sc1
    s_cbranch_vccnz Ls_79
Lq_78:
    v_mfma_f32_32x32x16_bf16 v[16:31], v[224:227], v[120:123], v[16:31]
    v_mfma_f32_32x32x16_bf16 v[32:47], v[228:231], v[120:123], v[32:47]
    buffer_load_dwordx4 v[120:123], v2, s[4:7], s73 offen offset:2048 sc1
    s_waitcnt lgkmcnt(0)
    v_mfma_f32_32x32x16_bf16 v[16:31], v[64:67], v[124:127], v[16:31]
    v_mfma_f32_32x32x16_bf16 v[32:47], v[68:71], v[124:127], v[32:47]
    ds_read_b64_tr_b16 v[64:65], v6 offset:18432
    ds_read_b64_tr_b16 v[66:67], v6 offset:18944
    ds_read_b64_tr_b16 v[68:69], v7 offset:18432
    ds_read_b64_tr_b16 v[70:71], v7 offset:18944
    buffer_load_dwordx4 v[124:127], v2, s[4:7], s73 offen offset:3072 sc1
    v_mfma_f32_32x32x16_bf16 v[16:31], v[232:235], v[96:99], v[16:31]
    v_mfma_f32_32x32x16_bf16 v[32:47], v[236:239], v[96:99], v[32:47]
    s_add_u32 s73, s72, 122880
    buffer_load_dwordx4 v[96:99], v2, s[4:7], s73 offen offset:0 sc1
    s_waitcnt lgkmcnt(0)
    s_waitcnt vmcnt(9)
    v_max3_u32 v5, v104, v108, v72
    v_max_u32 v5, v5, v76
    v_cmp_eq_u32 vcc, -1, v5
    v_mfma_f32_32x32x16_bf16 v[16:31], v[64:67], v[100:103], v[16:31]
    v_mfma_f32_32x32x16_bf16 v[32:47], v[68:71], v[100:103], v[32:47]
    ds_read_b64_tr_b16 v[64:65], v6 offset:20480
    ds_read_b64_tr_b16 v[66:67], v6 offset:20992
    ds_read_b64_tr_b16 v[68:69], v7 offset:20480
    ds_read_b64_tr_b16 v[70:71], v7 offset:20992
    buffer_load_dwordx4 v[100:103], v2, s[4:7], s73 offen offset:1024 sc1
    s_cbranch_vccnz Ls_81
Lq_80:
    v_mfma_f32_32x32x16_bf16 v[16:31], v[240:243], v[104:107], v[16:31]
    v_mfma_f32_32x32x16_bf16 v[32:47], v[244:247], v[104:107], v[32:47]
    buffer_load_dwordx4 v[104:107], v2, s[4:7], s73 offen offset:2048 sc1
    s_waitcnt lgkmcnt(0)
    v_mfma_f32_32x32x16_bf16 v[16:31], v[64:67], v[108:111], v[16:31]
    v_mfma_f32_32x32x16_bf16 v[32:47], v[68:71], v[108:111], v[32:47]
    ds_read_b64_tr_b16 v[64:65], v6 offset:22528
    ds_read_b64_tr_b16 v[66:67], v6 offset:23040
    ds_read_b64_tr_b16 v[68:69], v7 offset:22528
    ds_read_b64_tr_b16 v[70:71], v7 offset:23040
    buffer_load_dwordx4 v[108:111], v2, s[4:7], s73 offen offset:3072 sc1
    v_mfma_f32_32x32x16_bf16 v[16:31], v[248:251], v[72:75], v[16:31]
    v_mfma_f32_32x32x16_bf16 v[32:47], v[252:255], v[72:75], v[32:47]
    s_waitcnt lgkmcnt(0)
    s_waitcnt vmcnt(8)
    v_max3_u32 v5, v80, v84, v88
    v_max_u32 v5, v5, v92
    v_cmp_eq_u32 vcc, -1, v5
    v_mfma_f32_32x32x16_bf16 v[16:31], v[64:67], v[76:79], v[16:31]
    v_mfma_f32_32x32x16_bf16 v[32:47], v[68:71], v[76:79], v[32:47]
    s_cbranch_vccnz Ls_83
Lq_82:
    v_mfma_f32_32x32x16_bf16 v[48:63], v[128:131], v[80:83], v[48:63]
    v_mfma_f32_32x32x16_bf16 v[64:79], v[132:135], v[80:83], 0
    s_add_u32 s73, s72, 126976
    buffer_load_dwordx4 v[80:83], v2, s[4:7], s73 offen offset:0 sc1
    v_mfma_f32_32x32x16_bf16 v[48:63], v[136:139], v[84:87], v[48:63]
    s_nop 4
    ds_write_b128 v8, v[24:27] offset:0
    v_mfma_f32_32x32x16_bf16 v[64:79], v[140:143], v[84:87], v[64:79]
    ds_write_b128 v8, v[28:31] offset:1024
    buffer_load_dwordx4 v[84:87], v2, s[4:7], s73 offen offset:1024 sc1
    v_mfma_f32_32x32x16_bf16 v[48:63], v[144:147], v[88:91], v[48:63]
    ds_write_b128 v9, v[32:35] offset:0
    v_mfma_f32_32x32x16_bf16 v[64:79], v[148:151], v[88:91], v[64:79]
    ds_write_b128 v9, v[36:39] offset:1024
    buffer_load_dwordx4 v[88:91], v2, s[4:7], s73 offen offset:2048 sc1
    s_waitcnt vmcnt(7)
    v_max3_u32 v5, v112, v116, v120
    v_max_u32 v5, v5, v124
    v_cmp_eq_u32 vcc, -1, v5
    v_mfma_f32_32x32x16_bf16 v[48:63], v[152:155], v[92:95], v[48:63]
    ds_write_b128 v10, v[40:43] offset:0
    v_mfma_f32_32x32x16_bf16 v[64:79], v[156:159], v[92:95], v[64:79]
    ds_write_b128 v10, v[44:47] offset:1024
    buffer_load_dwordx4 v[92:95], v2, s[4:7], s73 offen offset:3072 sc1
    s_cbranch_vccnz Ls_85
Lq_84:
    s_waitcnt lgkmcnt(0)
    s_barrier
    s_add_u32 s73, s72, 131072
    buffer_load_dwordx4 v[40:43], v2, s[4:7], s73 offen offset:0 sc1
    buffer_load_dwordx4 v[44:47], v2, s[4:7], s73 offen offset:1024 sc1
    ds_read_b64_tr_b16 v[32:33], v6 offset:0
    ds_read_b64_tr_b16 v[34:35], v6 offset:512
    ds_read_b64_tr_b16 v[36:37], v7 offset:0
    ds_read_b64_tr_b16 v[38:39], v7 offset:512
    v_mfma_f32_32x32x16_bf16 v[48:63], v[160:163], v[112:115], v[48:63]
    ds_read_b128 v[24:27], v11 offset:0
    ds_read_b128 v[28:31], v11 offset:1024
    v_mfma_f32_32x32x16_bf16 v[64:79], v[164:167], v[112:115], v[64:79]
    buffer_load_dwordx4 v[112:115], v2, s[4:7], s73 offen offset:2048 sc1
    s_waitcnt lgkmcnt(2)
    v_mfma_f32_32x32x16_bf16 v[48:63], v[32:35], v[116:119], v[48:63]
    v_mfma_f32_32x32x16_bf16 v[64:79], v[36:39], v[116:119], v[64:79]
    s_waitcnt lgkmcnt(0)
    v_add_f32 v16, v16, v24
    v_add_f32 v17, v17, v25
    ds_read_b64_tr_b16 v[32:33], v6 offset:2048
    ds_read_b64_tr_b16 v[34:35], v6 offset:2560
    ds_read_b64_tr_b16 v[36:37], v7 offset:2048
    ds_read_b64_tr_b16 v[38:39], v7 offset:2560
    buffer_load_dwordx4 v[116:119], v2, s[4:7], s73 offen offset:3072 sc1
    v_mfma_f32_32x32x16_bf16 v[48:63], v[168:171], v[120:123], v[48:63]
    v_add_f32 v18, v18, v26
    v_add_f32 v19, v19, v27
    v_add_f32 v20, v20, v28
    v_mfma_f32_32x32x16_bf16 v[64:79], v[172:175], v[120:123], v[64:79]
    v_add_f32 v21, v21, v29
    v_add_f32 v22, v22, v30
    s_add_u32 s73, s72, 135168
    buffer_load_dwordx4 v[120:123], v2, s[4:7], s73 offen offset:0 sc1
    s_waitcnt lgkmcnt(0)
    s_waitcnt vmcnt(9)
    v_max3_u32 v5, v96, v100, v104
    v_max_u32 v5, v5, v108
    v_cmp_eq_u32 vcc, -1, v5
    v_mfma_f32_32x32x16_bf16 v[48:63], v[32:35], v[124:127], v[48:63]
    v_add_f32 v23, v23, v31
    ds_read_b128 v[24:27], v11 offset:2048
    ds_read_b128 v[28:31], v11 offset:3072
    v_mfma_f32_32x32x16_bf16 v[64:79], v[36:39], v[124:127], v[64:79]
    ds_read_b64_tr_b16 v[32:33], v6 offset:4096
    ds_read_b64_tr_b16 v[34:35], v6 offset:4608
    ds_read_b64_tr_b16 v[36:37], v7 offset:4096
    ds_read_b64_tr_b16 v[38:39], v7 offset:4608
    buffer_load_dwordx4 v[124:127], v2, s[4:7], s73 offen offset:1024 sc1
    s_cbranch_vccnz Ls_87
Lq_86:
    v_mfma_f32_32x32x16_bf16 v[48:63], v[176:179], v[96:99], v[48:63]
    v_mfma_f32_32x32x16_bf16 v[64:79], v[180:183], v[96:99], v[64:79]
    buffer_load_dwordx4 v[96:99], v2, s[4:7], s73 offen offset:2048 sc1
    s_waitcnt lgkmcnt(0)
    v_mfma_f32_32x32x16_bf16 v[48:63], v[32:35], v[100:103], v[48:63]
    v_add_f32 v16, v16, v24
    v_add_f32 v17, v17, v25
    v_add_f32 v18, v18, v26
    v_mfma_f32_32x32x16_bf16 v[64:79], v[36:39], v[100:103], v[64:79]
    v_add_f32 v19, v19, v27
    v_add_f32 v20, v20, v28
    ds_read_b64_tr_b16 v[32:33], v6 offset:6144
    ds_read_b64_tr_b16 v[34:35], v6 offset:6656
    ds_read_b64_tr_b16 v[36:37], v7 offset:6144
    ds_read_b64_tr_b16 v[38:39], v7 offset:6656
    buffer_load_dwordx4 v[100:103], v2, s[4:7], s73 offen offset:3072 sc1
    v_mfma_f32_32x32x16_bf16 v[48:63], v[184:187], v[104:107], v[48:63]
    v_add_f32 v21, v21, v29
    v_add_f32 v22, v22, v30
    v_add_f32 v23, v23, v31
    v_mfma_f32_32x32x16_bf16 v[64:79], v[188:191], v[104:107], v[64:79]
    ds_read_b128 v[24:27], v11 offset:4096
    ds_read_b128 v[28:31], v11 offset:5120
    s_add_u32 s73, s72, 139264
    buffer_load_dwordx4 v[104:107], v2, s[4:7], s73 offen offset:0 sc1
    s_waitcnt lgkmcnt(2)
    s_waitcnt vmcnt(9)
    v_max3_u32 v5, v80, v84, v88
    v_max_u32 v5, v5, v92
    v_cmp_eq_u32 vcc, -1, v5
    v_mfma_f32_32x32x16_bf16 v[48:63], v[32:35], v[108:111], v[48:63]
    v_mfma_f32_32x32x16_bf16 v[64:79], v[36:39], v[108:111], v[64:79]
    ds_read_b64_tr_b16 v[32:33], v6 offset:8192
    ds_read_b64_tr_b16 v[34:35], v6 offset:8704
    ds_read_b64_tr_b16 v[36:37], v7 offset:8192
    ds_read_b64_tr_b16 v[38:39], v7 offset:8704
    buffer_load_dwordx4 v[108:111], v2, s[4:7], s73 offen offset:1024 sc1
    s_cbranch_vccnz Ls_89
Lq_88:
    v_mfma_f32_32x32x16_bf16 v[48:63], v[192:195], v[80:83], v[48:63]
    v_mfma_f32_32x32x16_bf16 v[64:79], v[196:199], v[80:83], v[64:79]
    s_waitcnt lgkmcnt(4)
    v_add_f32 v16, v16, v24
    v_add_f32 v17, v17, v25
    buffer_load_dwordx4 v[80:83], v2, s[4:7], s73 offen offset:2048 sc1
    s_waitcnt lgkmcnt(0)
    v_mfma_f32_32x32x16_bf16 v[48:63], v[32:35], v[84:87], v[48:63]
    v_add_f32 v18, v18, v26
    v_add_f32 v19, v19, v27
    v_add_f32 v20, v20, v28
    v_mfma_f32_32x32x16_bf16 v[64:79], v[36:39], v[84:87], v[64:79]
    v_add_f32 v21, v21, v29
    v_add_f32 v22, v22, v30
    ds_read_b64_tr_b16 v[32:33], v6 offset:10240
    ds_read_b64_tr_b16 v[34:35], v6 offset:10752
    ds_read_b64_tr_b16 v[36:37], v7 offset:10240
    ds_read_b64_tr_b16 v[38:39], v7 offset:10752
    buffer_load_dwordx4 v[84:87], v2, s[4:7], s73 offen offset:3072 sc1
    v_mfma_f32_32x32x16_bf16 v[48:63], v[200:203], v[88:91], v[48:63]
    v_add_f32 v23, v23, v31
    v_cvt_pk_bf16_f32 v24, v16, v17
    v_cvt_pk_bf16_f32 v25, v18, v19
    v_mfma_f32_32x32x16_bf16 v[64:79], v[204:207], v[88:91], v[64:79]
    v_cvt_pk_bf16_f32 v26, v20, v21
    v_cvt_pk_bf16_f32 v27, v22, v23
    s_waitcnt lgkmcnt(0)
    s_waitcnt vmcnt(8)
    v_max3_u32 v5, v40, v44, v112
    v_max_u32 v5, v5, v116
    v_cmp_eq_u32 vcc, -1, v5
    v_mfma_f32_32x32x16_bf16 v[48:63], v[32:35], v[92:95], v[48:63]
    v_mfma_f32_32x32x16_bf16 v[64:79], v[36:39], v[92:95], v[64:79]
    ds_read_b64_tr_b16 v[32:33], v6 offset:12288
    ds_read_b64_tr_b16 v[34:35], v6 offset:12800
    ds_read_b64_tr_b16 v[36:37], v7 offset:12288
    ds_read_b64_tr_b16 v[38:39], v7 offset:12800
    s_cbranch_vccnz Ls_91
Lq_90:
    v_mfma_f32_32x32x16_bf16 v[48:63], v[208:211], v[40:43], v[48:63]
    s_cmp_lg_u32 s51, 0
    s_cbranch_scc1 Lh_92
    buffer_store_dwordx4 v[24:27], v12, s[4:7], s77 offen sc1
    s_branch Lh_93
Lh_92:
    ds_write_b128 v14, v[24:27]
    s_waitcnt lgkmcnt(0)
    ds_read_b64_tr_b16 v[24:25], v13
    ds_read_b64_tr_b16 v[26:27], v13 offset:128
    s_waitcnt lgkmcnt(0)
    buffer_store_dwordx4 v[24:27], v12, s[52:55], s77 offen sc1
Lh_93:
    v_mfma_f32_32x32x16_bf16 v[64:79], v[212:215], v[40:43], v[64:79]
    s_waitcnt lgkmcnt(0)
    v_mfma_f32_32x32x16_bf16 v[48:63], v[32:35], v[44:47], v[48:63]
    v_mfma_f32_32x32x16_bf16 v[64:79], v[36:39], v[44:47], v[64:79]
    ds_read_b64_tr_b16 v[32:33], v6 offset:14336
    ds_read_b64_tr_b16 v[34:35], v6 offset:14848
    ds_read_b64_tr_b16 v[36:37], v7 offset:14336
    ds_read_b64_tr_b16 v[38:39], v7 offset:14848
    v_mfma_f32_32x32x16_bf16 v[48:63], v[216:219], v[112:115], v[48:63]
    v_mfma_f32_32x32x16_bf16 v[64:79], v[220:223], v[112:115], v[64:79]
    s_waitcnt lgkmcnt(0)
    s_waitcnt vmcnt(5)
    v_max3_u32 v5, v120, v124, v96
    v_max_u32 v5, v5, v100
    v_cmp_eq_u32 vcc, -1, v5
    v_mfma_f32_32x32x16_bf16 v[48:63], v[32:35], v[116:119], v[48:63]
    v_mfma_f32_32x32x16_bf16 v[64:79], v[36:39], v[116:119], v[64:79]
    ds_read_b64_tr_b16 v[32:33], v6 offset:16384
    ds_read_b64_tr_b16 v[34:35], v6 offset:16896
    ds_read_b64_tr_b16 v[36:37], v7 offset:16384
    ds_read_b64_tr_b16 v[38:39], v7 offset:16896
    s_cbranch_vccnz Ls_95
Lq_94:
    v_mfma_f32_32x32x16_bf16 v[48:63], v[224:227], v[120:123], v[48:63]
    v_mfma_f32_32x32x16_bf16 v[64:79], v[228:231], v[120:123], v[64:79]
    s_waitcnt lgkmcnt(0)
    v_mfma_f32_32x32x16_bf16 v[48:63], v[32:35], v[124:127], v[48:63]
    v_mfma_f32_32x32x16_bf16 v[64:79], v[36:39], v[124:127], v[64:79]
    ds_read_b64_tr_b16 v[32:33], v6 offset:18432
    ds_read_b64_tr_b16 v[34:35], v6 offset:18944
    ds_read_b64_tr_b16 v[36:37], v7 offset:18432
    ds_read_b64_tr_b16 v[38:39], v7 offset:18944
    v_mfma_f32_32x32x16_bf16 v[48:63], v[232:235], v[96:99], v[48:63]
    v_mfma_f32_32x32x16_bf16 v[64:79], v[236:239], v[96:99], v[64:79]
    s_waitcnt lgkmcnt(0)
    s_waitcnt vmcnt(1)
    v_max3_u32 v5, v104, v108, v80
    v_max_u32 v5, v5, v84
    v_cmp_eq_u32 vcc, -1, v5
    v_mfma_f32_32x32x16_bf16 v[48:63], v[32:35], v[100:103], v[48:63]
    v_mfma_f32_32x32x16_bf16 v[64:79], v[36:39], v[100:103], v[64:79]
    ds_read_b64_tr_b16 v[32:33], v6 offset:20480
    ds_read_b64_tr_b16 v[34:35], v6 offset:20992
    ds_read_b64_tr_b16 v[36:37], v7 offset:20480
    ds_read_b64_tr_b16 v[38:39], v7 offset:20992
    s_cbranch_vccnz Ls_97
Lq_96:
    s_barrier
    ds_read_b64_tr_b16 v[40:41], v6 offset:22528
    ds_read_b64_tr_b16 v[42:43], v6 offset:23040
    ds_read_b64_tr_b16 v[44:45], v7 offset:22528
    ds_read_b64_tr_b16 v[46:47], v7 offset:23040
    v_mfma_f32_32x32x16_bf16 v[64:79], v[244:247], v[104:107], v[64:79]
    v_mfma_f32_32x32x16_bf16 v[64:79], v[252:255], v[80:83], v[64:79]
    s_waitcnt lgkmcnt(4)
    v_mfma_f32_32x32x16_bf16 v[64:79], v[36:39], v[108:111], v[64:79]
    s_waitcnt lgkmcnt(0)
    v_mfma_f32_32x32x16_bf16 v[64:79], v[44:47], v[84:87], v[64:79]
    v_mfma_f32_32x32x16_bf16 v[48:63], v[240:243], v[104:107], v[48:63]
    v_mfma_f32_32x32x16_bf16 v[48:63], v[32:35], v[108:111], v[48:63]
    v_mfma_f32_32x32x16_bf16 v[48:63], v[248:251], v[80:83], v[48:63]
    s_nop 8
    ds_write_b128 v9, v[64:67] offset:0
    ds_write_b128 v9, v[68:71] offset:1024
    v_mfma_f32_32x32x16_bf16 v[48:63], v[40:43], v[84:87], v[48:63]
    ds_write_b128 v10, v[72:75] offset:0
    ds_write_b128 v10, v[76:79] offset:1024
    s_nop 9
    ds_write_b128 v8, v[56:59] offset:0
    ds_write_b128 v8, v[60:63] offset:1024
    s_waitcnt lgkmcnt(0)
    s_barrier
    ds_read_b128 v[56:59], v11 offset:0
    ds_read_b128 v[60:63], v11 offset:1024
    ds_read_b128 v[64:67], v11 offset:2048
    ds_read_b128 v[68:71], v11 offset:3072
    ds_read_b128 v[72:75], v11 offset:4096
    ds_read_b128 v[76:79], v11 offset:5120
    s_waitcnt lgkmcnt(4)
    v_pk_add_f32 v[48:49], v[48:49], v[56:57]
    v_pk_add_f32 v[50:51], v[50:51], v[58:59]
    v_pk_add_f32 v[52:53], v[52:53], v[60:61]
    v_pk_add_f32 v[54:55], v[54:55], v[62:63]
    s_waitcnt lgkmcnt(2)
    v_pk_add_f32 v[48:49], v[48:49], v[64:65]
    v_pk_add_f32 v[50:51], v[50:51], v[66:67]
    v_pk_add_f32 v[52:53], v[52:53], v[68:69]
    v_pk_add_f32 v[54:55], v[54:55], v[70:71]
    s_waitcnt lgkmcnt(0)
    v_pk_add_f32 v[48:49], v[48:49], v[72:73]
    v_pk_add_f32 v[50:51], v[50:51], v[74:75]
    v_pk_add_f32 v[52:53], v[52:53], v[76:77]
    v_pk_add_f32 v[54:55], v[54:55], v[78:79]
    v_cvt_pk_bf16_f32 v56, v48, v49
    v_cvt_pk_bf16_f32 v57, v50, v51
    v_cvt_pk_bf16_f32 v58, v52, v53
    v_cvt_pk_bf16_f32 v59, v54, v55
    s_cmp_lg_u32 s51, 0
    s_cbranch_scc1 Lh_98
    buffer_store_dwordx4 v[56:59], v12, s[4:7], s78 offen sc1
    v_pk_mul_f32 v[24:25], v[16:17], v[16:17]
    v_pk_mul_f32 v[26:27], v[18:19], v[18:19]
    v_pk_mul_f32 v[28:29], v[20:21], v[20:21]
    v_pk_mul_f32 v[30:31], v[22:23], v[22:23]
    v_pk_fma_f32 v[24:25], v[48:49], v[48:49], v[24:25]
    v_pk_add_f32 v[16:17], v[16:17], v[48:49]
    v_pk_fma_f32 v[26:27], v[50:51], v[50:51], v[26:27]
    v_pk_add_f32 v[18:19], v[18:19], v[50:51]
    v_pk_fma_f32 v[28:29], v[52:53], v[52:53], v[28:29]
    v_pk_add_f32 v[20:21], v[20:21], v[52:53]
    v_pk_fma_f32 v[30:31], v[54:55], v[54:55], v[30:31]
    v_pk_add_f32 v[22:23], v[22:23], v[54:55]
    v_add_f32_dpp v32, v16, v16 row_shl:4 row_mask:0xf bank_mask:0x5
    v_add_f32_dpp v33, v18, v18 row_shl:4 row_mask:0xf bank_mask:0x5
    v_add_f32_dpp v34, v20, v20 row_shl:4 row_mask:0xf bank_mask:0x5
    v_add_f32_dpp v35, v22, v22 row_shl:4 row_mask:0xf bank_mask:0x5
    v_add_f32_dpp v36, v24, v24 row_shl:4 row_mask:0xf bank_mask:0x5
    v_add_f32_dpp v37, v26, v26 row_shl:4 row_mask:0xf bank_mask:0x5
    v_add_f32_dpp v38, v28, v28 row_shl:4 row_mask:0xf bank_mask:0x5
    v_add_f32_dpp v39, v30, v30 row_shl:4 row_mask:0xf bank_mask:0x5
    v_add_f32_dpp v32, v17, v17 row_shr:4 row_mask:0xf bank_mask:0xa
    v_add_f32_dpp v33, v19, v19 row_shr:4 row_mask:0xf bank_mask:0xa
    v_add_f32_dpp v34, v21, v21 row_shr:4 row_mask:0xf bank_mask:0xa
    v_add_f32_dpp v35, v23, v23 row_shr:4 row_mask:0xf bank_mask:0xa
    v_add_f32_dpp v36, v25, v25 row_shr:4 row_mask:0xf bank_mask:0xa
    v_add_f32_dpp v37, v27, v27 row_shr:4 row_mask:0xf bank_mask:0xa
    v_add_f32_dpp v38, v29, v29 row_shr:4 row_mask:0xf bank_mask:0xa
    v_add_f32_dpp v39, v31, v31 row_shr:4 row_mask:0xf bank_mask:0xa
    v_add_f32_dpp v16, v32, v32 row_shl:8 row_mask:0xf bank_mask:0x3
    v_add_f32_dpp v17, v34, v34 row_shl:8 row_mask:0xf bank_mask:0x3
    v_add_f32_dpp v18, v36, v36 row_shl:8 row_mask:0xf bank_mask:0x3
    v_add_f32_dpp v19, v38, v38 row_shl:8 row_mask:0xf bank_mask:0x3
    v_add_f32_dpp v16, v33, v33 row_shr:8 row_mask:0xf bank_mask:0xc
    v_add_f32_dpp v17, v35, v35 row_shr:8 row_mask:0xf bank_mask:0xc
    v_add_f32_dpp v18, v37, v37 row_shr:8 row_mask:0xf bank_mask:0xc
    v_add_f32_dpp v19, v39, v39 row_shr:8 row_mask:0xf bank_mask:0xc
    v_permlane16_swap_b32 v16, v17
    s_nop 0
    v_permlane16_swap_b32 v18, v19
    v_add_f32 v32, v16, v17
    v_add_f32 v34, v18, v19
    v_and_b32 v4, 3, v1
    v_cmp_eq_u32 s[80:81], 1, v4
    v_cmp_eq_u32 s[82:83], 2, v4
    v_cmp_eq_u32 vcc, 3, v4
    v_add_f32_dpp v32, v32, v32 quad_perm:[1,0,3,2] row_mask:0xf bank_mask:0xf
    s_nop 1
    v_add_f32_dpp v32, v32, v32 quad_perm:[2,3,0,1] row_mask:0xf bank_mask:0xf
    v_add_f32_dpp v34, v34, v34 quad_perm:[1,0,3,2] row_mask:0xf bank_mask:0xf
    s_nop 1
    v_add_f32_dpp v34, v34, v34 quad_perm:[2,3,0,1] row_mask:0xf bank_mask:0xf
    v_lshlrev_b32 v4, 2, v1
    v_cndmask_b32 v32, v32, v34, s[80:81]
    v_cndmask_b32 v32, v32, 1.0, s[82:83]
    v_cndmask_b32 v32, v32, 0, vcc
    buffer_atomic_add_f32 v32, v4, s[4:7], s79 offen
    s_branch Lh_99
Lh_98:
    ds_write_b128 v14, v[56:59]
    s_waitcnt lgkmcnt(0)
    ds_read_b64_tr_b16 v[56:57], v13
    ds_read_b64_tr_b16 v[58:59], v13 offset:128
    s_waitcnt lgkmcnt(0)
    buffer_store_dwordx4 v[56:59], v12, s[52:55], s78 offen sc1
Lh_99:
    s_cmp_lg_u32 s51, 0
    s_cbranch_scc1 L_fin
    s_mov_b32 s51, 1
    s_mov_b32 s66, 7110656
    s_mov_b32 s68, 9469952
    s_mov_b32 s69, 1114112
    s_mov_b32 s67, 0x40e00000
    s_mov_b32 s44, 24
    s_or_b32 s72, s2, s50
    s_cmp_lg_u32 s72, 0
    s_cbranch_scc1 Lm_100
    v_mov_b32 v4, s56
    s_mov_b64 exec, 1
    buffer_store_dword v4, off, s[4:7], 0 sc1
    s_mov_b64 exec, -1
Lm_100:
    s_barrier
    v_lshrrev_b32 v16, 1, v0
    v_mul_u32_u24 v16, 14336, v16
    v_and_b32 v17, 1, v0
    v_lshl_add_u32 v16, v17, 4, v16
    s_lshl_b32 s72, s60, 5
    v_add_u32 v16, s72, v16
    s_lshr_b32 s84, s50, 1
    s_and_b32 s85, s50, 1
    v_and_b32 v28, 15, v1
    v_lshrrev_b32 v29, 4, v1
    s_mul_i32 s74, s84, 7520
    s_lshl_b32 s75, s85, 8
    s_sub_u32 s74, s74, s75
    s_add_u32 s74, s74, 131264
    v_lshlrev_b32 v4, 5, v28
    v_lshl_add_u32 v4, v29, 4, v4
    v_add_u32 v4, s74, v4
    s_mul_i32 s74, s84, 16480
    s_lshl_b32 s75, s85, 10
    s_sub_u32 s74, s74, s75
    s_add_u32 s74, s74, 98424
    v_lshlrev_b32 v5, 6, v29
    v_lshrrev_b32 v6, 2, v28
    v_lshlrev_b32 v6, 5, v6
    v_sub_u32 v5, v5, v6
    v_and_b32 v6, 3, v1
    v_lshlrev_b32 v6, 3, v6
    v_sub_u32 v5, v5, v6
    v_add_u32 v5, s74, v5
    s_lshl_b32 s74, s84, 11
    s_lshl_b32 s75, s85, 13
    s_add_u32 s74, s74, 143552
    s_add_u32 s76, s74, s75
    s_xor_b32 s75, s75, 8192
    s_add_u32 s77, s74, s75
    v_lshlrev_b32 v7, 6, v28
    v_lshl_add_u32 v7, v29, 4, v7
    v_add_u32 v6, s76, v7
    v_add_u32 v7, s77, v2
    s_mov_b32 s87, s76
    v_lshlrev_b32 v8, 5, v28
    v_and_b32 v28, 1, v29
    v_lshl_add_u32 v8, v28, 9, v8
    v_lshrrev_b32 v29, 1, v29
    v_lshl_add_u32 v8, v29, 4, v8
    s_lshl_b32 s86, s60, 12
    s_lshl_b32 s75, s84, 12
    s_add_u32 s86, s86, s75
    s_lshl_b32 s75, s85, 11
    s_add_u32 s86, s86, s75
    s_add_u32 s86, s86, s66
    s_add_u32 s86, s86, 4194304
    s_lshl_b32 s74, s50, 12
    s_add_u32 s74, s74, 143552
    v_lshrrev_b32 v24, 1, v1
    v_lshrrev_b32 v25, 5, v1
    v_xor_b32 v24, v24, v25
    v_lshlrev_b32 v24, 4, v24
    v_and_b32 v25, 1, v1
    v_lshl_add_u32 v24, v25, 3, v24
    v_add_u32 v24, s74, v24
    v_xor_b32 v25, 32, v24
    v_bfe_u32 v26, v1, 2, 2
    v_lshlrev_b32 v26, 4, v26
    v_lshl_add_u32 v26, v1, 6, v26
    v_add_u32 v26, s74, v26
    v_xor_b32 v27, 16, v26
    v_xor_b32 v28, 32, v26
    v_xor_b32 v29, 48, v26
    v_lshl_add_u32 v30, v1, 5, s74
    v_lshlrev_b32 v31, 4, v0
    v_add_u32 v31, 131744, v31
    v_mov_b32 v22, 0x3b124925
    v_mov_b32 v23, 0x3b124925
    s_mov_b32 s80, 0
    s_mov_b32 s81, 0x3727c5ac
    s_lshl_b32 s72, s50, 13
    s_add_u32 s72, s72, s69
    s_add_u32 s73, s72, 4096
    s_mov_b32 s71, 0
    s_mov_b32 s74, 9469952
    v_and_b32 v17, 31, v1
    v_lshlrev_b32 v17, 7, v17
    s_mov_b32 s75, 90112
    s_mov_b64 exec, 1
Lw_101:
    buffer_load_dword v18, v2, s[4:7], s73 offen offset:8 sc1
    s_waitcnt vmcnt(0)
    v_cmp_ne_u32 vcc, s67, v18
    s_cbranch_vccz Lr_103
    s_add_u32 s71, s71, 1
    s_cmp_gt_u32 s71, 32768
    s_cbranch_scc1 Lr_103
    s_sleep 1
    s_branch Lw_101
Lr_103:
    s_mov_b64 exec, -1
Lw_102:
    buffer_load_dwordx4 v[80:83], v16, s[4:7], s74 offen sc1
    buffer_load_dwordx4 v[84:87], v16, s[4:7], s74 offen offset:32 sc1
Lc_104:
    buffer_load_dword v18, v17, s[4:7], s75 offen sc1
    buffer_load_dwordx3 v[48:50], v2, s[4:7], s72 offen offset:0 sc1
    buffer_load_dwordx3 v[52:54], v2, s[4:7], s72 offen offset:1024 sc1
    buffer_load_dwordx3 v[56:58], v2, s[4:7], s72 offen offset:2048 sc1
    buffer_load_dwordx3 v[60:62], v2, s[4:7], s72 offen offset:3072 sc1
    buffer_load_dwordx3 v[64:66], v2, s[4:7], s73 offen offset:0 sc1
    buffer_load_dwordx3 v[68:70], v2, s[4:7], s73 offen offset:1024 sc1
    buffer_load_dwordx3 v[72:74], v2, s[4:7], s73 offen offset:2048 sc1
    buffer_load_dwordx3 v[76:78], v2, s[4:7], s73 offen offset:3072 sc1
    s_waitcnt vmcnt(0)
    v_xor_b32 v15, s67, v50
    v_bitop3_b32 v15, v15, v54, s67 bitop3:0xf6
    v_bitop3_b32 v15, v15, v58, s67 bitop3:0xf6
    v_bitop3_b32 v15, v15, v62, s67 bitop3:0xf6
    v_bitop3_b32 v15, v15, v66, s67 bitop3:0xf6
    v_bitop3_b32 v15, v15, v70, s67 bitop3:0xf6
    v_bitop3_b32 v15, v15, v74, s67 bitop3:0xf6
    v_bitop3_b32 v15, v15, v78, s67 bitop3:0xf6
    v_bitop3_b32 v15, v15, v18, s56 bitop3:0xf6
    v_cmp_ne_u32 vcc, 0, v15
    s_cbranch_vccz Lr_105
    s_add_u32 s71, s71, 1
    s_cmp_gt_u32 s71, 32768
    s_cbranch_scc1 Lr_105
    s_sleep 1
    s_branch Lc_104
Lr_105:
Lc_106:
    v_max_u32 v51, v80, v84
    v_cmp_eq_u32 vcc, -1, v51
    s_cbranch_vccz Lc_107
    s_add_u32 s71, s71, 1
    s_cmp_gt_u32 s71, 32768
    s_cbranch_scc1 Lc_107
    buffer_load_dwordx4 v[80:83], v16, s[4:7], s74 offen sc1
    buffer_load_dwordx4 v[84:87], v16, s[4:7], s74 offen offset:32 sc1
    s_waitcnt vmcnt(0)
    s_branch Lc_106
Lc_107:
    v_pk_fma_f32 v[48:49], v[48:49], v[22:23], s[80:81]
    v_pk_fma_f32 v[52:53], v[52:53], v[22:23], s[80:81]
    v_pk_fma_f32 v[56:57], v[56:57], v[22:23], s[80:81]
    v_pk_fma_f32 v[60:61], v[60:61], v[22:23], s[80:81]
    v_pk_fma_f32 v[64:65], v[64:65], v[22:23], s[80:81]
    v_pk_fma_f32 v[68:69], v[68:69], v[22:23], s[80:81]
    v_pk_fma_f32 v[72:73], v[72:73], v[22:23], s[80:81]
    v_pk_fma_f32 v[76:77], v[76:77], v[22:23], s[80:81]
    v_fma_f32 v49, -v48, v48, v49
    v_fma_f32 v53, -v52, v52, v53
    v_fma_f32 v57, -v56, v56, v57
    v_fma_f32 v61, -v60, v60, v61
    v_fma_f32 v65, -v64, v64, v65
    v_fma_f32 v69, -v68, v68, v69
    v_fma_f32 v73, -v72, v72, v73
    v_fma_f32 v77, -v76, v76, v77
    v_max_f32 v49, s81, v49
    v_max_f32 v53, s81, v53
    v_max_f32 v57, s81, v57
    v_max_f32 v61, s81, v61
    v_max_f32 v65, s81, v65
    v_max_f32 v69, s81, v69
    v_max_f32 v73, s81, v73
    v_max_f32 v77, s81, v77
    v_rsq_f32 v50, v49
    v_rsq_f32 v54, v53
    v_rsq_f32 v58, v57
    v_rsq_f32 v62, v61
    v_rsq_f32 v66, v65
    v_rsq_f32 v70, v69
    v_rsq_f32 v74, v73
    v_rsq_f32 v78, v77
    v_mul_f32 v51, -v48, v50
    ds_write_b64 v24, v[50:51] offset:0
    v_mul_f32 v55, -v52, v54
    ds_write_b64 v25, v[54:55] offset:512
    v_mul_f32 v59, -v56, v58
    ds_write_b64 v24, v[58:59] offset:1024
    v_mul_f32 v63, -v60, v62
    ds_write_b64 v25, v[62:63] offset:1536
    v_mul_f32 v67, -v64, v66
    ds_write_b64 v24, v[66:67] offset:2048
    v_mul_f32 v71, -v68, v70
    ds_write_b64 v25, v[70:71] offset:2560
    v_mul_f32 v75, -v72, v74
    ds_write_b64 v24, v[74:75] offset:3072
    v_mul_f32 v79, -v76, v78
    ds_write_b64 v25, v[78:79] offset:3584
    ds_read_b128 v[48:51], v26
    ds_read_b128 v[52:55], v27
    ds_read_b128 v[56:59], v28
    ds_read_b128 v[60:63], v29
    v_lshlrev_b32 v88, 16, v80
    v_lshlrev_b32 v89, 16, v84
    v_and_b32 v90, 0xffff0000, v80
    v_and_b32 v91, 0xffff0000, v84
    v_lshlrev_b32 v92, 16, v81
    v_lshlrev_b32 v93, 16, v85
    v_and_b32 v94, 0xffff0000, v81
    v_and_b32 v95, 0xffff0000, v85
    v_lshlrev_b32 v96, 16, v82
    v_lshlrev_b32 v97, 16, v86
    v_and_b32 v98, 0xffff0000, v82
    v_and_b32 v99, 0xffff0000, v86
    v_lshlrev_b32 v100, 16, v83
    v_lshlrev_b32 v101, 16, v87
    v_and_b32 v102, 0xffff0000, v83
    v_and_b32 v103, 0xffff0000, v87
    s_waitcnt lgkmcnt(3)
    v_pk_fma_f32 v[64:65], v[88:89], v[48:49], v[48:49] op_sel:[0,0,1] op_sel_hi:[1,0,1]
    v_pk_fma_f32 v[66:67], v[90:91], v[50:51], v[50:51] op_sel:[0,0,1] op_sel_hi:[1,0,1]
    s_waitcnt lgkmcnt(2)
    v_pk_fma_f32 v[68:69], v[92:93], v[52:53], v[52:53] op_sel:[0,0,1] op_sel_hi:[1,0,1]
    v_pk_fma_f32 v[70:71], v[94:95], v[54:55], v[54:55] op_sel:[0,0,1] op_sel_hi:[1,0,1]
    s_waitcnt lgkmcnt(1)
    v_pk_fma_f32 v[72:73], v[96:97], v[56:57], v[56:57] op_sel:[0,0,1] op_sel_hi:[1,0,1]
    v_pk_fma_f32 v[74:75], v[98:99], v[58:59], v[58:59] op_sel:[0,0,1] op_sel_hi:[1,0,1]
    s_waitcnt lgkmcnt(0)
    v_pk_fma_f32 v[76:77], v[100:101], v[60:61], v[60:61] op_sel:[0,0,1] op_sel_hi:[1,0,1]
    v_pk_fma_f32 v[78:79], v[102:103], v[62:63], v[62:63] op_sel:[0,0,1] op_sel_hi:[1,0,1]
    v_cvt_pk_bf16_f32 v104, v64, v66
    v_cvt_pk_bf16_f32 v105, v68, v70
    v_cvt_pk_bf16_f32 v106, v72, v74
    v_cvt_pk_bf16_f32 v107, v76, v78
    ds_write_b128 v31, v[104:107] offset:0
    v_cvt_pk_bf16_f32 v108, v65, v67
    v_cvt_pk_bf16_f32 v109, v69, v71
    v_cvt_pk_bf16_f32 v110, v73, v75
    v_cvt_pk_bf16_f32 v111, v77, v79
    ds_write_b128 v31, v[108:111] offset:7520
    v_fma_f32 v112, v64, s34, v88
    v_fma_f32 v113, v66, s34, v90
    v_fma_f32 v114, v68, s34, v92
    v_fma_f32 v115, v70, s34, v94
    v_fma_f32 v116, v72, s34, v96
    v_fma_f32 v117, v74, s34, v98
    v_fma_f32 v118, v76, s34, v100
    v_fma_f32 v119, v78, s34, v102
    ds_write_b128 v30, v[112:115] offset:0
    ds_write_b128 v30, v[116:119] offset:16
    v_fma_f32 v120, v65, s35, v89
    v_fma_f32 v121, v67, s35, v91
    v_fma_f32 v122, v69, s35, v93
    v_fma_f32 v123, v71, s35, v95
    v_fma_f32 v124, v73, s35, v97
    v_fma_f32 v125, v75, s35, v99
    v_fma_f32 v126, v77, s35, v101
    v_fma_f32 v127, v79, s35, v103
    ds_write_b128 v30, v[120:123] offset:2048
    ds_write_b128 v30, v[124:127] offset:2064
    s_waitcnt lgkmcnt(0)
    s_barrier
    s_cmp_eq_u32 s85, 0
    s_cbranch_scc0 Lc_108
    ds_read_b128 v[16:19], v6 offset:0
    ds_read_b128 v[20:23], v6 offset:1024
    ds_read_b128 v[24:27], v6 offset:4096
    ds_read_b128 v[28:31], v6 offset:5120
    v_pk_mov_b32 v[32:33], 0, 0
    v_pk_mov_b32 v[34:35], 0, 0
    v_pk_mov_b32 v[36:37], 0, 0
    v_pk_mov_b32 v[38:39], 0, 0
    v_pk_mov_b32 v[40:41], 0, 0
    v_pk_mov_b32 v[42:43], 0, 0
    v_pk_mov_b32 v[44:45], 0, 0
    v_pk_mov_b32 v[46:47], 0, 0
    s_branch Lc_109
Lc_108:
    ds_read_b128 v[32:35], v6 offset:0
    ds_read_b128 v[36:39], v6 offset:1024
    ds_read_b128 v[40:43], v6 offset:4096
    ds_read_b128 v[44:47], v6 offset:5120
    v_pk_mov_b32 v[16:17], 0, 0
    v_pk_mov_b32 v[18:19], 0, 0
    v_pk_mov_b32 v[20:21], 0, 0
    v_pk_mov_b32 v[22:23], 0, 0
    v_pk_mov_b32 v[24:25], 0, 0
    v_pk_mov_b32 v[26:27], 0, 0
    v_pk_mov_b32 v[28:29], 0, 0
    v_pk_mov_b32 v[30:31], 0, 0
Lc_109:
    v_add_u32 v6, s87, v2
    ds_read_b64 v[100:101], v5 offset:16128
    ds_read_b64 v[102:103], v5 offset:16160
    ds_read_b128 v[48:51], v4 offset:448
    ds_read_b128 v[52:55], v4 offset:960
    ds_read_b128 v[56:59], v4 offset:1472
    ds_read_b128 v[60:63], v4 offset:1984
    ds_read_b128 v[64:67], v4 offset:2496
    ds_read_b128 v[68:71], v4 offset:3008
    ds_read_b128 v[72:75], v4 offset:3520
    ds_read_b128 v[76:79], v4 offset:4032
    ds_read_b64 v[104:105], v5 offset:7936
    ds_read_b64 v[106:107], v5 offset:7968
    s_waitcnt lgkmcnt(12)
    s_waitcnt lgkmcnt(10)
    s_waitcnt lgkmcnt(9)
    v_mfma_f32_16x16x32_bf16 v[16:19], v[100:103], v[48:51], v[16:19]
    ds_read_b64 v[108:109], v5 offset:9984
    s_waitcnt lgkmcnt(9)
    v_mfma_f32_16x16x32_bf16 v[20:23], v[100:103], v[52:55], v[20:23]
    ds_read_b64 v[110:111], v5 offset:10016
    s_waitcnt lgkmcnt(9)
    v_mfma_f32_16x16x32_bf16 v[24:27], v[100:103], v[56:59], v[24:27]
    ds_read_b128 v[80:83], v4 offset:384
    s_waitcnt lgkmcnt(9)
    v_mfma_f32_16x16x32_bf16 v[28:31], v[100:103], v[60:63], v[28:31]
    ds_read_b128 v[84:87], v4 offset:896
    s_waitcnt lgkmcnt(9)
    v_mfma_f32_16x16x32_bf16 v[32:35], v[100:103], v[64:67], v[32:35]
    ds_read_b128 v[88:91], v4 offset:1408
    s_waitcnt lgkmcnt(9)
    v_mfma_f32_16x16x32_bf16 v[36:39], v[100:103], v[68:71], v[36:39]
    ds_read_b128 v[92:95], v4 offset:1920
    s_waitcnt lgkmcnt(9)
    v_mfma_f32_16x16x32_bf16 v[40:43], v[100:103], v[72:75], v[40:43]
    ds_read_b128 v[96:99], v4 offset:2432
    s_waitcnt lgkmcnt(9)
    v_mfma_f32_16x16x32_bf16 v[44:47], v[100:103], v[76:79], v[44:47]
    s_waitcnt lgkmcnt(7)
    v_mfma_f32_16x16x32_bf16 v[32:35], v[104:107], v[48:51], v[32:35]
    ds_read_b64 v[100:101], v5 offset:14080
    v_mfma_f32_16x16x32_bf16 v[36:39], v[104:107], v[52:55], v[36:39]
    ds_read_b64 v[102:103], v5 offset:14112
    v_mfma_f32_16x16x32_bf16 v[40:43], v[104:107], v[56:59], v[40:43]
    ds_read_b128 v[76:79], v4 offset:2944
    v_mfma_f32_16x16x32_bf16 v[44:47], v[104:107], v[60:63], v[44:47]
    s_waitcnt lgkmcnt(8)
    v_mfma_f32_16x16x32_bf16 v[28:31], v[108:111], v[48:51], v[28:31]
    ds_read_b64 v[104:105], v5 offset:12032
    v_mfma_f32_16x16x32_bf16 v[32:35], v[108:111], v[52:55], v[32:35]
    ds_read_b64 v[106:107], v5 offset:12064
    v_mfma_f32_16x16x32_bf16 v[36:39], v[108:111], v[56:59], v[36:39]
    v_mfma_f32_16x16x32_bf16 v[40:43], v[108:111], v[60:63], v[40:43]
    v_mfma_f32_16x16x32_bf16 v[44:47], v[108:111], v[64:67], v[44:47]
    s_waitcnt lgkmcnt(3)
    v_mfma_f32_16x16x32_bf16 v[20:23], v[100:103], v[48:51], v[20:23]
    ds_read_b64 v[108:109], v5 offset:15872
    v_mfma_f32_16x16x32_bf16 v[24:27], v[100:103], v[52:55], v[24:27]
    ds_read_b64 v[110:111], v5 offset:15904
    v_mfma_f32_16x16x32_bf16 v[28:31], v[100:103], v[56:59], v[28:31]
    v_mfma_f32_16x16x32_bf16 v[32:35], v[100:103], v[60:63], v[32:35]
    v_mfma_f32_16x16x32_bf16 v[36:39], v[100:103], v[64:67], v[36:39]
    v_mfma_f32_16x16x32_bf16 v[40:43], v[100:103], v[68:71], v[40:43]
    v_mfma_f32_16x16x32_bf16 v[44:47], v[100:103], v[72:75], v[44:47]
    s_waitcnt lgkmcnt(2)
    v_mfma_f32_16x16x32_bf16 v[24:27], v[104:107], v[48:51], v[24:27]
    ds_read_b64 v[100:101], v5 offset:9728
    v_mfma_f32_16x16x32_bf16 v[28:31], v[104:107], v[52:55], v[28:31]
    ds_read_b64 v[102:103], v5 offset:9760
    v_mfma_f32_16x16x32_bf16 v[32:35], v[104:107], v[56:59], v[32:35]
    ds_read_b128 v[72:75], v4 offset:3456
    v_mfma_f32_16x16x32_bf16 v[36:39], v[104:107], v[60:63], v[36:39]
    v_mfma_f32_16x16x32_bf16 v[40:43], v[104:107], v[64:67], v[40:43]
    v_mfma_f32_16x16x32_bf16 v[44:47], v[104:107], v[68:71], v[44:47]
    s_waitcnt lgkmcnt(3)
    v_mfma_f32_16x16x32_bf16 v[16:19], v[108:111], v[80:83], v[16:19]
    ds_read_b128 v[48:51], v4 offset:3968
    v_mfma_f32_16x16x32_bf16 v[20:23], v[108:111], v[84:87], v[20:23]
    ds_read_b64 v[104:105], v5 offset:13824
    v_mfma_f32_16x16x32_bf16 v[24:27], v[108:111], v[88:91], v[24:27]
    ds_read_b64 v[106:107], v5 offset:13856
    v_mfma_f32_16x16x32_bf16 v[28:31], v[108:111], v[92:95], v[28:31]
    ds_read_b128 v[52:55], v4 offset:320
    v_mfma_f32_16x16x32_bf16 v[32:35], v[108:111], v[96:99], v[32:35]
    ds_read_b128 v[56:59], v4 offset:832
    v_mfma_f32_16x16x32_bf16 v[36:39], v[108:111], v[76:79], v[36:39]
    ds_read_b128 v[60:63], v4 offset:1344
    s_waitcnt lgkmcnt(6)
    v_mfma_f32_16x16x32_bf16 v[40:43], v[108:111], v[72:75], v[40:43]
    ds_read_b128 v[64:67], v4 offset:1856
    s_waitcnt lgkmcnt(6)
    v_mfma_f32_16x16x32_bf16 v[44:47], v[108:111], v[48:51], v[44:47]
    ds_read_b128 v[68:71], v4 offset:2368
    v_mfma_f32_16x16x32_bf16 v[28:31], v[100:103], v[80:83], v[28:31]
    ds_read_b64 v[108:109], v5 offset:11776
    v_mfma_f32_16x16x32_bf16 v[32:35], v[100:103], v[84:87], v[32:35]
    ds_read_b64 v[110:111], v5 offset:11808
    v_mfma_f32_16x16x32_bf16 v[36:39], v[100:103], v[88:91], v[36:39]
    ds_read_b128 v[48:51], v4 offset:2880
    v_mfma_f32_16x16x32_bf16 v[40:43], v[100:103], v[92:95], v[40:43]
    s_lshl_b32 s90, s85, 10
    v_mfma_f32_16x16x32_bf16 v[44:47], v[100:103], v[96:99], v[44:47]
    s_add_u32 s90, s90, 116832
    s_waitcnt lgkmcnt(8)
    v_mfma_f32_16x16x32_bf16 v[20:23], v[104:107], v[80:83], v[20:23]
    ds_read_b64 v[100:101], v5 offset:15616
    v_mfma_f32_16x16x32_bf16 v[24:27], v[104:107], v[84:87], v[24:27]
    ds_read_b64 v[102:103], v5 offset:15648
    v_mfma_f32_16x16x32_bf16 v[28:31], v[104:107], v[88:91], v[28:31]
    v_add_u32 v126, s90, v2
    v_mfma_f32_16x16x32_bf16 v[32:35], v[104:107], v[92:95], v[32:35]
    ds_read_b128 v[122:125], v126
    v_mfma_f32_16x16x32_bf16 v[36:39], v[104:107], v[96:99], v[36:39]
    s_mul_i32 s90, s85, 240
    v_mfma_f32_16x16x32_bf16 v[40:43], v[104:107], v[76:79], v[40:43]
    s_add_u32 s90, s90, 432
    v_mfma_f32_16x16x32_bf16 v[44:47], v[104:107], v[72:75], v[44:47]
    v_add_u32 v126, s90, v4
    s_waitcnt lgkmcnt(4)
    v_mfma_f32_16x16x32_bf16 v[24:27], v[108:111], v[80:83], v[24:27]
    ds_read_b64 v[104:105], v5 offset:9472
    v_mfma_f32_16x16x32_bf16 v[28:31], v[108:111], v[84:87], v[28:31]
    ds_read_b64 v[106:107], v5 offset:9504
    v_mfma_f32_16x16x32_bf16 v[32:35], v[108:111], v[88:91], v[32:35]
    ds_read_b128 v[72:75], v4 offset:3392
    v_mfma_f32_16x16x32_bf16 v[36:39], v[108:111], v[92:95], v[36:39]
    s_mul_i32 s90, s85, 1792
    v_mfma_f32_16x16x32_bf16 v[40:43], v[108:111], v[96:99], v[40:43]
    v_lshrrev_b32 v127, 4, v1
    v_mfma_f32_16x16x32_bf16 v[44:47], v[108:111], v[76:79], v[44:47]
    v_lshlrev_b32 v127, 5, v127
    s_waitcnt lgkmcnt(4)
    v_mfma_f32_16x16x32_bf16 v[16:19], v[100:103], v[52:55], v[16:19]
    ds_read_b128 v[80:83], v4 offset:3904
    v_mfma_f32_16x16x32_bf16 v[20:23], v[100:103], v[56:59], v[20:23]
    ds_read_b64 v[108:109], v5 offset:13568
    v_mfma_f32_16x16x32_bf16 v[24:27], v[100:103], v[60:63], v[24:27]
    ds_read_b64 v[110:111], v5 offset:13600
    v_mfma_f32_16x16x32_bf16 v[28:31], v[100:103], v[64:67], v[28:31]
    ds_read_b128 v[84:87], v4 offset:256
    v_mfma_f32_16x16x32_bf16 v[32:35], v[100:103], v[68:71], v[32:35]
    ds_read_b128 v[88:91], v4 offset:768
    v_mfma_f32_16x16x32_bf16 v[36:39], v[100:103], v[48:51], v[36:39]
    ds_read_b128 v[92:95], v4 offset:1280
    s_waitcnt lgkmcnt(6)
    v_mfma_f32_16x16x32_bf16 v[40:43], v[100:103], v[72:75], v[40:43]
    ds_read_b128 v[96:99], v4 offset:1792
    s_waitcnt lgkmcnt(6)
    v_mfma_f32_16x16x32_bf16 v[44:47], v[100:103], v[80:83], v[44:47]
    ds_read_b128 v[76:79], v4 offset:2304
    v_mfma_f32_16x16x32_bf16 v[28:31], v[104:107], v[52:55], v[28:31]
    ds_read_b64 v[100:101], v5 offset:11520
    v_mfma_f32_16x16x32_bf16 v[32:35], v[104:107], v[56:59], v[32:35]
    ds_read_b64 v[102:103], v5 offset:11552
    v_mfma_f32_16x16x32_bf16 v[36:39], v[104:107], v[60:63], v[36:39]
    ds_read_b128 v[80:83], v4 offset:2816
    v_mfma_f32_16x16x32_bf16 v[40:43], v[104:107], v[64:67], v[40:43]
    v_sub_u32 v127, v5, v127
    v_mfma_f32_16x16x32_bf16 v[44:47], v[104:107], v[68:71], v[44:47]
    v_add_u32 v127, s90, v127
    s_waitcnt lgkmcnt(8)
    v_mfma_f32_16x16x32_bf16 v[20:23], v[108:111], v[52:55], v[20:23]
    ds_read_b64 v[104:105], v5 offset:15360
    v_mfma_f32_16x16x32_bf16 v[24:27], v[108:111], v[56:59], v[24:27]
    ds_read_b64 v[106:107], v5 offset:15392
    v_mfma_f32_16x16x32_bf16 v[28:31], v[108:111], v[60:63], v[28:31]
    v_mfma_f32_16x16x32_bf16 v[32:35], v[108:111], v[64:67], v[32:35]
    v_mfma_f32_16x16x32_bf16 v[36:39], v[108:111], v[68:71], v[36:39]
    v_mfma_f32_16x16x32_bf16 v[40:43], v[108:111], v[48:51], v[40:43]
    v_mfma_f32_16x16x32_bf16 v[44:47], v[108:111], v[72:75], v[44:47]
    s_waitcnt lgkmcnt(3)
    v_mfma_f32_16x16x32_bf16 v[24:27], v[100:103], v[52:55], v[24:27]
    ds_read_b64 v[108:109], v5 offset:9216
    v_mfma_f32_16x16x32_bf16 v[28:31], v[100:103], v[56:59], v[28:31]
    ds_read_b64 v[110:111], v5 offset:9248
    v_mfma_f32_16x16x32_bf16 v[32:35], v[100:103], v[60:63], v[32:35]
    ds_read_b128 v[72:75], v4 offset:3328
    v_mfma_f32_16x16x32_bf16 v[36:39], v[100:103], v[64:67], v[36:39]
    v_mfma_f32_16x16x32_bf16 v[40:43], v[100:103], v[68:71], v[40:43]
    v_mfma_f32_16x16x32_bf16 v[44:47], v[100:103], v[48:51], v[44:47]
    s_waitcnt lgkmcnt(3)
    v_mfma_f32_16x16x32_bf16 v[16:19], v[104:107], v[84:87], v[16:19]
    ds_read_b128 v[52:55], v4 offset:3840
    v_mfma_f32_16x16x32_bf16 v[20:23], v[104:107], v[88:91], v[20:23]
    ds_read_b64 v[100:101], v5 offset:13312
    v_mfma_f32_16x16x32_bf16 v[24:27], v[104:107], v[92:95], v[24:27]
    ds_read_b64 v[102:103], v5 offset:13344
    v_mfma_f32_16x16x32_bf16 v[28:31], v[104:107], v[96:99], v[28:31]
    ds_read_b128 v[56:59], v126 offset:0
    v_mfma_f32_16x16x32_bf16 v[32:35], v[104:107], v[76:79], v[32:35]
    ds_read_b128 v[60:63], v126 offset:512
    v_mfma_f32_16x16x32_bf16 v[36:39], v[104:107], v[80:83], v[36:39]
    ds_read_b128 v[64:67], v126 offset:1024
    s_waitcnt lgkmcnt(6)
    v_mfma_f32_16x16x32_bf16 v[40:43], v[104:107], v[72:75], v[40:43]
    ds_read_b128 v[68:71], v126 offset:1536
    s_waitcnt lgkmcnt(6)
    v_mfma_f32_16x16x32_bf16 v[44:47], v[104:107], v[52:55], v[44:47]
    ds_read_b64 v[112:113], v127 offset:32
    s_waitcnt lgkmcnt(3)
    v_mfma_f32_16x16x32_bf16 v[48:51], v[56:59], v[122:125], 0
    ds_read_b64 v[104:105], v5 offset:11264
    v_mfma_f32_16x16x32_bf16 v[52:55], v[60:63], v[122:125], 0
    ds_read_b64 v[106:107], v5 offset:11296
    v_mfma_f32_16x16x32_bf16 v[28:31], v[108:111], v[84:87], v[28:31]
    ds_read_b64 v[114:115], v127 offset:160
    v_mfma_f32_16x16x32_bf16 v[32:35], v[108:111], v[88:91], v[32:35]
    ds_read_b64 v[116:117], v127 offset:288
    v_mfma_f32_16x16x32_bf16 v[36:39], v[108:111], v[92:95], v[36:39]
    ds_read_b64 v[118:119], v127 offset:416
    v_mfma_f32_16x16x32_bf16 v[40:43], v[108:111], v[96:99], v[40:43]
    ds_read_b64 v[120:121], v127 offset:544
    v_mfma_f32_16x16x32_bf16 v[44:47], v[108:111], v[76:79], v[44:47]
    v_mfma_f32_16x16x32_bf16 v[20:23], v[100:103], v[84:87], v[20:23]
    v_cvt_pk_bf16_f32 v56, v48, v49
    v_mfma_f32_16x16x32_bf16 v[24:27], v[100:103], v[88:91], v[24:27]
    v_cvt_pk_bf16_f32 v57, v50, v51
    v_mfma_f32_16x16x32_bf16 v[28:31], v[100:103], v[92:95], v[28:31]
    v_cvt_pk_bf16_f32 v58, v52, v53
    v_cvt_pk_bf16_f32 v59, v54, v55
    s_waitcnt lgkmcnt(7)
    v_mfma_f32_16x16x32_bf16 v[48:51], v[64:67], v[122:125], 0
    v_mfma_f32_16x16x32_bf16 v[52:55], v[68:71], v[122:125], 0
    v_mfma_f32_16x16x32_bf16 v[32:35], v[100:103], v[96:99], v[32:35]
    v_mfma_f32_16x16x32_bf16 v[36:39], v[100:103], v[76:79], v[36:39]
    v_mfma_f32_16x16x32_bf16 v[40:43], v[100:103], v[80:83], v[40:43]
    v_mfma_f32_16x16x32_bf16 v[44:47], v[100:103], v[72:75], v[44:47]
    s_waitcnt lgkmcnt(4)
    v_mfma_f32_16x16x32_bf16 v[24:27], v[104:107], v[84:87], v[24:27]
    s_nop 0
    v_cvt_pk_bf16_f32 v60, v48, v49
    v_mfma_f32_16x16x32_bf16 v[28:31], v[104:107], v[88:91], v[28:31]
    v_cvt_pk_bf16_f32 v61, v50, v51
    v_mfma_f32_16x16x32_bf16 v[32:35], v[104:107], v[92:95], v[32:35]
    v_cvt_pk_bf16_f32 v62, v52, v53
    v_mfma_f32_16x16x32_bf16 v[36:39], v[104:107], v[96:99], v[36:39]
    v_cvt_pk_bf16_f32 v63, v54, v55
    v_mfma_f32_16x16x32_bf16 v[40:43], v[104:107], v[76:79], v[40:43]
    v_mfma_f32_16x16x32_bf16 v[44:47], v[104:107], v[80:83], v[44:47]
    s_waitcnt lgkmcnt(0)
    v_mfma_f32_16x16x32_bf16 v[32:35], v[56:59], v[118:121], v[32:35]
    v_mfma_f32_16x16x32_bf16 v[36:39], v[56:59], v[116:119], v[36:39]
    v_mfma_f32_16x16x32_bf16 v[40:43], v[56:59], v[114:117], v[40:43]
    v_mfma_f32_16x16x32_bf16 v[44:47], v[56:59], v[112:115], v[44:47]
    v_mfma_f32_16x16x32_bf16 v[40:43], v[60:63], v[118:121], v[40:43]
    v_mfma_f32_16x16x32_bf16 v[44:47], v[60:63], v[116:119], v[44:47]
    s_cmp_eq_u32 s85, 0
    s_cbranch_scc0 Lc_110
    s_nop 0
    ds_write_b128 v6, v[32:35] offset:0
    ds_write_b128 v6, v[36:39] offset:1024
    s_nop 1
    ds_write_b128 v6, v[40:43] offset:4096
    ds_write_b128 v6, v[44:47] offset:5120
    s_waitcnt lgkmcnt(0)
    s_barrier
    ds_read_b128 v[48:51], v7 offset:0
    ds_read_b128 v[52:55], v7 offset:1024
    ds_read_b128 v[56:59], v7 offset:4096
    ds_read_b128 v[60:63], v7 offset:5120
    s_waitcnt lgkmcnt(3)
    v_pk_add_f32 v[48:49], v[48:49], v[16:17]
    v_pk_add_f32 v[50:51], v[50:51], v[18:19]
    s_waitcnt lgkmcnt(2)
    v_pk_add_f32 v[52:53], v[52:53], v[20:21]
    v_pk_add_f32 v[54:55], v[54:55], v[22:23]
    s_waitcnt lgkmcnt(1)
    v_pk_add_f32 v[56:57], v[56:57], v[24:25]
    v_pk_add_f32 v[58:59], v[58:59], v[26:27]
    s_waitcnt lgkmcnt(0)
    v_pk_add_f32 v[60:61], v[60:61], v[28:29]
    v_pk_add_f32 v[62:63], v[62:63], v[30:31]
    s_branch Lc_111
Lc_110:
    ds_write_b128 v6, v[16:19] offset:0
    ds_write_b128 v6, v[20:23] offset:1024
    ds_write_b128 v6, v[24:27] offset:4096
    ds_write_b128 v6, v[28:31] offset:5120
    s_waitcnt lgkmcnt(0)
    s_barrier
    ds_read_b128 v[48:51], v7 offset:0
    ds_read_b128 v[52:55], v7 offset:1024
    ds_read_b128 v[56:59], v7 offset:4096
    ds_read_b128 v[60:63], v7 offset:5120
    s_waitcnt lgkmcnt(3)
    v_pk_add_f32 v[48:49], v[48:49], v[32:33]
    v_pk_add_f32 v[50:51], v[50:51], v[34:35]
    s_waitcnt lgkmcnt(2)
    v_pk_add_f32 v[52:53], v[52:53], v[36:37]
    v_pk_add_f32 v[54:55], v[54:55], v[38:39]
    s_waitcnt lgkmcnt(1)
    v_pk_add_f32 v[56:57], v[56:57], v[40:41]
    v_pk_add_f32 v[58:59], v[58:59], v[42:43]
    s_waitcnt lgkmcnt(0)
    v_pk_add_f32 v[60:61], v[60:61], v[44:45]
    v_pk_add_f32 v[62:63], v[62:63], v[46:47]
Lc_111:
    v_cvt_pk_bf16_f32 v64, v48, v49
    v_cvt_pk_bf16_f32 v65, v50, v51
    v_cvt_pk_bf16_f32 v66, v52, v53
    v_cvt_pk_bf16_f32 v67, v54, v55
    v_cvt_pk_bf16_f32 v68, v56, v57
    v_cvt_pk_bf16_f32 v69, v58, v59
    v_cvt_pk_bf16_f32 v70, v60, v61
    v_cvt_pk_bf16_f32 v71, v62, v63
    v_permlane16_swap_b32 v64, v66
    v_permlane16_swap_b32 v65, v67
    v_permlane16_swap_b32 v68, v70
    v_permlane16_swap_b32 v69, v71
    buffer_store_dwordx4 v[64:67], v8, s[4:7], s86 offen sc1
    buffer_store_dwordx4 v[68:71], v8, s[4:7], s86 offen offset:1024 sc1
    s_sleep 12
L_norm:
    v_lshrrev_b32 v6, 5, v1
    v_lshlrev_b32 v5, 4, v6
    s_lshl_b32 s72, s62, 7
    s_lshl_b32 s73, s50, 5
    s_add_u32 s72, s72, s73
    v_add_u32 v5, s72, v5
    global_load_dwordx4 v[16:19], v5, s[38:39]
    v_lshlrev_b32 v4, 12, v1
    s_lshl_b32 s72, s50, 18
    s_add_u32 s72, s72, s66
    s_lshl_b32 s73, s59, 4
    s_add_u32 s73, s73, s72
    s_add_u32 s73, s73, 4194304
    s_add_u32 s74, s73, 0x100000
    s_mov_b32 s71, 0
    s_lshl_b32 s75, s59, 9
    s_add_u32 s75, s75, s72
    s_add_u32 s75, s75, 6029312
    s_add_u32 s76, s75, 0x100000
    s_mov_b32 s77, 73728
    v_pk_mov_b32 v[76:77], 0, 0
    v_pk_mov_b32 v[78:79], 0, 0
    v_mov_b32 v20, s56
    v_lshlrev_b32 v6, 17, v6
    v_and_b32 v7, 31, v1
    v_lshl_add_u32 v6, v7, 4, v6
    v_lshlrev_b32 v7, 7, v7
    s_cmp_lt_u32 s58, 28
    s_cbranch_scc1 Lw_113
    s_mov_b64 exec, 1
Lw_112:
    buffer_load_dword v5, v4, s[4:7], s73 offen offset:0 sc1
    s_waitcnt vmcnt(0)
    v_cmp_eq_u32 vcc, -1, v5
    s_cbranch_vccz Lr_114
    s_add_u32 s71, s71, 1
    s_cmp_gt_u32 s71, 32768
    s_cbranch_scc1 Lr_114
    s_sleep 8
    s_branch Lw_112
Lr_114:
    s_mov_b64 exec, -1
Lw_113:
Ln_115:
    buffer_load_dwordx4 v[72:75], v4, s[4:7], s73 offen sc1
    s_cmp_eq_u32 s50, 3
    s_cbranch_scc1 Ln_116
    buffer_load_dwordx4 v[76:79], v4, s[4:7], s74 offen sc1
    s_branch Ln_117
Ln_116:
    buffer_load_dword v20, v7, s[4:7], s77 offen sc1
Ln_117:
    s_waitcnt vmcnt(0)
    v_max_u32 v5, v72, v76
    v_cmp_eq_u32 vcc, -1, v5
    v_cmp_ne_u32 s[82:83], s56, v20
    s_nop 0
    s_or_b64 vcc, vcc, s[82:83]
    s_cbranch_vccz Lr_118
    s_add_u32 s71, s71, 1
    s_cmp_gt_u32 s71, 32768
    s_cbranch_scc1 Lr_118
    s_sleep 1
    s_branch Ln_115
Lr_118:
    v_lshlrev_b32 v32, 16, v72
    v_and_b32 v33, 0xffff0000, v72
    v_lshlrev_b32 v34, 16, v73
    v_and_b32 v35, 0xffff0000, v73
    v_lshlrev_b32 v36, 16, v74
    v_and_b32 v37, 0xffff0000, v74
    v_lshlrev_b32 v38, 16, v75
    v_and_b32 v39, 0xffff0000, v75
    v_lshlrev_b32 v40, 16, v76
    v_and_b32 v41, 0xffff0000, v76
    v_lshlrev_b32 v42, 16, v77
    v_and_b32 v43, 0xffff0000, v77
    v_lshlrev_b32 v44, 16, v78
    v_and_b32 v45, 0xffff0000, v78
    v_lshlrev_b32 v46, 16, v79
    v_and_b32 v47, 0xffff0000, v79
    v_pk_add_f32 v[48:49], v[32:33], v[40:41]
    v_pk_mul_f32 v[56:57], v[32:33], v[32:33]
    v_pk_add_f32 v[50:51], v[34:35], v[42:43]
    v_pk_mul_f32 v[58:59], v[34:35], v[34:35]
    v_pk_add_f32 v[52:53], v[36:37], v[44:45]
    v_pk_mul_f32 v[60:61], v[36:37], v[36:37]
    v_pk_add_f32 v[54:55], v[38:39], v[46:47]
    v_pk_mul_f32 v[62:63], v[38:39], v[38:39]
    v_pk_fma_f32 v[56:57], v[40:41], v[40:41], v[56:57]
    v_pk_fma_f32 v[58:59], v[42:43], v[42:43], v[58:59]
    v_pk_fma_f32 v[60:61], v[44:45], v[44:45], v[60:61]
    v_pk_fma_f32 v[62:63], v[46:47], v[46:47], v[62:63]
    v_add_f32_dpp v64, v48, v48 row_shl:4 row_mask:0xf bank_mask:0x5
    v_add_f32_dpp v65, v50, v50 row_shl:4 row_mask:0xf bank_mask:0x5
    v_add_f32_dpp v66, v52, v52 row_shl:4 row_mask:0xf bank_mask:0x5
    v_add_f32_dpp v67, v54, v54 row_shl:4 row_mask:0xf bank_mask:0x5
    v_add_f32_dpp v68, v56, v56 row_shl:4 row_mask:0xf bank_mask:0x5
    v_add_f32_dpp v69, v58, v58 row_shl:4 row_mask:0xf bank_mask:0x5
    v_add_f32_dpp v70, v60, v60 row_shl:4 row_mask:0xf bank_mask:0x5
    v_add_f32_dpp v71, v62, v62 row_shl:4 row_mask:0xf bank_mask:0x5
    v_add_f32_dpp v64, v49, v49 row_shr:4 row_mask:0xf bank_mask:0xa
    v_add_f32_dpp v65, v51, v51 row_shr:4 row_mask:0xf bank_mask:0xa
    v_add_f32_dpp v66, v53, v53 row_shr:4 row_mask:0xf bank_mask:0xa
    v_add_f32_dpp v67, v55, v55 row_shr:4 row_mask:0xf bank_mask:0xa
    v_add_f32_dpp v68, v57, v57 row_shr:4 row_mask:0xf bank_mask:0xa
    v_add_f32_dpp v69, v59, v59 row_shr:4 row_mask:0xf bank_mask:0xa
    v_add_f32_dpp v70, v61, v61 row_shr:4 row_mask:0xf bank_mask:0xa
    v_add_f32_dpp v71, v63, v63 row_shr:4 row_mask:0xf bank_mask:0xa
    v_add_f32_dpp v48, v64, v64 row_shl:8 row_mask:0xf bank_mask:0x3
    v_add_f32_dpp v49, v66, v66 row_shl:8 row_mask:0xf bank_mask:0x3
    v_add_f32_dpp v50, v68, v68 row_shl:8 row_mask:0xf bank_mask:0x3
    v_add_f32_dpp v51, v70, v70 row_shl:8 row_mask:0xf bank_mask:0x3
    v_add_f32_dpp v48, v65, v65 row_shr:8 row_mask:0xf bank_mask:0xc
    v_add_f32_dpp v49, v67, v67 row_shr:8 row_mask:0xf bank_mask:0xc
    v_add_f32_dpp v50, v69, v69 row_shr:8 row_mask:0xf bank_mask:0xc
    v_add_f32_dpp v51, v71, v71 row_shr:8 row_mask:0xf bank_mask:0xc
    v_permlane16_swap_b32 v48, v49
    s_nop 0
    v_permlane16_swap_b32 v50, v51
    v_add_f32 v64, v48, v49
    v_add_f32 v66, v50, v51
    s_nop 1
    v_permlane32_swap_b32 v64, v66
    v_add_f32 v64, v64, v66
    s_nop 1
    v_add_f32_dpp v64, v64, v64 quad_perm:[1,0,3,2] row_mask:0xf bank_mask:0xf
    s_nop 1
    v_add_f32_dpp v64, v64, v64 quad_perm:[2,3,0,1] row_mask:0xf bank_mask:0xf
    s_lshl_b32 s72, s50, 2
    s_add_u32 s72, s72, 135872
    v_lshrrev_b32 v5, 2, v1
    v_lshl_add_u32 v5, v5, 4, s72
    ds_write_b32 v5, v64
    v_and_b32 v5, 7, v1
    v_lshlrev_b32 v5, 4, v5
    v_add_u32 v5, 135872, v5
    s_waitcnt lgkmcnt(0)
    s_barrier
    ds_read_b128 v[48:51], v5
    ds_read_b128 v[52:55], v5 offset:128
    s_waitcnt lgkmcnt(0)
    v_add_f32 v48, v48, v49
    v_add_f32 v52, v52, v53
    v_add_f32 v50, v50, v51
    v_add_f32 v54, v54, v55
    v_add_f32 v48, v48, v50
    v_add_f32 v52, v52, v54
    v_mul_f32 v48, 0x3b124925, v48
    v_mul_f32 v52, 0x3b124925, v52
    v_fma_f32 v52, -v48, v48, v52
    v_max_f32 v52, 0, v52
    v_add_f32 v49, 0x3727c5ac, v52
    v_rsq_f32 v49, v49
    v_sub_f32 v48, 0, v48
    v_mov_b32 v51, 0x3727c5ac
    v_mul_f32 v50, v49, v49
    v_fma_f32 v50, v52, v50, v51
    v_rsq_f32 v50, v50
    v_readlane_b32 s84, v48, 0
    v_readlane_b32 s85, v48, 1
    v_readlane_b32 s86, v48, 2
    v_readlane_b32 s87, v48, 3
    v_readlane_b32 s88, v48, 4
    v_readlane_b32 s89, v48, 5
    v_readlane_b32 s90, v48, 6
    v_readlane_b32 s91, v48, 7
    v_mul_f32 v49, v49, v50
    v_pk_add_f32 v[32:33], v[32:33], s[84:85]
    v_pk_add_f32 v[34:35], v[34:35], s[86:87]
    v_pk_add_f32 v[36:37], v[36:37], s[88:89]
    v_pk_add_f32 v[38:39], v[38:39], s[90:91]
    v_pk_add_f32 v[40:41], v[40:41], s[84:85]
    v_pk_add_f32 v[42:43], v[42:43], s[86:87]
    v_pk_add_f32 v[44:45], v[44:45], s[88:89]
    v_pk_add_f32 v[46:47], v[46:47], s[90:91]
    v_readlane_b32 s92, v49, 0
    v_readlane_b32 s93, v49, 1
    v_readlane_b32 s94, v49, 2
    v_readlane_b32 s95, v49, 3
    v_readlane_b32 s96, v49, 4
    v_readlane_b32 s97, v49, 5
    v_readlane_b32 s98, v49, 6
    v_readlane_b32 s99, v49, 7
    v_pk_mul_f32 v[32:33], v[32:33], s[92:93]
    v_pk_mul_f32 v[34:35], v[34:35], s[94:95]
    v_pk_mul_f32 v[36:37], v[36:37], s[96:97]
    v_pk_mul_f32 v[38:39], v[38:39], s[98:99]
    v_cvt_pk_bf16_f32 v72, v32, v33
    v_cvt_pk_bf16_f32 v73, v34, v35
    v_cvt_pk_bf16_f32 v74, v36, v37
    v_cvt_pk_bf16_f32 v75, v38, v39
    buffer_store_dwordx4 v[72:75], v6, s[4:7], s75 offen sc1
    s_cmp_eq_u32 s50, 3
    s_cbranch_scc1 Ln_119
    v_pk_mul_f32 v[40:41], v[40:41], s[92:93]
    v_pk_mul_f32 v[42:43], v[42:43], s[94:95]
    v_pk_mul_f32 v[44:45], v[44:45], s[96:97]
    v_pk_mul_f32 v[46:47], v[46:47], s[98:99]
    v_cvt_pk_bf16_f32 v76, v40, v41
    v_cvt_pk_bf16_f32 v77, v42, v43
    v_cvt_pk_bf16_f32 v78, v44, v45
    v_cvt_pk_bf16_f32 v79, v46, v47
    buffer_store_dwordx4 v[76:79], v6, s[4:7], s76 offen sc1
Ln_119:
    s_cmp_ge_u32 s58, 28
    s_cbranch_scc1 L_helper2
    v_lshrrev_b32 v8, 5, v1
    v_lshlrev_b32 v8, 3, v8
    v_bfe_u32 v9, v1, 2, 2
    v_add_u32 v8, v8, v9
    v_lshlrev_b32 v8, 7, v8
    s_mul_i32 s78, s50, 24576
    v_add_u32 v8, s78, v8
    v_and_b32 v9, 1, v1
    v_lshlrev_b32 v9, 4, v9
    v_bfe_u32 v10, v1, 1, 1
    v_lshl_add_u32 v9, v10, 3, v9
    v_add_u32 v8, v8, v9
    v_bfe_u32 v9, v1, 4, 1
    v_add_u32 v9, s50, v9
    v_bfe_u32 v10, v1, 3, 1
    v_lshl_add_u32 v9, v10, 1, v9
    v_and_b32 v9, 3, v9
    v_lshl_add_u32 v6, v9, 5, v8
    v_xor_b32 v9, 2, v9
    v_lshl_add_u32 v7, v9, 5, v8
    s_add_u32 s76, s50, 1
    s_and_b32 s76, s76, 3
    s_mul_i32 s76, s76, 6144
    s_add_u32 s76, s76, 139264
    v_add_u32 v8, s76, v2
    s_add_u32 s76, s50, 2
    s_and_b32 s76, s76, 3
    s_mul_i32 s76, s76, 6144
    s_add_u32 s76, s76, 141312
    v_add_u32 v9, s76, v2
    s_add_u32 s76, s50, 3
    s_and_b32 s76, s76, 3
    s_mul_i32 s76, s76, 6144
    s_add_u32 s76, s76, 143360
    v_add_u32 v10, s76, v2
    s_mul_i32 s76, s50, 6144
    s_add_u32 s76, s76, 139264
    v_add_u32 v11, s76, v2
    s_cmp_eq_u32 s61, 0
    s_cbranch_scc1 Lm_120
    s_mov_b32 s71, 0
    s_mul_i32 s72, s63, 262144
    s_mul_i32 s73, s50, 32768
    s_add_u32 s72, s72, s73
    s_add_u32 s72, s72, s66
    s_add_u32 s72, s72, 6029312
    v_and_b32 v23, 0xffff0000, v19
    v_lshlrev_b32 v22, 16, v19
    v_and_b32 v21, 0xffff0000, v18
    v_lshlrev_b32 v20, 16, v18
    v_and_b32 v19, 0xffff0000, v17
    v_lshlrev_b32 v18, 16, v17
    v_and_b32 v17, 0xffff0000, v16
    v_lshlrev_b32 v16, 16, v16
    v_pk_mov_b32 v[48:49], v[16:17], v[16:17] op_sel:[0,1]
    v_pk_mov_b32 v[50:51], v[18:19], v[18:19] op_sel:[0,1]
    v_pk_mov_b32 v[52:53], v[20:21], v[20:21] op_sel:[0,1]
    v_pk_mov_b32 v[54:55], v[22:23], v[22:23] op_sel:[0,1]
    v_pk_mov_b32 v[24:25], 0, 0
    v_pk_mov_b32 v[26:27], 0, 0
    v_pk_mov_b32 v[28:29], 0, 0
    v_pk_mov_b32 v[30:31], 0, 0
    v_pk_mov_b32 v[56:57], 0, 0
    v_pk_mov_b32 v[58:59], 0, 0
    v_pk_mov_b32 v[60:61], 0, 0
    v_pk_mov_b32 v[62:63], 0, 0
    s_mov_b32 s80, 0xbdd2d3e8
    s_mov_b32 s81, 0xc0135761
    v_mov_b32 v4, s80
    s_mul_i32 s77, s63, 229376
    s_lshl_b32 s76, s62, 2
    s_add_u32 s76, s76, s50
    s_lshl_b32 s76, s76, 10
    s_add_u32 s77, s77, s76
    s_add_u32 s77, s77, s66
    s_add_u32 s77, s77, 7864320
    s_add_u32 s78, s77, 114688
    s_sleep 8
    s_add_u32 s73, s72, 0
    buffer_load_dwordx4 v[80:83], v2, s[4:7], s73 offen offset:0 sc1
    buffer_load_dwordx4 v[84:87], v2, s[4:7], s73 offen offset:1024 sc1
    buffer_load_dwordx4 v[88:91], v2, s[4:7], s73 offen offset:2048 sc1
    buffer_load_dwordx4 v[92:95], v2, s[4:7], s73 offen offset:3072 sc1
    s_add_u32 s73, s72, 4096
    buffer_load_dwordx4 v[96:99], v2, s[4:7], s73 offen offset:0 sc1
    buffer_load_dwordx4 v[100:103], v2, s[4:7], s73 offen offset:1024 sc1
    buffer_load_dwordx4 v[104:107], v2, s[4:7], s73 offen offset:2048 sc1
    buffer_load_dwordx4 v[108:111], v2, s[4:7], s73 offen offset:3072 sc1
    s_add_u32 s73, s72, 8192
    buffer_load_dwordx4 v[112:115], v2, s[4:7], s73 offen offset:0 sc1
    buffer_load_dwordx4 v[116:119], v2, s[4:7], s73 offen offset:1024 sc1
    buffer_load_dwordx4 v[120:123], v2, s[4:7], s73 offen offset:2048 sc1
    buffer_load_dwordx4 v[124:127], v2, s[4:7], s73 offen offset:3072 sc1
    s_add_u32 s73, s72, 12288
    buffer_load_dwordx4 v[64:67], v2, s[4:7], s73 offen offset:0 sc1
    buffer_load_dwordx4 v[68:71], v2, s[4:7], s73 offen offset:1024 sc1
    buffer_load_dwordx4 v[72:75], v2, s[4:7], s73 offen offset:2048 sc1
    buffer_load_dwordx4 v[76:79], v2, s[4:7], s73 offen offset:3072 sc1
    s_waitcnt vmcnt(12)
    v_max3_u32 v5, v80, v84, v88
    v_max_u32 v5, v5, v92
    v_cmp_eq_u32 vcc, -1, v5
    s_cbranch_vccnz Ls_122
Lq_121:
    v_mfma_f32_32x32x16_bf16 v[16:31], a[0:3], v[80:83], v[16:31]
    v_mfma_f32_32x32x16_bf16 v[32:47], a[4:7], v[80:83], 0
    s_add_u32 s73, s72, 16384
    buffer_load_dwordx4 v[80:83], v2, s[4:7], s73 offen offset:0 sc1
    v_mfma_f32_32x32x16_bf16 v[16:31], a[8:11], v[84:87], v[16:31]
    v_mfma_f32_32x32x16_bf16 v[32:47], a[12:15], v[84:87], v[32:47]
    buffer_load_dwordx4 v[84:87], v2, s[4:7], s73 offen offset:1024 sc1
    v_mfma_f32_32x32x16_bf16 v[16:31], a[16:19], v[88:91], v[16:31]
    v_mfma_f32_32x32x16_bf16 v[32:47], a[20:23], v[88:91], v[32:47]
    buffer_load_dwordx4 v[88:91], v2, s[4:7], s73 offen offset:2048 sc1
    s_waitcnt vmcnt(11)
    v_max3_u32 v5, v96, v100, v104
    v_max_u32 v5, v5, v108
    v_cmp_eq_u32 vcc, -1, v5
    v_mfma_f32_32x32x16_bf16 v[16:31], a[24:27], v[92:95], v[16:31]
    v_mfma_f32_32x32x16_bf16 v[32:47], a[28:31], v[92:95], v[32:47]
    buffer_load_dwordx4 v[92:95], v2, s[4:7], s73 offen offset:3072 sc1
    s_cbranch_vccnz Ls_124
Lq_123:
    v_mfma_f32_32x32x16_bf16 v[16:31], a[32:35], v[96:99], v[16:31]
    v_mfma_f32_32x32x16_bf16 v[32:47], a[36:39], v[96:99], v[32:47]
    s_add_u32 s73, s72, 20480
    buffer_load_dwordx4 v[96:99], v2, s[4:7], s73 offen offset:0 sc1
    v_mfma_f32_32x32x16_bf16 v[16:31], a[40:43], v[100:103], v[16:31]
    v_mfma_f32_32x32x16_bf16 v[32:47], a[44:47], v[100:103], v[32:47]
    buffer_load_dwordx4 v[100:103], v2, s[4:7], s73 offen offset:1024 sc1
    v_mfma_f32_32x32x16_bf16 v[16:31], a[48:51], v[104:107], v[16:31]
    v_mfma_f32_32x32x16_bf16 v[32:47], a[52:55], v[104:107], v[32:47]
    buffer_load_dwordx4 v[104:107], v2, s[4:7], s73 offen offset:2048 sc1
    s_waitcnt vmcnt(11)
    v_max3_u32 v5, v112, v116, v120
    v_max_u32 v5, v5, v124
    v_cmp_eq_u32 vcc, -1, v5
    v_mfma_f32_32x32x16_bf16 v[16:31], a[56:59], v[108:111], v[16:31]
    v_mfma_f32_32x32x16_bf16 v[32:47], a[60:63], v[108:111], v[32:47]
    buffer_load_dwordx4 v[108:111], v2, s[4:7], s73 offen offset:3072 sc1
    s_cbranch_vccnz Ls_126
Lq_125:
    v_mfma_f32_32x32x16_bf16 v[16:31], a[64:67], v[112:115], v[16:31]
    v_mfma_f32_32x32x16_bf16 v[32:47], a[68:71], v[112:115], v[32:47]
    s_add_u32 s73, s72, 24576
    buffer_load_dwordx4 v[112:115], v2, s[4:7], s73 offen offset:0 sc1
    v_mfma_f32_32x32x16_bf16 v[16:31], a[72:75], v[116:119], v[16:31]
    v_mfma_f32_32x32x16_bf16 v[32:47], a[76:79], v[116:119], v[32:47]
    buffer_load_dwordx4 v[116:119], v2, s[4:7], s73 offen offset:1024 sc1
    v_mfma_f32_32x32x16_bf16 v[16:31], a[80:83], v[120:123], v[16:31]
    v_mfma_f32_32x32x16_bf16 v[32:47], a[84:87], v[120:123], v[32:47]
    buffer_load_dwordx4 v[120:123], v2, s[4:7], s73 offen offset:2048 sc1
    s_waitcnt vmcnt(11)
    v_max3_u32 v5, v64, v68, v72
    v_max_u32 v5, v5, v76
    v_cmp_eq_u32 vcc, -1, v5
    v_mfma_f32_32x32x16_bf16 v[16:31], a[88:91], v[124:127], v[16:31]
    v_mfma_f32_32x32x16_bf16 v[32:47], a[92:95], v[124:127], v[32:47]
    buffer_load_dwordx4 v[124:127], v2, s[4:7], s73 offen offset:3072 sc1
    s_cbranch_vccnz Ls_128
Lq_127:
    v_mfma_f32_32x32x16_bf16 v[16:31], a[96:99], v[64:67], v[16:31]
    v_mfma_f32_32x32x16_bf16 v[32:47], a[100:103], v[64:67], v[32:47]
    s_add_u32 s73, s72, 28672
    buffer_load_dwordx4 v[64:67], v2, s[4:7], s73 offen offset:0 sc1
    v_mfma_f32_32x32x16_bf16 v[16:31], a[104:107], v[68:71], v[16:31]
    v_mfma_f32_32x32x16_bf16 v[32:47], a[108:111], v[68:71], v[32:47]
    buffer_load_dwordx4 v[68:71], v2, s[4:7], s73 offen offset:1024 sc1
    v_mfma_f32_32x32x16_bf16 v[16:31], a[112:115], v[72:75], v[16:31]
    v_mfma_f32_32x32x16_bf16 v[32:47], a[116:119], v[72:75], v[32:47]
    buffer_load_dwordx4 v[72:75], v2, s[4:7], s73 offen offset:2048 sc1
    s_waitcnt vmcnt(11)
    v_max3_u32 v5, v80, v84, v88
    v_max_u32 v5, v5, v92
    v_cmp_eq_u32 vcc, -1, v5
    v_mfma_f32_32x32x16_bf16 v[16:31], a[120:123], v[76:79], v[16:31]
    v_mfma_f32_32x32x16_bf16 v[32:47], a[124:127], v[76:79], v[32:47]
    buffer_load_dwordx4 v[76:79], v2, s[4:7], s73 offen offset:3072 sc1
    s_cbranch_vccnz Ls_130
Lq_129:
    v_mfma_f32_32x32x16_bf16 v[16:31], a[128:131], v[80:83], v[16:31]
    v_mfma_f32_32x32x16_bf16 v[32:47], a[132:135], v[80:83], v[32:47]
    s_add_u32 s73, s72, 131072
    buffer_load_dwordx4 v[80:83], v2, s[4:7], s73 offen offset:0 sc1
    v_mfma_f32_32x32x16_bf16 v[16:31], a[136:139], v[84:87], v[16:31]
    v_mfma_f32_32x32x16_bf16 v[32:47], a[140:143], v[84:87], v[32:47]
    buffer_load_dwordx4 v[84:87], v2, s[4:7], s73 offen offset:1024 sc1
    v_mfma_f32_32x32x16_bf16 v[16:31], a[144:147], v[88:91], v[16:31]
    v_mfma_f32_32x32x16_bf16 v[32:47], a[148:151], v[88:91], v[32:47]
    buffer_load_dwordx4 v[88:91], v2, s[4:7], s73 offen offset:2048 sc1
    s_waitcnt vmcnt(11)
    v_max3_u32 v5, v96, v100, v104
    v_max_u32 v5, v5, v108
    v_cmp_eq_u32 vcc, -1, v5
    v_mfma_f32_32x32x16_bf16 v[16:31], a[152:155], v[92:95], v[16:31]
    v_mfma_f32_32x32x16_bf16 v[32:47], a[156:159], v[92:95], v[32:47]
    buffer_load_dwordx4 v[92:95], v2, s[4:7], s73 offen offset:3072 sc1
    s_cbranch_vccnz Ls_132
Lq_131:
    v_mfma_f32_32x32x16_bf16 v[16:31], a[160:163], v[96:99], v[16:31]
    v_mfma_f32_32x32x16_bf16 v[32:47], a[164:167], v[96:99], v[32:47]
    s_add_u32 s73, s72, 135168
    buffer_load_dwordx4 v[96:99], v2, s[4:7], s73 offen offset:0 sc1
    v_mfma_f32_32x32x16_bf16 v[16:31], a[168:171], v[100:103], v[16:31]
    v_mfma_f32_32x32x16_bf16 v[32:47], a[172:175], v[100:103], v[32:47]
    buffer_load_dwordx4 v[100:103], v2, s[4:7], s73 offen offset:1024 sc1
    v_mfma_f32_32x32x16_bf16 v[16:31], a[176:179], v[104:107], v[16:31]
    v_mfma_f32_32x32x16_bf16 v[32:47], a[180:183], v[104:107], v[32:47]
    buffer_load_dwordx4 v[104:107], v2, s[4:7], s73 offen offset:2048 sc1
    s_waitcnt vmcnt(11)
    v_max3_u32 v5, v112, v116, v120
    v_max_u32 v5, v5, v124
    v_cmp_eq_u32 vcc, -1, v5
    v_mfma_f32_32x32x16_bf16 v[16:31], a[184:187], v[108:111], v[16:31]
    v_mfma_f32_32x32x16_bf16 v[32:47], a[188:191], v[108:111], v[32:47]
    buffer_load_dwordx4 v[108:111], v2, s[4:7], s73 offen offset:3072 sc1
    s_cbranch_vccnz Ls_134
Lq_133:
    v_mfma_f32_32x32x16_bf16 v[16:31], a[192:195], v[112:115], v[16:31]
    v_mfma_f32_32x32x16_bf16 v[32:47], a[196:199], v[112:115], v[32:47]
    s_add_u32 s73, s72, 139264
    buffer_load_dwordx4 v[112:115], v2, s[4:7], s73 offen offset:0 sc1
    v_mfma_f32_32x32x16_bf16 v[16:31], a[200:203], v[116:119], v[16:31]
    v_mfma_f32_32x32x16_bf16 v[32:47], a[204:207], v[116:119], v[32:47]
    buffer_load_dwordx4 v[116:119], v2, s[4:7], s73 offen offset:1024 sc1
    v_mfma_f32_32x32x16_bf16 v[16:31], a[208:211], v[120:123], v[16:31]
    v_mfma_f32_32x32x16_bf16 v[32:47], a[212:215], v[120:123], v[32:47]
    buffer_load_dwordx4 v[120:123], v2, s[4:7], s73 offen offset:2048 sc1
    s_waitcnt vmcnt(11)
    v_max3_u32 v5, v64, v68, v72
    v_max_u32 v5, v5, v76
    v_cmp_eq_u32 vcc, -1, v5
    v_mfma_f32_32x32x16_bf16 v[16:31], a[216:219], v[124:127], v[16:31]
    v_mfma_f32_32x32x16_bf16 v[32:47], a[220:223], v[124:127], v[32:47]
    buffer_load_dwordx4 v[124:127], v2, s[4:7], s73 offen offset:3072 sc1
    s_cbranch_vccnz Ls_136
Lq_135:
    v_mfma_f32_32x32x16_bf16 v[16:31], a[224:227], v[64:67], v[16:31]
    v_mfma_f32_32x32x16_bf16 v[32:47], a[228:231], v[64:67], v[32:47]
    v_mfma_f32_32x32x16_bf16 v[16:31], a[232:235], v[68:71], v[16:31]
    v_mfma_f32_32x32x16_bf16 v[32:47], a[236:239], v[68:71], v[32:47]
    v_mfma_f32_32x32x16_bf16 v[16:31], a[240:243], v[72:75], v[16:31]
    v_mfma_f32_32x32x16_bf16 v[32:47], a[244:247], v[72:75], v[32:47]
    s_waitcnt vmcnt(8)
    v_max3_u32 v5, v80, v84, v88
    v_max_u32 v5, v5, v92
    v_cmp_eq_u32 vcc, -1, v5
    v_mfma_f32_32x32x16_bf16 v[16:31], a[248:251], v[76:79], v[16:31]
    v_mfma_f32_32x32x16_bf16 v[32:47], a[252:255], v[76:79], v[32:47]
    s_cbranch_vccnz Ls_138
Lq_137:
    v_mfma_f32_32x32x16_bf16 v[48:63], a[0:3], v[80:83], v[48:63]
    v_mfma_f32_32x32x16_bf16 v[64:79], a[4:7], v[80:83], 0
    s_add_u32 s73, s72, 143360
    buffer_load_dwordx4 v[80:83], v2, s[4:7], s73 offen offset:0 sc1
    v_mfma_f32_32x32x16_bf16 v[48:63], a[8:11], v[84:87], v[48:63]
    s_nop 4
    ds_write_b128 v8, v[24:27] offset:0
    v_mfma_f32_32x32x16_bf16 v[64:79], a[12:15], v[84:87], v[64:79]
    ds_write_b128 v8, v[28:31] offset:1024
    buffer_load_dwordx4 v[84:87], v2, s[4:7], s73 offen offset:1024 sc1
    v_mfma_f32_32x32x16_bf16 v[48:63], a[16:19], v[88:91], v[48:63]
    ds_write_b128 v9, v[32:35] offset:0
    v_mfma_f32_32x32x16_bf16 v[64:79], a[20:23], v[88:91], v[64:79]
    ds_write_b128 v9, v[36:39] offset:1024
    buffer_load_dwordx4 v[88:91], v2, s[4:7], s73 offen offset:2048 sc1
    s_waitcnt vmcnt(7)
    v_max3_u32 v5, v96, v100, v104
    v_max_u32 v5, v5, v108
    v_cmp_eq_u32 vcc, -1, v5
    v_mfma_f32_32x32x16_bf16 v[48:63], a[24:27], v[92:95], v[48:63]
    ds_write_b128 v10, v[40:43] offset:0
    v_mfma_f32_32x32x16_bf16 v[64:79], a[28:31], v[92:95], v[64:79]
    ds_write_b128 v10, v[44:47] offset:1024
    buffer_load_dwordx4 v[92:95], v2, s[4:7], s73 offen offset:3072 sc1
    s_cbranch_vccnz Ls_140
Lq_139:
    v_mfma_f32_32x32x16_bf16 v[48:63], a[32:35], v[96:99], v[48:63]
    v_mfma_f32_32x32x16_bf16 v[64:79], a[36:39], v[96:99], v[64:79]
    s_add_u32 s73, s72, 147456
    buffer_load_dwordx4 v[96:99], v2, s[4:7], s73 offen offset:0 sc1
    v_mfma_f32_32x32x16_bf16 v[48:63], a[40:43], v[100:103], v[48:63]
    v_mfma_f32_32x32x16_bf16 v[64:79], a[44:47], v[100:103], v[64:79]
    buffer_load_dwordx4 v[100:103], v2, s[4:7], s73 offen offset:1024 sc1
    v_mfma_f32_32x32x16_bf16 v[48:63], a[48:51], v[104:107], v[48:63]
    v_mfma_f32_32x32x16_bf16 v[64:79], a[52:55], v[104:107], v[64:79]
    buffer_load_dwordx4 v[104:107], v2, s[4:7], s73 offen offset:2048 sc1
    s_waitcnt lgkmcnt(0)
    s_barrier
    buffer_load_dwordx4 v[32:35], v2, s[4:7], s73 offen offset:3072 sc1
    s_add_u32 s73, s72, 151552
    buffer_load_dwordx4 v[36:39], v2, s[4:7], s73 offen offset:0 sc1
    buffer_load_dwordx4 v[40:43], v2, s[4:7], s73 offen offset:1024 sc1
    buffer_load_dwordx4 v[44:47], v2, s[4:7], s73 offen offset:2048 sc1
    s_waitcnt vmcnt(11)
    v_max3_u32 v5, v112, v116, v120
    v_max_u32 v5, v5, v124
    v_cmp_eq_u32 vcc, -1, v5
    v_mfma_f32_32x32x16_bf16 v[48:63], a[56:59], v[108:111], v[48:63]
    ds_read_b128 v[24:27], v11 offset:0
    ds_read_b128 v[28:31], v11 offset:1024
    v_mfma_f32_32x32x16_bf16 v[64:79], a[60:63], v[108:111], v[64:79]
    buffer_load_dwordx4 v[108:111], v2, s[4:7], s73 offen offset:3072 sc1
    s_cbranch_vccnz Ls_142
Lq_141:
    v_mfma_f32_32x32x16_bf16 v[48:63], a[64:67], v[112:115], v[48:63]
    v_mfma_f32_32x32x16_bf16 v[64:79], a[68:71], v[112:115], v[64:79]
    s_waitcnt lgkmcnt(0)
    v_add_f32 v16, v16, v24
    v_add_f32 v17, v17, v25
    s_add_u32 s73, s72, 155648
    buffer_load_dwordx4 v[112:115], v2, s[4:7], s73 offen offset:0 sc1
    v_mfma_f32_32x32x16_bf16 v[48:63], a[72:75], v[116:119], v[48:63]
    v_add_f32 v18, v18, v26
    v_add_f32 v19, v19, v27
    v_add_f32 v20, v20, v28
    v_mfma_f32_32x32x16_bf16 v[64:79], a[76:79], v[116:119], v[64:79]
    v_add_f32 v21, v21, v29
    v_add_f32 v22, v22, v30
    buffer_load_dwordx4 v[116:119], v2, s[4:7], s73 offen offset:1024 sc1
    v_mfma_f32_32x32x16_bf16 v[48:63], a[80:83], v[120:123], v[48:63]
    v_add_f32 v23, v23, v31
    ds_read_b128 v[24:27], v11 offset:2048
    ds_read_b128 v[28:31], v11 offset:3072
    v_mfma_f32_32x32x16_bf16 v[64:79], a[84:87], v[120:123], v[64:79]
    buffer_load_dwordx4 v[120:123], v2, s[4:7], s73 offen offset:2048 sc1
    s_waitcnt vmcnt(11)
    v_max3_u32 v5, v80, v84, v88
    v_max_u32 v5, v5, v92
    v_cmp_eq_u32 vcc, -1, v5
    v_mfma_f32_32x32x16_bf16 v[48:63], a[88:91], v[124:127], v[48:63]
    v_mfma_f32_32x32x16_bf16 v[64:79], a[92:95], v[124:127], v[64:79]
    buffer_load_dwordx4 v[124:127], v2, s[4:7], s73 offen offset:3072 sc1
    s_cbranch_vccnz Ls_144
Lq_143:
    v_mfma_f32_32x32x16_bf16 v[48:63], a[96:99], v[80:83], v[48:63]
    s_waitcnt lgkmcnt(0)
    v_add_f32 v16, v16, v24
    v_add_f32 v17, v17, v25
    v_add_f32 v18, v18, v26
    v_mfma_f32_32x32x16_bf16 v[64:79], a[100:103], v[80:83], v[64:79]
    v_add_f32 v19, v19, v27
    v_add_f32 v20, v20, v28
    s_add_u32 s73, s72, 159744
    buffer_load_dwordx4 v[80:83], v2, s[4:7], s73 offen offset:0 sc1
    v_mfma_f32_32x32x16_bf16 v[48:63], a[104:107], v[84:87], v[48:63]
    v_add_f32 v21, v21, v29
    v_add_f32 v22, v22, v30
    v_add_f32 v23, v23, v31
    v_mfma_f32_32x32x16_bf16 v[64:79], a[108:111], v[84:87], v[64:79]
    ds_read_b128 v[24:27], v11 offset:4096
    ds_read_b128 v[28:31], v11 offset:5120
    buffer_load_dwordx4 v[84:87], v2, s[4:7], s73 offen offset:1024 sc1
    v_mfma_f32_32x32x16_bf16 v[48:63], a[112:115], v[88:91], v[48:63]
    v_mfma_f32_32x32x16_bf16 v[64:79], a[116:119], v[88:91], v[64:79]
    buffer_load_dwordx4 v[88:91], v2, s[4:7], s73 offen offset:2048 sc1
    s_waitcnt vmcnt(11)
    v_max3_u32 v5, v96, v100, v104
    v_max_u32 v5, v5, v32
    v_cmp_eq_u32 vcc, -1, v5
    v_mfma_f32_32x32x16_bf16 v[48:63], a[120:123], v[92:95], v[48:63]
    v_mfma_f32_32x32x16_bf16 v[64:79], a[124:127], v[92:95], v[64:79]
    s_waitcnt lgkmcnt(0)
    v_add_f32 v16, v16, v24
    v_add_f32 v17, v17, v25
    buffer_load_dwordx4 v[92:95], v2, s[4:7], s73 offen offset:3072 sc1
    s_cbranch_vccnz Ls_146
Lq_145:
    v_mfma_f32_32x32x16_bf16 v[48:63], a[128:131], v[96:99], v[48:63]
    v_add_f32 v18, v18, v26
    v_add_f32 v19, v19, v27
    v_add_f32 v20, v20, v28
    v_mfma_f32_32x32x16_bf16 v[64:79], a[132:135], v[96:99], v[64:79]
    v_add_f32 v21, v21, v29
    v_add_f32 v22, v22, v30
    v_mfma_f32_32x32x16_bf16 v[48:63], a[136:139], v[100:103], v[48:63]
    v_add_f32 v23, v23, v31
    v_mul_f32 v24, v16, v16
    v_mul_f32 v25, v17, v17
    v_mfma_f32_32x32x16_bf16 v[64:79], a[140:143], v[100:103], v[64:79]
    v_mul_f32 v26, v18, v18
    v_mul_f32 v27, v19, v19
    v_mfma_f32_32x32x16_bf16 v[48:63], a[144:147], v[104:107], v[48:63]
    v_mul_f32 v28, v20, v20
    v_mul_f32 v29, v21, v21
    v_mul_f32 v30, v22, v22
    v_mfma_f32_32x32x16_bf16 v[64:79], a[148:151], v[104:107], v[64:79]
    v_mul_f32 v31, v23, v23
    v_fma_f32 v24, v24, v4, s81
    s_waitcnt vmcnt(8)
    v_max3_u32 v5, v36, v40, v44
    v_max_u32 v5, v5, v108
    v_cmp_eq_u32 vcc, -1, v5
    v_mfma_f32_32x32x16_bf16 v[48:63], a[152:155], v[32:35], v[48:63]
    v_fma_f32 v25, v25, v4, s81
    v_fma_f32 v26, v26, v4, s81
    v_fma_f32 v27, v27, v4, s81
    v_mfma_f32_32x32x16_bf16 v[64:79], a[156:159], v[32:35], v[64:79]
    v_fma_f32 v28, v28, v4, s81
    v_fma_f32 v29, v29, v4, s81
    s_cbranch_vccnz Ls_148
Lq_147:
    v_mfma_f32_32x32x16_bf16 v[48:63], a[160:163], v[36:39], v[48:63]
    v_fma_f32 v30, v30, v4, s81
    v_fma_f32 v31, v31, v4, s81
    v_mul_f32 v24, v24, v16
    v_mfma_f32_32x32x16_bf16 v[64:79], a[164:167], v[36:39], v[64:79]
    v_mul_f32 v25, v25, v17
    v_mul_f32 v26, v26, v18
    v_mfma_f32_32x32x16_bf16 v[48:63], a[168:171], v[40:43], v[48:63]
    v_mul_f32 v27, v27, v19
    v_mul_f32 v28, v28, v20
    v_mul_f32 v29, v29, v21
    v_mfma_f32_32x32x16_bf16 v[64:79], a[172:175], v[40:43], v[64:79]
    v_mul_f32 v30, v30, v22
    v_mul_f32 v31, v31, v23
    v_mfma_f32_32x32x16_bf16 v[48:63], a[176:179], v[44:47], v[48:63]
    v_exp_f32 v24, v24
    v_mfma_f32_32x32x16_bf16 v[64:79], a[180:183], v[44:47], v[64:79]
    v_exp_f32 v25, v25
    s_waitcnt vmcnt(4)
    v_max3_u32 v5, v112, v116, v120
    v_max_u32 v5, v5, v124
    v_cmp_eq_u32 vcc, -1, v5
    v_mfma_f32_32x32x16_bf16 v[48:63], a[184:187], v[108:111], v[48:63]
    v_exp_f32 v26, v26
    v_mfma_f32_32x32x16_bf16 v[64:79], a[188:191], v[108:111], v[64:79]
    v_exp_f32 v27, v27
    v_lshrrev_b32 v12, 5, v1
    v_lshlrev_b32 v12, 4, v12
    s_lshl_b32 s84, s64, 7
    s_lshl_b32 s85, s50, 5
    s_add_u32 s84, s84, s85
    v_add_u32 v15, s84, v12
    global_load_dwordx4 v[96:99], v15, s[42:43]
    v_and_b32 v12, 31, v1
    v_lshl_add_u32 v15, v12, 12, v15
    s_lshl_b32 s84, s65, 18
    s_add_u32 s84, s84, s66
    s_add_u32 s84, s84, 4194304
    s_add_u32 s85, s84, 0x20000
    v_lshlrev_b32 v12, 7, v12
    s_mov_b32 s86, 81920
    buffer_load_dword v108, v12, s[4:7], s86 offen sc1
    buffer_load_dwordx4 v[100:103], v15, s[4:7], s84 offen sc1
    buffer_load_dwordx4 v[104:107], v15, s[4:7], s85 offen sc1
    s_cbranch_vccnz Ls_150
Lq_149:
    v_mfma_f32_32x32x16_bf16 v[48:63], a[192:195], v[112:115], v[48:63]
    v_exp_f32 v28, v28
    v_mfma_f32_32x32x16_bf16 v[64:79], a[196:199], v[112:115], v[64:79]
    v_exp_f32 v29, v29
    v_mfma_f32_32x32x16_bf16 v[48:63], a[200:203], v[116:119], v[48:63]
    v_exp_f32 v30, v30
    v_mfma_f32_32x32x16_bf16 v[64:79], a[204:207], v[116:119], v[64:79]
    v_exp_f32 v31, v31
    v_mfma_f32_32x32x16_bf16 v[48:63], a[208:211], v[120:123], v[48:63]
    v_add_f32 v24, 1.0, v24
    v_add_f32 v25, 1.0, v25
    v_add_f32 v26, 1.0, v26
    v_mfma_f32_32x32x16_bf16 v[64:79], a[212:215], v[120:123], v[64:79]
    v_add_f32 v27, 1.0, v27
    v_add_f32 v28, 1.0, v28
    s_waitcnt vmcnt(4)
    v_max3_u32 v5, v80, v84, v88
    v_max_u32 v5, v5, v92
    v_cmp_eq_u32 vcc, -1, v5
    v_mfma_f32_32x32x16_bf16 v[48:63], a[216:219], v[124:127], v[48:63]
    v_add_f32 v29, 1.0, v29
    v_add_f32 v30, 1.0, v30
    v_add_f32 v31, 1.0, v31
    v_mfma_f32_32x32x16_bf16 v[64:79], a[220:223], v[124:127], v[64:79]
    v_rcp_f32 v24, v24
    s_cbranch_vccnz Ls_152
Lq_151:
    v_rcp_f32 v25, v25
    v_rcp_f32 v26, v26
    v_rcp_f32 v27, v27
    v_rcp_f32 v28, v28
    v_rcp_f32 v29, v29
    v_rcp_f32 v30, v30
    v_rcp_f32 v31, v31
    v_mul_f32 v16, v16, v24
    v_mul_f32 v17, v17, v25
    v_mul_f32 v18, v18, v26
    v_mul_f32 v19, v19, v27
    v_mul_f32 v20, v20, v28
    v_mul_f32 v21, v21, v29
    v_mul_f32 v22, v22, v30
    v_mul_f32 v23, v23, v31
    v_cvt_pk_bf16_f32 v24, v16, v17
    v_cvt_pk_bf16_f32 v25, v18, v19
    v_cvt_pk_bf16_f32 v26, v20, v21
    v_cvt_pk_bf16_f32 v27, v22, v23
    buffer_store_dwordx4 v[24:27], v2, s[4:7], s77 offen sc1
    s_barrier
    v_mfma_f32_32x32x16_bf16 v[64:79], a[228:231], v[80:83], v[64:79]
    v_mfma_f32_32x32x16_bf16 v[64:79], a[236:239], v[84:87], v[64:79]
    v_mfma_f32_32x32x16_bf16 v[64:79], a[244:247], v[88:91], v[64:79]
    v_mfma_f32_32x32x16_bf16 v[64:79], a[252:255], v[92:95], v[64:79]
    v_mfma_f32_32x32x16_bf16 v[48:63], a[224:227], v[80:83], v[48:63]
    v_mfma_f32_32x32x16_bf16 v[48:63], a[232:235], v[84:87], v[48:63]
    v_mfma_f32_32x32x16_bf16 v[48:63], a[240:243], v[88:91], v[48:63]
    s_nop 8
    ds_write_b128 v9, v[64:67] offset:0
    ds_write_b128 v9, v[68:71] offset:1024
    v_mfma_f32_32x32x16_bf16 v[48:63], a[248:251], v[92:95], v[48:63]
    ds_write_b128 v10, v[72:75] offset:0
    ds_write_b128 v10, v[76:79] offset:1024
    s_nop 9
    ds_write_b128 v8, v[56:59] offset:0
    ds_write_b128 v8, v[60:63] offset:1024
    s_waitcnt lgkmcnt(0)
    s_barrier
    ds_read_b128 v[56:59], v11 offset:0
    ds_read_b128 v[60:63], v11 offset:1024
    ds_read_b128 v[64:67], v11 offset:2048
    ds_read_b128 v[68:71], v11 offset:3072
    ds_read_b128 v[72:75], v11 offset:4096
    ds_read_b128 v[76:79], v11 offset:5120
    s_waitcnt lgkmcnt(4)
    v_pk_add_f32 v[48:49], v[48:49], v[56:57]
    v_pk_add_f32 v[50:51], v[50:51], v[58:59]
    v_pk_add_f32 v[52:53], v[52:53], v[60:61]
    v_pk_add_f32 v[54:55], v[54:55], v[62:63]
    s_waitcnt lgkmcnt(2)
    v_pk_add_f32 v[48:49], v[48:49], v[64:65]
    v_pk_add_f32 v[50:51], v[50:51], v[66:67]
    v_pk_add_f32 v[52:53], v[52:53], v[68:69]
    v_pk_add_f32 v[54:55], v[54:55], v[70:71]
    s_waitcnt lgkmcnt(0)
    v_pk_add_f32 v[48:49], v[48:49], v[72:73]
    v_pk_add_f32 v[50:51], v[50:51], v[74:75]
    v_pk_add_f32 v[52:53], v[52:53], v[76:77]
    v_pk_add_f32 v[54:55], v[54:55], v[78:79]
    v_pk_mul_f32 v[56:57], v[48:49], v[48:49]
    v_pk_mul_f32 v[58:59], v[50:51], v[50:51]
    v_pk_mul_f32 v[60:61], v[52:53], v[52:53]
    v_pk_mul_f32 v[62:63], v[54:55], v[54:55]
    v_pk_fma_f32 v[56:57], v[56:57], s[80:81], s[80:81] op_sel:[0,0,1] op_sel_hi:[1,0,1]
    v_pk_fma_f32 v[58:59], v[58:59], s[80:81], s[80:81] op_sel:[0,0,1] op_sel_hi:[1,0,1]
    v_pk_fma_f32 v[60:61], v[60:61], s[80:81], s[80:81] op_sel:[0,0,1] op_sel_hi:[1,0,1]
    v_pk_fma_f32 v[62:63], v[62:63], s[80:81], s[80:81] op_sel:[0,0,1] op_sel_hi:[1,0,1]
    v_pk_mul_f32 v[56:57], v[56:57], v[48:49]
    v_pk_mul_f32 v[58:59], v[58:59], v[50:51]
    v_pk_mul_f32 v[60:61], v[60:61], v[52:53]
    v_pk_mul_f32 v[62:63], v[62:63], v[54:55]
    v_exp_f32 v56, v56
    v_exp_f32 v57, v57
    v_exp_f32 v58, v58
    v_exp_f32 v59, v59
    v_exp_f32 v60, v60
    v_exp_f32 v61, v61
    v_exp_f32 v62, v62
    v_exp_f32 v63, v63
    v_pk_add_f32 v[56:57], v[56:57], 1.0 op_sel_hi:[1,0]
    v_pk_add_f32 v[58:59], v[58:59], 1.0 op_sel_hi:[1,0]
    v_pk_add_f32 v[60:61], v[60:61], 1.0 op_sel_hi:[1,0]
    v_pk_add_f32 v[62:63], v[62:63], 1.0 op_sel_hi:[1,0]
    v_rcp_f32 v56, v56
    v_rcp_f32 v57, v57
    v_rcp_f32 v58, v58
    v_rcp_f32 v59, v59
    v_rcp_f32 v60, v60
    v_rcp_f32 v61, v61
    v_rcp_f32 v62, v62
    v_rcp_f32 v63, v63
    v_pk_mul_f32 v[48:49], v[48:49], v[56:57]
    v_pk_mul_f32 v[50:51], v[50:51], v[58:59]
    v_pk_mul_f32 v[52:53], v[52:53], v[60:61]
    v_pk_mul_f32 v[54:55], v[54:55], v[62:63]
    v_cvt_pk_bf16_f32 v56, v48, v49
    v_cvt_pk_bf16_f32 v57, v50, v51
    v_cvt_pk_bf16_f32 v58, v52, v53
    v_cvt_pk_bf16_f32 v59, v54, v55
    buffer_store_dwordx4 v[56:59], v2, s[4:7], s78 offen sc1
    s_waitcnt vmcnt(2)
    s_branch L_g2
Lm_120:
    v_lshrrev_b32 v12, 5, v1
    v_lshlrev_b32 v12, 4, v12
    s_lshl_b32 s84, s64, 7
    s_lshl_b32 s85, s50, 5
    s_add_u32 s84, s84, s85
    v_add_u32 v15, s84, v12
    global_load_dwordx4 v[96:99], v15, s[42:43]
    v_and_b32 v12, 31, v1
    v_lshl_add_u32 v15, v12, 12, v15
    s_lshl_b32 s84, s65, 18
    s_add_u32 s84, s84, s66
    s_add_u32 s84, s84, 4194304
    s_add_u32 s85, s84, 0x20000
    v_lshlrev_b32 v12, 7, v12
    s_mov_b32 s86, 81920
    buffer_load_dword v108, v12, s[4:7], s86 offen sc1
    buffer_load_dwordx4 v[100:103], v15, s[4:7], s84 offen sc1
    buffer_load_dwordx4 v[104:107], v15, s[4:7], s85 offen sc1
    s_waitcnt vmcnt(0)
    s_branch L_g2
L_helper2:
    s_cmp_lg_u32 s51, 0
    s_cbranch_scc1 L_fin
    s_lshl_b32 s72, s59, 12
    s_add_u32 s72, s72, 7864320
    s_mov_b32 s71, 0
    s_mov_b64 exec, 1
Lw_153:
    buffer_load_dword v5, v2, s[4:7], s72 offen offset:0 sc1
    s_waitcnt vmcnt(0)
    v_cmp_eq_u32 vcc, -1, v5
    s_cbranch_vccz Lr_155
    s_add_u32 s71, s71, 1
    s_cmp_gt_u32 s71, 32768
    s_cbranch_scc1 Lr_155
    s_sleep 16
    s_branch Lw_153
Lr_155:
    s_mov_b64 exec, -1
Lw_154:
    s_lshl_b32 s77, s57, 2
    s_add_u32 s77, s77, s58
    s_sub_u32 s77, s77, 28
    v_pk_mov_b32 v[8:9], -1, -1
    v_pk_mov_b32 v[10:11], -1, -1
    v_lshlrev_b32 v7, 4, v0
    s_mul_i32 s75, s77, 172032
    s_add_u32 s75, s75, 11304960
    s_mov_b32 s76, 14
Lf_156:
    buffer_store_dwordx4 v[8:11], v7, s[4:7], s75 offen sc1
    s_add_u32 s75, s75, 4096
    buffer_store_dwordx4 v[8:11], v7, s[4:7], s75 offen sc1
    s_add_u32 s75, s75, 4096
    buffer_store_dwordx4 v[8:11], v7, s[4:7], s75 offen sc1
    s_add_u32 s75, s75, 4096
    s_sub_u32 s76, s76, 1
    s_cmp_lg_u32 s76, 0
    s_cbranch_scc1 Lf_156
    s_waitcnt vmcnt(0)
    s_barrier
    s_cmp_lg_u32 s50, 0
    s_cbranch_scc1 Lf_157
    s_lshl_b32 s72, s77, 7
    s_add_u32 s72, s72, 90112
    v_mov_b32 v5, s56
    s_mov_b64 exec, 1
    buffer_store_dword v5, off, s[4:7], s72 sc1
    s_mov_b64 exec, -1
Lf_157:
    s_mov_b32 s51, 1
    s_mov_b32 s66, 7110656
    s_mov_b32 s68, 9469952
    s_mov_b32 s69, 1114112
    s_mov_b32 s67, 0x40e00000
    s_mov_b32 s44, 24
    s_lshl_b32 s72, s59, 7
    s_add_u32 s72, s72, 1114112
    s_mov_b32 s71, 0
    s_mov_b64 exec, 1
Lw_158:
    buffer_load_dword v5, v2, s[4:7], s72 offen offset:8 sc1
    s_waitcnt vmcnt(0)
    v_cmp_ne_u32 vcc, s67, v5
    s_cbranch_vccz Lr_160
    s_add_u32 s71, s71, 1
    s_cmp_gt_u32 s71, 32768
    s_cbranch_scc1 Lr_160
    s_sleep 16
    s_branch Lw_158
Lr_160:
    s_mov_b64 exec, -1
Lw_159:
    v_and_b32 v4, 31, v1
    v_lshlrev_b32 v4, 7, v4
    s_mov_b32 s72, 90112
Lf_161:
    buffer_load_dword v5, v4, s[4:7], s72 offen sc1
    s_waitcnt vmcnt(0)
    v_cmp_ne_u32 vcc, s56, v5
    s_cbranch_vccz Lr_162
    s_add_u32 s71, s71, 1
    s_cmp_gt_u32 s71, 32768
    s_cbranch_scc1 Lr_162
    s_sleep 4
    s_branch Lf_161
Lr_162:
    s_barrier
    s_branch L_norm
L_helper:
    s_mul_i32 s72, s59, 7168
    s_lshl_b32 s73, s50, 7
    s_add_u32 s72, s72, s73
    s_add_u32 s72, s72, 3584
    v_lshl_add_u32 v4, v1, 1, s72
    global_load_short_d16_hi v32, v4, s[16:17] offset:-3584
    global_load_short_d16_hi v33, v4, s[16:17] offset:-2688
    global_load_short_d16_hi v34, v4, s[16:17] offset:-1792
    global_load_short_d16_hi v35, v4, s[16:17] offset:-896
    global_load_short_d16_hi v36, v4, s[16:17] offset:0
    global_load_short_d16_hi v37, v4, s[16:17] offset:896
    global_load_short_d16_hi v38, v4, s[16:17] offset:1792
    global_load_short_d16_hi v39, v4, s[16:17] offset:2688
    v_mov_b32 v40, 0
    v_mov_b32 v41, 0
    v_mov_b32 v42, 0
    v_mov_b32 v43, 0
    v_mov_b32 v44, 0
    v_mov_b32 v45, 0
    v_mov_b32 v46, 0
    v_mov_b32 v47, 0
    s_cmp_eq_u32 s50, 3
    s_cbranch_scc1 Lp_163
    global_load_short_d16_hi v40, v4, s[16:17] offset:-3072
    global_load_short_d16_hi v41, v4, s[16:17] offset:-2176
    global_load_short_d16_hi v42, v4, s[16:17] offset:-1280
    global_load_short_d16_hi v43, v4, s[16:17] offset:-384
    global_load_short_d16_hi v44, v4, s[16:17] offset:512
    global_load_short_d16_hi v45, v4, s[16:17] offset:1408
    global_load_short_d16_hi v46, v4, s[16:17] offset:2304
    global_load_short_d16_hi v47, v4, s[16:17] offset:3200
Lp_163:
    buffer_load_dword v96, off, s[4:7], 0 sc1
    s_waitcnt vmcnt(0)
    v_readfirstlane_b32 s56, v96
    s_mov_b32 s74, 0x07060302
    v_perm_b32 v114, v33, v32, s74
    v_perm_b32 v115, v35, v34, s74
    v_perm_b32 v116, v37, v36, s74
    v_perm_b32 v117, v39, v38, s74
    v_perm_b32 v118, v41, v40, s74
    v_perm_b32 v119, v43, v42, s74
    v_perm_b32 v120, v45, v44, s74
    v_perm_b32 v121, v47, v46, s74
    s_mul_i32 s72, s59, 7168
    s_lshl_b32 s73, s50, 10
    s_add_u32 s72, s72, s73
    s_add_u32 s72, s72, 2097152
    buffer_store_dwordx4 v[114:117], v2, s[4:7], s72 offen sc1
    s_cmp_eq_u32 s50, 3
    s_cbranch_scc1 Lp_164
    s_add_u32 s72, s72, 4096
    buffer_store_dwordx4 v[118:121], v2, s[4:7], s72 offen sc1
Lp_164:
    s_add_u32 s56, s56, 1
    s_mov_b32 s67, s56
    v_pk_add_f32 v[48:49], v[32:33], v[40:41]
    v_pk_mul_f32 v[56:57], v[32:33], v[32:33]
    v_pk_add_f32 v[50:51], v[34:35], v[42:43]
    v_pk_mul_f32 v[58:59], v[34:35], v[34:35]
    v_pk_add_f32 v[52:53], v[36:37], v[44:45]
    v_pk_mul_f32 v[60:61], v[36:37], v[36:37]
    v_pk_add_f32 v[54:55], v[38:39], v[46:47]
    v_pk_mul_f32 v[62:63], v[38:39], v[38:39]
    v_pk_fma_f32 v[56:57], v[40:41], v[40:41], v[56:57]
    v_pk_fma_f32 v[58:59], v[42:43], v[42:43], v[58:59]
    v_pk_fma_f32 v[60:61], v[44:45], v[44:45], v[60:61]
    v_pk_fma_f32 v[62:63], v[46:47], v[46:47], v[62:63]
    v_add_f32_dpp v64, v48, v48 row_shl:4 row_mask:0xf bank_mask:0x5
    v_add_f32_dpp v65, v50, v50 row_shl:4 row_mask:0xf bank_mask:0x5
    v_add_f32_dpp v66, v52, v52 row_shl:4 row_mask:0xf bank_mask:0x5
    v_add_f32_dpp v67, v54, v54 row_shl:4 row_mask:0xf bank_mask:0x5
    v_add_f32_dpp v68, v56, v56 row_shl:4 row_mask:0xf bank_mask:0x5
    v_add_f32_dpp v69, v58, v58 row_shl:4 row_mask:0xf bank_mask:0x5
    v_add_f32_dpp v70, v60, v60 row_shl:4 row_mask:0xf bank_mask:0x5
    v_add_f32_dpp v71, v62, v62 row_shl:4 row_mask:0xf bank_mask:0x5
    v_add_f32_dpp v64, v49, v49 row_shr:4 row_mask:0xf bank_mask:0xa
    v_add_f32_dpp v65, v51, v51 row_shr:4 row_mask:0xf bank_mask:0xa
    v_add_f32_dpp v66, v53, v53 row_shr:4 row_mask:0xf bank_mask:0xa
    v_add_f32_dpp v67, v55, v55 row_shr:4 row_mask:0xf bank_mask:0xa
    v_add_f32_dpp v68, v57, v57 row_shr:4 row_mask:0xf bank_mask:0xa
    v_add_f32_dpp v69, v59, v59 row_shr:4 row_mask:0xf bank_mask:0xa
    v_add_f32_dpp v70, v61, v61 row_shr:4 row_mask:0xf bank_mask:0xa
    v_add_f32_dpp v71, v63, v63 row_shr:4 row_mask:0xf bank_mask:0xa
    v_add_f32_dpp v48, v64, v64 row_shl:8 row_mask:0xf bank_mask:0x3
    v_add_f32_dpp v49, v66, v66 row_shl:8 row_mask:0xf bank_mask:0x3
    v_add_f32_dpp v50, v68, v68 row_shl:8 row_mask:0xf bank_mask:0x3
    v_add_f32_dpp v51, v70, v70 row_shl:8 row_mask:0xf bank_mask:0x3
    v_add_f32_dpp v48, v65, v65 row_shr:8 row_mask:0xf bank_mask:0xc
    v_add_f32_dpp v49, v67, v67 row_shr:8 row_mask:0xf bank_mask:0xc
    v_add_f32_dpp v50, v69, v69 row_shr:8 row_mask:0xf bank_mask:0xc
    v_add_f32_dpp v51, v71, v71 row_shr:8 row_mask:0xf bank_mask:0xc
    v_permlane16_swap_b32 v48, v49
    s_nop 0
    v_permlane16_swap_b32 v50, v51
    v_add_f32 v64, v48, v49
    v_add_f32 v66, v50, v51
    s_nop 1
    v_permlane32_swap_b32 v64, v66
    v_add_f32 v64, v64, v66
    s_nop 1
    v_add_f32_dpp v64, v64, v64 quad_perm:[1,0,3,2] row_mask:0xf bank_mask:0xf
    s_nop 1
    v_add_f32_dpp v64, v64, v64 quad_perm:[2,3,0,1] row_mask:0xf bank_mask:0xf
    s_lshl_b32 s72, s50, 2
    s_add_u32 s72, s72, 135872
    v_lshrrev_b32 v15, 2, v1
    v_lshl_add_u32 v15, v15, 4, s72
    ds_write_b32 v15, v64
    s_waitcnt vmcnt(0) lgkmcnt(0)
    s_barrier
    s_cmp_lg_u32 s50, 3
    s_cbranch_scc1 Lp_165
    v_and_b32 v15, 7, v1
    v_lshlrev_b32 v15, 4, v15
    v_add_u32 v15, 135872, v15
    ds_read_b128 v[114:117], v15
    ds_read_b128 v[118:121], v15 offset:128
    s_waitcnt lgkmcnt(0)
    v_add_f32 v114, v114, v115
    v_add_f32 v118, v118, v119
    v_add_f32 v116, v116, v117
    v_add_f32 v120, v120, v121
    v_add_f32 v114, v114, v116
    v_add_f32 v118, v118, v120
    v_mov_b32 v115, v118
    v_mov_b32 v116, s56
    v_mov_b32 v117, 0
    s_lshl_b32 s72, s59, 7
    s_add_u32 s72, s72, 1048576
    s_mov_b64 exec, 0xff
    buffer_store_dwordx4 v[114:117], v2, s[4:7], s72 offen sc1
    s_mov_b64 exec, -1
Lp_165:
    s_lshl_b32 s75, s57, 2
    s_add_u32 s75, s75, s58
    s_sub_u32 s75, s75, 28
    v_pk_mov_b32 v[12:13], 0, 0
    v_pk_mov_b32 v[14:15], 0, 0
    s_lshl_b32 s75, s75, 10
    s_lshl_b32 s76, s50, 8
    s_add_u32 s75, s75, s76
    s_add_u32 s75, s75, 1114112
    s_mov_b64 exec, 0xffff
    buffer_store_dwordx4 v[12:15], v2, s[4:7], s75 offen sc1
    s_mov_b64 exec, -1
    s_lshl_b32 s77, s57, 2
    s_add_u32 s77, s77, s58
    s_sub_u32 s77, s77, 28
    v_pk_mov_b32 v[8:9], -1, -1
    v_pk_mov_b32 v[10:11], -1, -1
    v_lshlrev_b32 v7, 4, v0
    s_mul_i32 s75, s77, 57344
    s_add_u32 s75, s75, 4194304
    s_mov_b32 s76, 7
Lf_166:
    buffer_store_dwordx4 v[8:11], v7, s[4:7], s75 offen sc1
    s_add_u32 s75, s75, 4096
    buffer_store_dwordx4 v[8:11], v7, s[4:7], s75 offen sc1
    s_add_u32 s75, s75, 4096
    s_sub_u32 s76, s76, 1
    s_cmp_lg_u32 s76, 0
    s_cbranch_scc1 Lf_166
    s_waitcnt vmcnt(0)
    s_barrier
    s_cmp_lg_u32 s50, 0
    s_cbranch_scc1 Lf_167
    s_lshl_b32 s72, s77, 7
    s_add_u32 s72, s72, 65536
    v_mov_b32 v5, s56
    s_mov_b64 exec, 1
    buffer_store_dword v5, off, s[4:7], s72 sc1
    s_mov_b64 exec, -1
Lf_167:
    s_lshl_b32 s77, s57, 2
    s_add_u32 s77, s77, s58
    s_sub_u32 s77, s77, 28
    v_pk_mov_b32 v[8:9], -1, -1
    v_pk_mov_b32 v[10:11], -1, -1
    v_lshlrev_b32 v7, 4, v0
    s_mul_i32 s75, s77, 110592
    s_add_u32 s75, s75, 6029312
    s_mov_b32 s76, 9
Lf_168:
    buffer_store_dwordx4 v[8:11], v7, s[4:7], s75 offen sc1
    s_add_u32 s75, s75, 4096
    buffer_store_dwordx4 v[8:11], v7, s[4:7], s75 offen sc1
    s_add_u32 s75, s75, 4096
    buffer_store_dwordx4 v[8:11], v7, s[4:7], s75 offen sc1
    s_add_u32 s75, s75, 4096
    s_sub_u32 s76, s76, 1
    s_cmp_lg_u32 s76, 0
    s_cbranch_scc1 Lf_168
    s_waitcnt vmcnt(0)
    s_barrier
    s_cmp_lg_u32 s50, 0
    s_cbranch_scc1 Lf_169
    s_lshl_b32 s72, s77, 7
    s_add_u32 s72, s72, 73728
    v_mov_b32 v5, s56
    s_mov_b64 exec, 1
    buffer_store_dword v5, off, s[4:7], s72 sc1
    s_mov_b64 exec, -1
Lf_169:
    s_lshl_b32 s77, s57, 2
    s_add_u32 s77, s77, s58
    s_sub_u32 s77, s77, 28
    v_pk_mov_b32 v[8:9], -1, -1
    v_pk_mov_b32 v[10:11], -1, -1
    v_lshlrev_b32 v7, 4, v0
    s_mul_i32 s75, s77, 57344
    s_add_u32 s75, s75, 9469952
    s_mov_b32 s76, 7
Lf_170:
    buffer_store_dwordx4 v[8:11], v7, s[4:7], s75 offen sc1
    s_add_u32 s75, s75, 4096
    buffer_store_dwordx4 v[8:11], v7, s[4:7], s75 offen sc1
    s_add_u32 s75, s75, 4096
    s_sub_u32 s76, s76, 1
    s_cmp_lg_u32 s76, 0
    s_cbranch_scc1 Lf_170
    s_waitcnt vmcnt(0)
    s_barrier
    s_cmp_lg_u32 s50, 0
    s_cbranch_scc1 Lf_171
    s_lshl_b32 s72, s77, 7
    s_add_u32 s72, s72, 81920
    v_mov_b32 v5, s56
    s_mov_b64 exec, 1
    buffer_store_dword v5, off, s[4:7], s72 sc1
    s_mov_b64 exec, -1
Lf_171:
    v_and_b32 v4, 31, v1
    v_lshlrev_b32 v4, 7, v4
    s_mov_b32 s72, 65536
Lf_172:
    buffer_load_dword v5, v4, s[4:7], s72 offen sc1
    s_waitcnt vmcnt(0)
    v_cmp_ne_u32 vcc, s56, v5
    s_cbranch_vccz Lr_173
    s_add_u32 s71, s71, 1
    s_cmp_gt_u32 s71, 32768
    s_cbranch_scc1 Lr_173
    s_sleep 4
    s_branch Lf_172
Lr_173:
    s_branch L_norm
L_fin:
L_end:
    s_endpgm
Ls_28:
    s_add_u32 s71, s71, 1
    s_cmp_gt_u32 s71, 32768
    s_cbranch_scc1 Lq_27
    s_sleep 1
    s_add_u32 s74, s72, 0
    buffer_load_dwordx4 v[80:83], v2, s[4:7], s74 offen offset:0 sc1
    buffer_load_dwordx4 v[84:87], v2, s[4:7], s74 offen offset:1024 sc1
    buffer_load_dwordx4 v[88:91], v2, s[4:7], s74 offen offset:2048 sc1
    buffer_load_dwordx4 v[92:95], v2, s[4:7], s74 offen offset:3072 sc1
    s_add_u32 s74, s72, 4096
    buffer_load_dwordx4 v[96:99], v2, s[4:7], s74 offen offset:0 sc1
    buffer_load_dwordx4 v[100:103], v2, s[4:7], s74 offen offset:1024 sc1
    buffer_load_dwordx4 v[104:107], v2, s[4:7], s74 offen offset:2048 sc1
    buffer_load_dwordx4 v[108:111], v2, s[4:7], s74 offen offset:3072 sc1
    s_add_u32 s74, s72, 8192
    buffer_load_dwordx4 v[112:115], v2, s[4:7], s74 offen offset:0 sc1
    buffer_load_dwordx4 v[116:119], v2, s[4:7], s74 offen offset:1024 sc1
    buffer_load_dwordx4 v[120:123], v2, s[4:7], s74 offen offset:2048 sc1
    buffer_load_dwordx4 v[124:127], v2, s[4:7], s74 offen offset:3072 sc1
    s_waitcnt vmcnt(0)
    v_max3_u32 v5, v80, v84, v88
    v_max_u32 v5, v5, v92
    v_cmp_eq_u32 vcc, -1, v5
    s_cbranch_vccnz Ls_28
    s_branch Lq_27
Ls_30:
    s_add_u32 s71, s71, 1
    s_cmp_gt_u32 s71, 32768
    s_cbranch_scc1 Lq_29
    s_sleep 1
    s_add_u32 s74, s72, 4096
    buffer_load_dwordx4 v[96:99], v2, s[4:7], s74 offen offset:0 sc1
    buffer_load_dwordx4 v[100:103], v2, s[4:7], s74 offen offset:1024 sc1
    buffer_load_dwordx4 v[104:107], v2, s[4:7], s74 offen offset:2048 sc1
    buffer_load_dwordx4 v[108:111], v2, s[4:7], s74 offen offset:3072 sc1
    s_add_u32 s74, s72, 8192
    buffer_load_dwordx4 v[112:115], v2, s[4:7], s74 offen offset:0 sc1
    buffer_load_dwordx4 v[116:119], v2, s[4:7], s74 offen offset:1024 sc1
    buffer_load_dwordx4 v[120:123], v2, s[4:7], s74 offen offset:2048 sc1
    buffer_load_dwordx4 v[124:127], v2, s[4:7], s74 offen offset:3072 sc1
    s_add_u32 s74, s72, 12288
    buffer_load_dwordx4 v[64:67], v2, s[4:7], s74 offen offset:0 sc1
    buffer_load_dwordx4 v[68:71], v2, s[4:7], s74 offen offset:1024 sc1
    buffer_load_dwordx4 v[72:75], v2, s[4:7], s74 offen offset:2048 sc1
    buffer_load_dwordx4 v[76:79], v2, s[4:7], s74 offen offset:3072 sc1
    s_waitcnt vmcnt(0)
    v_max3_u32 v5, v96, v100, v104
    v_max_u32 v5, v5, v108
    v_cmp_eq_u32 vcc, -1, v5
    s_cbranch_vccnz Ls_30
    s_branch Lq_29
Ls_32:
    s_add_u32 s71, s71, 1
    s_cmp_gt_u32 s71, 32768
    s_cbranch_scc1 Lq_31
    s_sleep 1
    s_add_u32 s74, s72, 8192
    buffer_load_dwordx4 v[112:115], v2, s[4:7], s74 offen offset:0 sc1
    buffer_load_dwordx4 v[116:119], v2, s[4:7], s74 offen offset:1024 sc1
    buffer_load_dwordx4 v[120:123], v2, s[4:7], s74 offen offset:2048 sc1
    buffer_load_dwordx4 v[124:127], v2, s[4:7], s74 offen offset:3072 sc1
    s_add_u32 s74, s72, 12288
    buffer_load_dwordx4 v[64:67], v2, s[4:7], s74 offen offset:0 sc1
    buffer_load_dwordx4 v[68:71], v2, s[4:7], s74 offen offset:1024 sc1
    buffer_load_dwordx4 v[72:75], v2, s[4:7], s74 offen offset:2048 sc1
    buffer_load_dwordx4 v[76:79], v2, s[4:7], s74 offen offset:3072 sc1
    s_add_u32 s74, s72, 16384
    buffer_load_dwordx4 v[80:83], v2, s[4:7], s74 offen offset:0 sc1
    buffer_load_dwordx4 v[84:87], v2, s[4:7], s74 offen offset:1024 sc1
    buffer_load_dwordx4 v[88:91], v2, s[4:7], s74 offen offset:2048 sc1
    buffer_load_dwordx4 v[92:95], v2, s[4:7], s74 offen offset:3072 sc1
    s_waitcnt vmcnt(0)
    v_max3_u32 v5, v112, v116, v120
    v_max_u32 v5, v5, v124
    v_cmp_eq_u32 vcc, -1, v5
    s_cbranch_vccnz Ls_32
    s_branch Lq_31
Ls_34:
    s_add_u32 s71, s71, 1
    s_cmp_gt_u32 s71, 32768
    s_cbranch_scc1 Lq_33
    s_sleep 1
    s_add_u32 s74, s72, 12288
    buffer_load_dwordx4 v[64:67], v2, s[4:7], s74 offen offset:0 sc1
    buffer_load_dwordx4 v[68:71], v2, s[4:7], s74 offen offset:1024 sc1
    buffer_load_dwordx4 v[72:75], v2, s[4:7], s74 offen offset:2048 sc1
    buffer_load_dwordx4 v[76:79], v2, s[4:7], s74 offen offset:3072 sc1
    s_add_u32 s74, s72, 16384
    buffer_load_dwordx4 v[80:83], v2, s[4:7], s74 offen offset:0 sc1
    buffer_load_dwordx4 v[84:87], v2, s[4:7], s74 offen offset:1024 sc1
    buffer_load_dwordx4 v[88:91], v2, s[4:7], s74 offen offset:2048 sc1
    buffer_load_dwordx4 v[92:95], v2, s[4:7], s74 offen offset:3072 sc1
    s_add_u32 s74, s72, 20480
    buffer_load_dwordx4 v[96:99], v2, s[4:7], s74 offen offset:0 sc1
    buffer_load_dwordx4 v[100:103], v2, s[4:7], s74 offen offset:1024 sc1
    buffer_load_dwordx4 v[104:107], v2, s[4:7], s74 offen offset:2048 sc1
    buffer_load_dwordx4 v[108:111], v2, s[4:7], s74 offen offset:3072 sc1
    s_waitcnt vmcnt(0)
    v_max3_u32 v5, v64, v68, v72
    v_max_u32 v5, v5, v76
    v_cmp_eq_u32 vcc, -1, v5
    s_cbranch_vccnz Ls_34
    s_branch Lq_33
Ls_36:
    s_add_u32 s71, s71, 1
    s_cmp_gt_u32 s71, 32768
    s_cbranch_scc1 Lq_35
    s_sleep 1
    s_add_u32 s74, s72, 16384
    buffer_load_dwordx4 v[80:83], v2, s[4:7], s74 offen offset:0 sc1
    buffer_load_dwordx4 v[84:87], v2, s[4:7], s74 offen offset:1024 sc1
    buffer_load_dwordx4 v[88:91], v2, s[4:7], s74 offen offset:2048 sc1
    buffer_load_dwordx4 v[92:95], v2, s[4:7], s74 offen offset:3072 sc1
    s_add_u32 s74, s72, 20480
    buffer_load_dwordx4 v[96:99], v2, s[4:7], s74 offen offset:0 sc1
    buffer_load_dwordx4 v[100:103], v2, s[4:7], s74 offen offset:1024 sc1
    buffer_load_dwordx4 v[104:107], v2, s[4:7], s74 offen offset:2048 sc1
    buffer_load_dwordx4 v[108:111], v2, s[4:7], s74 offen offset:3072 sc1
    s_add_u32 s74, s72, 24576
    buffer_load_dwordx4 v[112:115], v2, s[4:7], s74 offen offset:0 sc1
    buffer_load_dwordx4 v[116:119], v2, s[4:7], s74 offen offset:1024 sc1
    buffer_load_dwordx4 v[120:123], v2, s[4:7], s74 offen offset:2048 sc1
    buffer_load_dwordx4 v[124:127], v2, s[4:7], s74 offen offset:3072 sc1
    s_waitcnt vmcnt(0)
    v_max3_u32 v5, v80, v84, v88
    v_max_u32 v5, v5, v92
    v_cmp_eq_u32 vcc, -1, v5
    s_cbranch_vccnz Ls_36
    s_branch Lq_35
Ls_38:
    s_add_u32 s71, s71, 1
    s_cmp_gt_u32 s71, 32768
    s_cbranch_scc1 Lq_37
    s_sleep 1
    s_add_u32 s74, s72, 20480
    buffer_load_dwordx4 v[96:99], v2, s[4:7], s74 offen offset:0 sc1
    buffer_load_dwordx4 v[100:103], v2, s[4:7], s74 offen offset:1024 sc1
    buffer_load_dwordx4 v[104:107], v2, s[4:7], s74 offen offset:2048 sc1
    buffer_load_dwordx4 v[108:111], v2, s[4:7], s74 offen offset:3072 sc1
    s_add_u32 s74, s72, 24576
    buffer_load_dwordx4 v[112:115], v2, s[4:7], s74 offen offset:0 sc1
    buffer_load_dwordx4 v[116:119], v2, s[4:7], s74 offen offset:1024 sc1
    buffer_load_dwordx4 v[120:123], v2, s[4:7], s74 offen offset:2048 sc1
    buffer_load_dwordx4 v[124:127], v2, s[4:7], s74 offen offset:3072 sc1
    s_add_u32 s74, s72, 28672
    buffer_load_dwordx4 v[64:67], v2, s[4:7], s74 offen offset:0 sc1
    buffer_load_dwordx4 v[68:71], v2, s[4:7], s74 offen offset:1024 sc1
    buffer_load_dwordx4 v[72:75], v2, s[4:7], s74 offen offset:2048 sc1
    buffer_load_dwordx4 v[76:79], v2, s[4:7], s74 offen offset:3072 sc1
    s_waitcnt vmcnt(0)
    v_max3_u32 v5, v96, v100, v104
    v_max_u32 v5, v5, v108
    v_cmp_eq_u32 vcc, -1, v5
    s_cbranch_vccnz Ls_38
    s_branch Lq_37
Ls_40:
    s_add_u32 s71, s71, 1
    s_cmp_gt_u32 s71, 32768
    s_cbranch_scc1 Lq_39
    s_sleep 1
    s_add_u32 s74, s72, 24576
    buffer_load_dwordx4 v[112:115], v2, s[4:7], s74 offen offset:0 sc1
    buffer_load_dwordx4 v[116:119], v2, s[4:7], s74 offen offset:1024 sc1
    buffer_load_dwordx4 v[120:123], v2, s[4:7], s74 offen offset:2048 sc1
    buffer_load_dwordx4 v[124:127], v2, s[4:7], s74 offen offset:3072 sc1
    s_add_u32 s74, s72, 28672
    buffer_load_dwordx4 v[64:67], v2, s[4:7], s74 offen offset:0 sc1
    buffer_load_dwordx4 v[68:71], v2, s[4:7], s74 offen offset:1024 sc1
    buffer_load_dwordx4 v[72:75], v2, s[4:7], s74 offen offset:2048 sc1
    buffer_load_dwordx4 v[76:79], v2, s[4:7], s74 offen offset:3072 sc1
    s_add_u32 s74, s72, 131072
    buffer_load_dwordx4 v[80:83], v2, s[4:7], s74 offen offset:0 sc1
    buffer_load_dwordx4 v[84:87], v2, s[4:7], s74 offen offset:1024 sc1
    buffer_load_dwordx4 v[88:91], v2, s[4:7], s74 offen offset:2048 sc1
    buffer_load_dwordx4 v[92:95], v2, s[4:7], s74 offen offset:3072 sc1
    s_waitcnt vmcnt(0)
    v_max3_u32 v5, v112, v116, v120
    v_max_u32 v5, v5, v124
    v_cmp_eq_u32 vcc, -1, v5
    s_cbranch_vccnz Ls_40
    s_branch Lq_39
Ls_42:
    s_add_u32 s71, s71, 1
    s_cmp_gt_u32 s71, 32768
    s_cbranch_scc1 Lq_41
    s_sleep 1
    s_add_u32 s74, s72, 28672
    buffer_load_dwordx4 v[64:67], v2, s[4:7], s74 offen offset:0 sc1
    buffer_load_dwordx4 v[68:71], v2, s[4:7], s74 offen offset:1024 sc1
    buffer_load_dwordx4 v[72:75], v2, s[4:7], s74 offen offset:2048 sc1
    buffer_load_dwordx4 v[76:79], v2, s[4:7], s74 offen offset:3072 sc1
    s_add_u32 s74, s72, 131072
    buffer_load_dwordx4 v[80:83], v2, s[4:7], s74 offen offset:0 sc1
    buffer_load_dwordx4 v[84:87], v2, s[4:7], s74 offen offset:1024 sc1
    buffer_load_dwordx4 v[88:91], v2, s[4:7], s74 offen offset:2048 sc1
    buffer_load_dwordx4 v[92:95], v2, s[4:7], s74 offen offset:3072 sc1
    s_add_u32 s74, s72, 135168
    buffer_load_dwordx4 v[96:99], v2, s[4:7], s74 offen offset:0 sc1
    buffer_load_dwordx4 v[100:103], v2, s[4:7], s74 offen offset:1024 sc1
    buffer_load_dwordx4 v[104:107], v2, s[4:7], s74 offen offset:2048 sc1
    buffer_load_dwordx4 v[108:111], v2, s[4:7], s74 offen offset:3072 sc1
    s_waitcnt vmcnt(0)
    v_max3_u32 v5, v64, v68, v72
    v_max_u32 v5, v5, v76
    v_cmp_eq_u32 vcc, -1, v5
    s_cbranch_vccnz Ls_42
    s_branch Lq_41
Ls_44:
    s_add_u32 s71, s71, 1
    s_cmp_gt_u32 s71, 32768
    s_cbranch_scc1 Lq_43
    s_sleep 1
    s_add_u32 s74, s72, 131072
    buffer_load_dwordx4 v[80:83], v2, s[4:7], s74 offen offset:0 sc1
    buffer_load_dwordx4 v[84:87], v2, s[4:7], s74 offen offset:1024 sc1
    buffer_load_dwordx4 v[88:91], v2, s[4:7], s74 offen offset:2048 sc1
    buffer_load_dwordx4 v[92:95], v2, s[4:7], s74 offen offset:3072 sc1
    s_add_u32 s74, s72, 135168
    buffer_load_dwordx4 v[96:99], v2, s[4:7], s74 offen offset:0 sc1
    buffer_load_dwordx4 v[100:103], v2, s[4:7], s74 offen offset:1024 sc1
    buffer_load_dwordx4 v[104:107], v2, s[4:7], s74 offen offset:2048 sc1
    buffer_load_dwordx4 v[108:111], v2, s[4:7], s74 offen offset:3072 sc1
    s_add_u32 s74, s72, 139264
    buffer_load_dwordx4 v[112:115], v2, s[4:7], s74 offen offset:0 sc1
    buffer_load_dwordx4 v[116:119], v2, s[4:7], s74 offen offset:1024 sc1
    buffer_load_dwordx4 v[120:123], v2, s[4:7], s74 offen offset:2048 sc1
    buffer_load_dwordx4 v[124:127], v2, s[4:7], s74 offen offset:3072 sc1
    s_waitcnt vmcnt(0)
    v_max3_u32 v5, v80, v84, v88
    v_max_u32 v5, v5, v92
    v_cmp_eq_u32 vcc, -1, v5
    s_cbranch_vccnz Ls_44
    s_branch Lq_43
Ls_46:
    s_add_u32 s71, s71, 1
    s_cmp_gt_u32 s71, 32768
    s_cbranch_scc1 Lq_45
    s_sleep 1
    s_add_u32 s74, s72, 135168
    buffer_load_dwordx4 v[96:99], v2, s[4:7], s74 offen offset:0 sc1
    buffer_load_dwordx4 v[100:103], v2, s[4:7], s74 offen offset:1024 sc1
    buffer_load_dwordx4 v[104:107], v2, s[4:7], s74 offen offset:2048 sc1
    buffer_load_dwordx4 v[108:111], v2, s[4:7], s74 offen offset:3072 sc1
    s_add_u32 s74, s72, 139264
    buffer_load_dwordx4 v[112:115], v2, s[4:7], s74 offen offset:0 sc1
    buffer_load_dwordx4 v[116:119], v2, s[4:7], s74 offen offset:1024 sc1
    buffer_load_dwordx4 v[120:123], v2, s[4:7], s74 offen offset:2048 sc1
    buffer_load_dwordx4 v[124:127], v2, s[4:7], s74 offen offset:3072 sc1
    s_add_u32 s74, s72, 143360
    buffer_load_dwordx4 v[80:83], v2, s[4:7], s74 offen offset:0 sc1
    buffer_load_dwordx4 v[84:87], v2, s[4:7], s74 offen offset:1024 sc1
    buffer_load_dwordx4 v[88:91], v2, s[4:7], s74 offen offset:2048 sc1
    buffer_load_dwordx4 v[92:95], v2, s[4:7], s74 offen offset:3072 sc1
    s_waitcnt vmcnt(0)
    v_max3_u32 v5, v96, v100, v104
    v_max_u32 v5, v5, v108
    v_cmp_eq_u32 vcc, -1, v5
    s_cbranch_vccnz Ls_46
    s_branch Lq_45
Ls_48:
    s_add_u32 s71, s71, 1
    s_cmp_gt_u32 s71, 32768
    s_cbranch_scc1 Lq_47
    s_sleep 1
    s_add_u32 s74, s72, 139264
    buffer_load_dwordx4 v[112:115], v2, s[4:7], s74 offen offset:0 sc1
    buffer_load_dwordx4 v[116:119], v2, s[4:7], s74 offen offset:1024 sc1
    buffer_load_dwordx4 v[120:123], v2, s[4:7], s74 offen offset:2048 sc1
    buffer_load_dwordx4 v[124:127], v2, s[4:7], s74 offen offset:3072 sc1
    s_add_u32 s74, s72, 143360
    buffer_load_dwordx4 v[80:83], v2, s[4:7], s74 offen offset:0 sc1
    buffer_load_dwordx4 v[84:87], v2, s[4:7], s74 offen offset:1024 sc1
    buffer_load_dwordx4 v[88:91], v2, s[4:7], s74 offen offset:2048 sc1
    buffer_load_dwordx4 v[92:95], v2, s[4:7], s74 offen offset:3072 sc1
    s_add_u32 s74, s72, 147456
    buffer_load_dwordx4 v[96:99], v2, s[4:7], s74 offen offset:0 sc1
    buffer_load_dwordx4 v[100:103], v2, s[4:7], s74 offen offset:1024 sc1
    buffer_load_dwordx4 v[104:107], v2, s[4:7], s74 offen offset:2048 sc1
    buffer_load_dwordx4 v[32:35], v2, s[4:7], s74 offen offset:3072 sc1
    s_waitcnt vmcnt(0)
    v_max3_u32 v5, v112, v116, v120
    v_max_u32 v5, v5, v124
    v_cmp_eq_u32 vcc, -1, v5
    s_cbranch_vccnz Ls_48
    s_branch Lq_47
Ls_50:
    s_add_u32 s71, s71, 1
    s_cmp_gt_u32 s71, 32768
    s_cbranch_scc1 Lq_49
    s_sleep 1
    s_add_u32 s74, s72, 143360
    buffer_load_dwordx4 v[80:83], v2, s[4:7], s74 offen offset:0 sc1
    buffer_load_dwordx4 v[84:87], v2, s[4:7], s74 offen offset:1024 sc1
    buffer_load_dwordx4 v[88:91], v2, s[4:7], s74 offen offset:2048 sc1
    buffer_load_dwordx4 v[92:95], v2, s[4:7], s74 offen offset:3072 sc1
    s_add_u32 s74, s72, 147456
    buffer_load_dwordx4 v[96:99], v2, s[4:7], s74 offen offset:0 sc1
    buffer_load_dwordx4 v[100:103], v2, s[4:7], s74 offen offset:1024 sc1
    buffer_load_dwordx4 v[104:107], v2, s[4:7], s74 offen offset:2048 sc1
    buffer_load_dwordx4 v[32:35], v2, s[4:7], s74 offen offset:3072 sc1
    s_add_u32 s74, s72, 151552
    buffer_load_dwordx4 v[36:39], v2, s[4:7], s74 offen offset:0 sc1
    buffer_load_dwordx4 v[40:43], v2, s[4:7], s74 offen offset:1024 sc1
    buffer_load_dwordx4 v[44:47], v2, s[4:7], s74 offen offset:2048 sc1
    buffer_load_dwordx4 v[108:111], v2, s[4:7], s74 offen offset:3072 sc1
    s_waitcnt vmcnt(0)
    v_max3_u32 v5, v80, v84, v88
    v_max_u32 v5, v5, v92
    v_cmp_eq_u32 vcc, -1, v5
    s_cbranch_vccnz Ls_50
    s_branch Lq_49
Ls_52:
    s_add_u32 s71, s71, 1
    s_cmp_gt_u32 s71, 32768
    s_cbranch_scc1 Lq_51
    s_sleep 1
    s_add_u32 s74, s72, 147456
    buffer_load_dwordx4 v[96:99], v2, s[4:7], s74 offen offset:0 sc1
    buffer_load_dwordx4 v[100:103], v2, s[4:7], s74 offen offset:1024 sc1
    buffer_load_dwordx4 v[104:107], v2, s[4:7], s74 offen offset:2048 sc1
    buffer_load_dwordx4 v[32:35], v2, s[4:7], s74 offen offset:3072 sc1
    s_add_u32 s74, s72, 151552
    buffer_load_dwordx4 v[36:39], v2, s[4:7], s74 offen offset:0 sc1
    buffer_load_dwordx4 v[40:43], v2, s[4:7], s74 offen offset:1024 sc1
    buffer_load_dwordx4 v[44:47], v2, s[4:7], s74 offen offset:2048 sc1
    buffer_load_dwordx4 v[108:111], v2, s[4:7], s74 offen offset:3072 sc1
    s_add_u32 s74, s72, 155648
    buffer_load_dwordx4 v[112:115], v2, s[4:7], s74 offen offset:0 sc1
    buffer_load_dwordx4 v[116:119], v2, s[4:7], s74 offen offset:1024 sc1
    buffer_load_dwordx4 v[120:123], v2, s[4:7], s74 offen offset:2048 sc1
    buffer_load_dwordx4 v[124:127], v2, s[4:7], s74 offen offset:3072 sc1
    s_waitcnt vmcnt(0)
    v_max3_u32 v5, v96, v100, v104
    v_max_u32 v5, v5, v32
    v_cmp_eq_u32 vcc, -1, v5
    s_cbranch_vccnz Ls_52
    s_branch Lq_51
Ls_54:
    s_add_u32 s71, s71, 1
    s_cmp_gt_u32 s71, 32768
    s_cbranch_scc1 Lq_53
    s_sleep 1
    s_add_u32 s74, s72, 151552
    buffer_load_dwordx4 v[36:39], v2, s[4:7], s74 offen offset:0 sc1
    buffer_load_dwordx4 v[40:43], v2, s[4:7], s74 offen offset:1024 sc1
    buffer_load_dwordx4 v[44:47], v2, s[4:7], s74 offen offset:2048 sc1
    buffer_load_dwordx4 v[108:111], v2, s[4:7], s74 offen offset:3072 sc1
    s_add_u32 s74, s72, 155648
    buffer_load_dwordx4 v[112:115], v2, s[4:7], s74 offen offset:0 sc1
    buffer_load_dwordx4 v[116:119], v2, s[4:7], s74 offen offset:1024 sc1
    buffer_load_dwordx4 v[120:123], v2, s[4:7], s74 offen offset:2048 sc1
    buffer_load_dwordx4 v[124:127], v2, s[4:7], s74 offen offset:3072 sc1
    s_add_u32 s74, s72, 159744
    buffer_load_dwordx4 v[80:83], v2, s[4:7], s74 offen offset:0 sc1
    buffer_load_dwordx4 v[84:87], v2, s[4:7], s74 offen offset:1024 sc1
    buffer_load_dwordx4 v[88:91], v2, s[4:7], s74 offen offset:2048 sc1
    buffer_load_dwordx4 v[92:95], v2, s[4:7], s74 offen offset:3072 sc1
    s_waitcnt vmcnt(0)
    v_max3_u32 v5, v36, v40, v44
    v_max_u32 v5, v5, v108
    v_cmp_eq_u32 vcc, -1, v5
    s_cbranch_vccnz Ls_54
    s_branch Lq_53
Ls_56:
    s_add_u32 s71, s71, 1
    s_cmp_gt_u32 s71, 32768
    s_cbranch_scc1 Lq_55
    s_sleep 1
    s_add_u32 s74, s72, 155648
    buffer_load_dwordx4 v[112:115], v2, s[4:7], s74 offen offset:0 sc1
    buffer_load_dwordx4 v[116:119], v2, s[4:7], s74 offen offset:1024 sc1
    buffer_load_dwordx4 v[120:123], v2, s[4:7], s74 offen offset:2048 sc1
    buffer_load_dwordx4 v[124:127], v2, s[4:7], s74 offen offset:3072 sc1
    s_add_u32 s74, s72, 159744
    buffer_load_dwordx4 v[80:83], v2, s[4:7], s74 offen offset:0 sc1
    buffer_load_dwordx4 v[84:87], v2, s[4:7], s74 offen offset:1024 sc1
    buffer_load_dwordx4 v[88:91], v2, s[4:7], s74 offen offset:2048 sc1
    buffer_load_dwordx4 v[92:95], v2, s[4:7], s74 offen offset:3072 sc1
    s_waitcnt vmcnt(0)
    v_max3_u32 v5, v112, v116, v120
    v_max_u32 v5, v5, v124
    v_cmp_eq_u32 vcc, -1, v5
    s_cbranch_vccnz Ls_56
    s_branch Lq_55
Ls_58:
    s_add_u32 s71, s71, 1
    s_cmp_gt_u32 s71, 32768
    s_cbranch_scc1 Lq_57
    s_sleep 1
    s_add_u32 s74, s72, 159744
    buffer_load_dwordx4 v[80:83], v2, s[4:7], s74 offen offset:0 sc1
    buffer_load_dwordx4 v[84:87], v2, s[4:7], s74 offen offset:1024 sc1
    buffer_load_dwordx4 v[88:91], v2, s[4:7], s74 offen offset:2048 sc1
    buffer_load_dwordx4 v[92:95], v2, s[4:7], s74 offen offset:3072 sc1
    s_waitcnt vmcnt(0)
    v_max3_u32 v5, v80, v84, v88
    v_max_u32 v5, v5, v92
    v_cmp_eq_u32 vcc, -1, v5
    s_cbranch_vccnz Ls_58
    s_branch Lq_57
Ls_67:
    s_add_u32 s71, s71, 1
    s_cmp_gt_u32 s71, 32768
    s_cbranch_scc1 Lq_66
    s_sleep 1
    s_add_u32 s74, s72, 0
    buffer_load_dwordx4 v[80:83], v2, s[4:7], s74 offen offset:0 sc1
    buffer_load_dwordx4 v[84:87], v2, s[4:7], s74 offen offset:1024 sc1
    buffer_load_dwordx4 v[88:91], v2, s[4:7], s74 offen offset:2048 sc1
    buffer_load_dwordx4 v[92:95], v2, s[4:7], s74 offen offset:3072 sc1
    s_add_u32 s74, s72, 4096
    buffer_load_dwordx4 v[112:115], v2, s[4:7], s74 offen offset:0 sc1
    buffer_load_dwordx4 v[116:119], v2, s[4:7], s74 offen offset:1024 sc1
    buffer_load_dwordx4 v[120:123], v2, s[4:7], s74 offen offset:2048 sc1
    buffer_load_dwordx4 v[124:127], v2, s[4:7], s74 offen offset:3072 sc1
    s_add_u32 s74, s72, 8192
    buffer_load_dwordx4 v[96:99], v2, s[4:7], s74 offen offset:0 sc1
    buffer_load_dwordx4 v[100:103], v2, s[4:7], s74 offen offset:1024 sc1
    buffer_load_dwordx4 v[104:107], v2, s[4:7], s74 offen offset:2048 sc1
    buffer_load_dwordx4 v[108:111], v2, s[4:7], s74 offen offset:3072 sc1
    s_waitcnt vmcnt(0)
    v_max3_u32 v5, v80, v84, v88
    v_max_u32 v5, v5, v92
    v_cmp_eq_u32 vcc, -1, v5
    s_cbranch_vccnz Ls_67
    s_branch Lq_66
Ls_69:
    s_add_u32 s71, s71, 1
    s_cmp_gt_u32 s71, 32768
    s_cbranch_scc1 Lq_68
    s_sleep 1
    s_add_u32 s74, s72, 4096
    buffer_load_dwordx4 v[112:115], v2, s[4:7], s74 offen offset:0 sc1
    buffer_load_dwordx4 v[116:119], v2, s[4:7], s74 offen offset:1024 sc1
    buffer_load_dwordx4 v[120:123], v2, s[4:7], s74 offen offset:2048 sc1
    buffer_load_dwordx4 v[124:127], v2, s[4:7], s74 offen offset:3072 sc1
    s_add_u32 s74, s72, 8192
    buffer_load_dwordx4 v[96:99], v2, s[4:7], s74 offen offset:0 sc1
    buffer_load_dwordx4 v[100:103], v2, s[4:7], s74 offen offset:1024 sc1
    buffer_load_dwordx4 v[104:107], v2, s[4:7], s74 offen offset:2048 sc1
    buffer_load_dwordx4 v[108:111], v2, s[4:7], s74 offen offset:3072 sc1
    s_add_u32 s74, s72, 12288
    buffer_load_dwordx4 v[72:75], v2, s[4:7], s74 offen offset:0 sc1
    buffer_load_dwordx4 v[76:79], v2, s[4:7], s74 offen offset:1024 sc1
    buffer_load_dwordx4 v[80:83], v2, s[4:7], s74 offen offset:2048 sc1
    buffer_load_dwordx4 v[84:87], v2, s[4:7], s74 offen offset:3072 sc1
    s_waitcnt vmcnt(0)
    v_max3_u32 v5, v112, v116, v120
    v_max_u32 v5, v5, v124
    v_cmp_eq_u32 vcc, -1, v5
    s_cbranch_vccnz Ls_69
    s_branch Lq_68
Ls_73:
    s_add_u32 s71, s71, 1
    s_cmp_gt_u32 s71, 32768
    s_cbranch_scc1 Lq_72
    s_sleep 1
    s_add_u32 s74, s72, 8192
    buffer_load_dwordx4 v[96:99], v2, s[4:7], s74 offen offset:0 sc1
    buffer_load_dwordx4 v[100:103], v2, s[4:7], s74 offen offset:1024 sc1
    buffer_load_dwordx4 v[104:107], v2, s[4:7], s74 offen offset:2048 sc1
    buffer_load_dwordx4 v[108:111], v2, s[4:7], s74 offen offset:3072 sc1
    s_add_u32 s74, s72, 12288
    buffer_load_dwordx4 v[72:75], v2, s[4:7], s74 offen offset:0 sc1
    buffer_load_dwordx4 v[76:79], v2, s[4:7], s74 offen offset:1024 sc1
    buffer_load_dwordx4 v[80:83], v2, s[4:7], s74 offen offset:2048 sc1
    buffer_load_dwordx4 v[84:87], v2, s[4:7], s74 offen offset:3072 sc1
    s_add_u32 s74, s72, 16384
    buffer_load_dwordx4 v[88:91], v2, s[4:7], s74 offen offset:0 sc1
    buffer_load_dwordx4 v[92:95], v2, s[4:7], s74 offen offset:1024 sc1
    buffer_load_dwordx4 v[112:115], v2, s[4:7], s74 offen offset:2048 sc1
    buffer_load_dwordx4 v[116:119], v2, s[4:7], s74 offen offset:3072 sc1
    s_waitcnt vmcnt(0)
    v_max3_u32 v5, v96, v100, v104
    v_max_u32 v5, v5, v108
    v_cmp_eq_u32 vcc, -1, v5
    s_cbranch_vccnz Ls_73
    s_branch Lq_72
Ls_75:
    s_add_u32 s71, s71, 1
    s_cmp_gt_u32 s71, 32768
    s_cbranch_scc1 Lq_74
    s_sleep 1
    s_add_u32 s74, s72, 12288
    buffer_load_dwordx4 v[72:75], v2, s[4:7], s74 offen offset:0 sc1
    buffer_load_dwordx4 v[76:79], v2, s[4:7], s74 offen offset:1024 sc1
    buffer_load_dwordx4 v[80:83], v2, s[4:7], s74 offen offset:2048 sc1
    buffer_load_dwordx4 v[84:87], v2, s[4:7], s74 offen offset:3072 sc1
    s_add_u32 s74, s72, 16384
    buffer_load_dwordx4 v[88:91], v2, s[4:7], s74 offen offset:0 sc1
    buffer_load_dwordx4 v[92:95], v2, s[4:7], s74 offen offset:1024 sc1
    buffer_load_dwordx4 v[112:115], v2, s[4:7], s74 offen offset:2048 sc1
    buffer_load_dwordx4 v[116:119], v2, s[4:7], s74 offen offset:3072 sc1
    s_add_u32 s74, s72, 20480
    buffer_load_dwordx4 v[120:123], v2, s[4:7], s74 offen offset:0 sc1
    buffer_load_dwordx4 v[124:127], v2, s[4:7], s74 offen offset:1024 sc1
    buffer_load_dwordx4 v[96:99], v2, s[4:7], s74 offen offset:2048 sc1
    buffer_load_dwordx4 v[100:103], v2, s[4:7], s74 offen offset:3072 sc1
    s_waitcnt vmcnt(0)
    v_max3_u32 v5, v72, v76, v80
    v_max_u32 v5, v5, v84
    v_cmp_eq_u32 vcc, -1, v5
    s_cbranch_vccnz Ls_75
    s_branch Lq_74
Ls_77:
    s_add_u32 s71, s71, 1
    s_cmp_gt_u32 s71, 32768
    s_cbranch_scc1 Lq_76
    s_sleep 1
    s_add_u32 s74, s72, 16384
    buffer_load_dwordx4 v[88:91], v2, s[4:7], s74 offen offset:0 sc1
    buffer_load_dwordx4 v[92:95], v2, s[4:7], s74 offen offset:1024 sc1
    buffer_load_dwordx4 v[112:115], v2, s[4:7], s74 offen offset:2048 sc1
    buffer_load_dwordx4 v[116:119], v2, s[4:7], s74 offen offset:3072 sc1
    s_add_u32 s74, s72, 20480
    buffer_load_dwordx4 v[120:123], v2, s[4:7], s74 offen offset:0 sc1
    buffer_load_dwordx4 v[124:127], v2, s[4:7], s74 offen offset:1024 sc1
    buffer_load_dwordx4 v[96:99], v2, s[4:7], s74 offen offset:2048 sc1
    buffer_load_dwordx4 v[100:103], v2, s[4:7], s74 offen offset:3072 sc1
    s_add_u32 s74, s72, 24576
    buffer_load_dwordx4 v[104:107], v2, s[4:7], s74 offen offset:0 sc1
    buffer_load_dwordx4 v[108:111], v2, s[4:7], s74 offen offset:1024 sc1
    buffer_load_dwordx4 v[72:75], v2, s[4:7], s74 offen offset:2048 sc1
    buffer_load_dwordx4 v[76:79], v2, s[4:7], s74 offen offset:3072 sc1
    s_waitcnt vmcnt(0)
    v_max3_u32 v5, v88, v92, v112
    v_max_u32 v5, v5, v116
    v_cmp_eq_u32 vcc, -1, v5
    s_cbranch_vccnz Ls_77
    s_branch Lq_76
Ls_79:
    s_add_u32 s71, s71, 1
    s_cmp_gt_u32 s71, 32768
    s_cbranch_scc1 Lq_78
    s_sleep 1
    s_add_u32 s74, s72, 20480
    buffer_load_dwordx4 v[120:123], v2, s[4:7], s74 offen offset:0 sc1
    buffer_load_dwordx4 v[124:127], v2, s[4:7], s74 offen offset:1024 sc1
    buffer_load_dwordx4 v[96:99], v2, s[4:7], s74 offen offset:2048 sc1
    buffer_load_dwordx4 v[100:103], v2, s[4:7], s74 offen offset:3072 sc1
    s_add_u32 s74, s72, 24576
    buffer_load_dwordx4 v[104:107], v2, s[4:7], s74 offen offset:0 sc1
    buffer_load_dwordx4 v[108:111], v2, s[4:7], s74 offen offset:1024 sc1
    buffer_load_dwordx4 v[72:75], v2, s[4:7], s74 offen offset:2048 sc1
    buffer_load_dwordx4 v[76:79], v2, s[4:7], s74 offen offset:3072 sc1
    s_add_u32 s74, s72, 114688
    buffer_load_dwordx4 v[80:83], v2, s[4:7], s74 offen offset:0 sc1
    buffer_load_dwordx4 v[84:87], v2, s[4:7], s74 offen offset:1024 sc1
    buffer_load_dwordx4 v[88:91], v2, s[4:7], s74 offen offset:2048 sc1
    buffer_load_dwordx4 v[92:95], v2, s[4:7], s74 offen offset:3072 sc1
    s_waitcnt vmcnt(0)
    v_max3_u32 v5, v120, v124, v96
    v_max_u32 v5, v5, v100
    v_cmp_eq_u32 vcc, -1, v5
    s_cbranch_vccnz Ls_79
    s_branch Lq_78
Ls_81:
    s_add_u32 s71, s71, 1
    s_cmp_gt_u32 s71, 32768
    s_cbranch_scc1 Lq_80
    s_sleep 1
    s_add_u32 s74, s72, 24576
    buffer_load_dwordx4 v[104:107], v2, s[4:7], s74 offen offset:0 sc1
    buffer_load_dwordx4 v[108:111], v2, s[4:7], s74 offen offset:1024 sc1
    buffer_load_dwordx4 v[72:75], v2, s[4:7], s74 offen offset:2048 sc1
    buffer_load_dwordx4 v[76:79], v2, s[4:7], s74 offen offset:3072 sc1
    s_add_u32 s74, s72, 114688
    buffer_load_dwordx4 v[80:83], v2, s[4:7], s74 offen offset:0 sc1
    buffer_load_dwordx4 v[84:87], v2, s[4:7], s74 offen offset:1024 sc1
    buffer_load_dwordx4 v[88:91], v2, s[4:7], s74 offen offset:2048 sc1
    buffer_load_dwordx4 v[92:95], v2, s[4:7], s74 offen offset:3072 sc1
    s_add_u32 s74, s72, 118784
    buffer_load_dwordx4 v[112:115], v2, s[4:7], s74 offen offset:0 sc1
    buffer_load_dwordx4 v[116:119], v2, s[4:7], s74 offen offset:1024 sc1
    buffer_load_dwordx4 v[120:123], v2, s[4:7], s74 offen offset:2048 sc1
    buffer_load_dwordx4 v[124:127], v2, s[4:7], s74 offen offset:3072 sc1
    s_waitcnt vmcnt(0)
    v_max3_u32 v5, v104, v108, v72
    v_max_u32 v5, v5, v76
    v_cmp_eq_u32 vcc, -1, v5
    s_cbranch_vccnz Ls_81
    s_branch Lq_80
Ls_83:
    s_add_u32 s71, s71, 1
    s_cmp_gt_u32 s71, 32768
    s_cbranch_scc1 Lq_82
    s_sleep 1
    s_add_u32 s74, s72, 114688
    buffer_load_dwordx4 v[80:83], v2, s[4:7], s74 offen offset:0 sc1
    buffer_load_dwordx4 v[84:87], v2, s[4:7], s74 offen offset:1024 sc1
    buffer_load_dwordx4 v[88:91], v2, s[4:7], s74 offen offset:2048 sc1
    buffer_load_dwordx4 v[92:95], v2, s[4:7], s74 offen offset:3072 sc1
    s_add_u32 s74, s72, 118784
    buffer_load_dwordx4 v[112:115], v2, s[4:7], s74 offen offset:0 sc1
    buffer_load_dwordx4 v[116:119], v2, s[4:7], s74 offen offset:1024 sc1
    buffer_load_dwordx4 v[120:123], v2, s[4:7], s74 offen offset:2048 sc1
    buffer_load_dwordx4 v[124:127], v2, s[4:7], s74 offen offset:3072 sc1
    s_add_u32 s74, s72, 122880
    buffer_load_dwordx4 v[96:99], v2, s[4:7], s74 offen offset:0 sc1
    buffer_load_dwordx4 v[100:103], v2, s[4:7], s74 offen offset:1024 sc1
    buffer_load_dwordx4 v[104:107], v2, s[4:7], s74 offen offset:2048 sc1
    buffer_load_dwordx4 v[108:111], v2, s[4:7], s74 offen offset:3072 sc1
    s_waitcnt vmcnt(0)
    v_max3_u32 v5, v80, v84, v88
    v_max_u32 v5, v5, v92
    v_cmp_eq_u32 vcc, -1, v5
    s_cbranch_vccnz Ls_83
    s_branch Lq_82
Ls_85:
    s_add_u32 s71, s71, 1
    s_cmp_gt_u32 s71, 32768
    s_cbranch_scc1 Lq_84
    s_sleep 1
    s_add_u32 s74, s72, 118784
    buffer_load_dwordx4 v[112:115], v2, s[4:7], s74 offen offset:0 sc1
    buffer_load_dwordx4 v[116:119], v2, s[4:7], s74 offen offset:1024 sc1
    buffer_load_dwordx4 v[120:123], v2, s[4:7], s74 offen offset:2048 sc1
    buffer_load_dwordx4 v[124:127], v2, s[4:7], s74 offen offset:3072 sc1
    s_add_u32 s74, s72, 122880
    buffer_load_dwordx4 v[96:99], v2, s[4:7], s74 offen offset:0 sc1
    buffer_load_dwordx4 v[100:103], v2, s[4:7], s74 offen offset:1024 sc1
    buffer_load_dwordx4 v[104:107], v2, s[4:7], s74 offen offset:2048 sc1
    buffer_load_dwordx4 v[108:111], v2, s[4:7], s74 offen offset:3072 sc1
    s_add_u32 s74, s72, 126976
    buffer_load_dwordx4 v[80:83], v2, s[4:7], s74 offen offset:0 sc1
    buffer_load_dwordx4 v[84:87], v2, s[4:7], s74 offen offset:1024 sc1
    buffer_load_dwordx4 v[88:91], v2, s[4:7], s74 offen offset:2048 sc1
    buffer_load_dwordx4 v[92:95], v2, s[4:7], s74 offen offset:3072 sc1
    s_waitcnt vmcnt(0)
    v_max3_u32 v5, v112, v116, v120
    v_max_u32 v5, v5, v124
    v_cmp_eq_u32 vcc, -1, v5
    s_cbranch_vccnz Ls_85
    s_branch Lq_84
Ls_87:
    s_add_u32 s71, s71, 1
    s_cmp_gt_u32 s71, 32768
    s_cbranch_scc1 Lq_86
    s_sleep 1
    s_add_u32 s74, s72, 122880
    buffer_load_dwordx4 v[96:99], v2, s[4:7], s74 offen offset:0 sc1
    buffer_load_dwordx4 v[100:103], v2, s[4:7], s74 offen offset:1024 sc1
    buffer_load_dwordx4 v[104:107], v2, s[4:7], s74 offen offset:2048 sc1
    buffer_load_dwordx4 v[108:111], v2, s[4:7], s74 offen offset:3072 sc1
    s_add_u32 s74, s72, 126976
    buffer_load_dwordx4 v[80:83], v2, s[4:7], s74 offen offset:0 sc1
    buffer_load_dwordx4 v[84:87], v2, s[4:7], s74 offen offset:1024 sc1
    buffer_load_dwordx4 v[88:91], v2, s[4:7], s74 offen offset:2048 sc1
    buffer_load_dwordx4 v[92:95], v2, s[4:7], s74 offen offset:3072 sc1
    s_add_u32 s74, s72, 131072
    buffer_load_dwordx4 v[40:43], v2, s[4:7], s74 offen offset:0 sc1
    buffer_load_dwordx4 v[44:47], v2, s[4:7], s74 offen offset:1024 sc1
    buffer_load_dwordx4 v[112:115], v2, s[4:7], s74 offen offset:2048 sc1
    buffer_load_dwordx4 v[116:119], v2, s[4:7], s74 offen offset:3072 sc1
    s_waitcnt vmcnt(0)
    v_max3_u32 v5, v96, v100, v104
    v_max_u32 v5, v5, v108
    v_cmp_eq_u32 vcc, -1, v5
    s_cbranch_vccnz Ls_87
    s_branch Lq_86
Ls_89:
    s_add_u32 s71, s71, 1
    s_cmp_gt_u32 s71, 32768
    s_cbranch_scc1 Lq_88
    s_sleep 1
    s_add_u32 s74, s72, 126976
    buffer_load_dwordx4 v[80:83], v2, s[4:7], s74 offen offset:0 sc1
    buffer_load_dwordx4 v[84:87], v2, s[4:7], s74 offen offset:1024 sc1
    buffer_load_dwordx4 v[88:91], v2, s[4:7], s74 offen offset:2048 sc1
    buffer_load_dwordx4 v[92:95], v2, s[4:7], s74 offen offset:3072 sc1
    s_add_u32 s74, s72, 131072
    buffer_load_dwordx4 v[40:43], v2, s[4:7], s74 offen offset:0 sc1
    buffer_load_dwordx4 v[44:47], v2, s[4:7], s74 offen offset:1024 sc1
    buffer_load_dwordx4 v[112:115], v2, s[4:7], s74 offen offset:2048 sc1
    buffer_load_dwordx4 v[116:119], v2, s[4:7], s74 offen offset:3072 sc1
    s_add_u32 s74, s72, 135168
    buffer_load_dwordx4 v[120:123], v2, s[4:7], s74 offen offset:0 sc1
    buffer_load_dwordx4 v[124:127], v2, s[4:7], s74 offen offset:1024 sc1
    buffer_load_dwordx4 v[96:99], v2, s[4:7], s74 offen offset:2048 sc1
    buffer_load_dwordx4 v[100:103], v2, s[4:7], s74 offen offset:3072 sc1
    s_waitcnt vmcnt(0)
    v_max3_u32 v5, v80, v84, v88
    v_max_u32 v5, v5, v92
    v_cmp_eq_u32 vcc, -1, v5
    s_cbranch_vccnz Ls_89
    s_branch Lq_88
Ls_91:
    s_add_u32 s71, s71, 1
    s_cmp_gt_u32 s71, 32768
    s_cbranch_scc1 Lq_90
    s_sleep 1
    s_add_u32 s74, s72, 131072
    buffer_load_dwordx4 v[40:43], v2, s[4:7], s74 offen offset:0 sc1
    buffer_load_dwordx4 v[44:47], v2, s[4:7], s74 offen offset:1024 sc1
    buffer_load_dwordx4 v[112:115], v2, s[4:7], s74 offen offset:2048 sc1
    buffer_load_dwordx4 v[116:119], v2, s[4:7], s74 offen offset:3072 sc1
    s_add_u32 s74, s72, 135168
    buffer_load_dwordx4 v[120:123], v2, s[4:7], s74 offen offset:0 sc1
    buffer_load_dwordx4 v[124:127], v2, s[4:7], s74 offen offset:1024 sc1
    buffer_load_dwordx4 v[96:99], v2, s[4:7], s74 offen offset:2048 sc1
    buffer_load_dwordx4 v[100:103], v2, s[4:7], s74 offen offset:3072 sc1
    s_add_u32 s74, s72, 139264
    buffer_load_dwordx4 v[104:107], v2, s[4:7], s74 offen offset:0 sc1
    buffer_load_dwordx4 v[108:111], v2, s[4:7], s74 offen offset:1024 sc1
    buffer_load_dwordx4 v[80:83], v2, s[4:7], s74 offen offset:2048 sc1
    buffer_load_dwordx4 v[84:87], v2, s[4:7], s74 offen offset:3072 sc1
    s_waitcnt vmcnt(0)
    v_max3_u32 v5, v40, v44, v112
    v_max_u32 v5, v5, v116
    v_cmp_eq_u32 vcc, -1, v5
    s_cbranch_vccnz Ls_91
    s_branch Lq_90
Ls_95:
    s_add_u32 s71, s71, 1
    s_cmp_gt_u32 s71, 32768
    s_cbranch_scc1 Lq_94
    s_sleep 1
    s_add_u32 s74, s72, 135168
    buffer_load_dwordx4 v[120:123], v2, s[4:7], s74 offen offset:0 sc1
    buffer_load_dwordx4 v[124:127], v2, s[4:7], s74 offen offset:1024 sc1
    buffer_load_dwordx4 v[96:99], v2, s[4:7], s74 offen offset:2048 sc1
    buffer_load_dwordx4 v[100:103], v2, s[4:7], s74 offen offset:3072 sc1
    s_add_u32 s74, s72, 139264
    buffer_load_dwordx4 v[104:107], v2, s[4:7], s74 offen offset:0 sc1
    buffer_load_dwordx4 v[108:111], v2, s[4:7], s74 offen offset:1024 sc1
    buffer_load_dwordx4 v[80:83], v2, s[4:7], s74 offen offset:2048 sc1
    buffer_load_dwordx4 v[84:87], v2, s[4:7], s74 offen offset:3072 sc1
    s_waitcnt vmcnt(0)
    v_max3_u32 v5, v120, v124, v96
    v_max_u32 v5, v5, v100
    v_cmp_eq_u32 vcc, -1, v5
    s_cbranch_vccnz Ls_95
    s_branch Lq_94
Ls_97:
    s_add_u32 s71, s71, 1
    s_cmp_gt_u32 s71, 32768
    s_cbranch_scc1 Lq_96
    s_sleep 1
    s_add_u32 s74, s72, 139264
    buffer_load_dwordx4 v[104:107], v2, s[4:7], s74 offen offset:0 sc1
    buffer_load_dwordx4 v[108:111], v2, s[4:7], s74 offen offset:1024 sc1
    buffer_load_dwordx4 v[80:83], v2, s[4:7], s74 offen offset:2048 sc1
    buffer_load_dwordx4 v[84:87], v2, s[4:7], s74 offen offset:3072 sc1
    s_waitcnt vmcnt(0)
    v_max3_u32 v5, v104, v108, v80
    v_max_u32 v5, v5, v84
    v_cmp_eq_u32 vcc, -1, v5
    s_cbranch_vccnz Ls_97
    s_branch Lq_96
Ls_122:
    s_add_u32 s71, s71, 1
    s_cmp_gt_u32 s71, 32768
    s_cbranch_scc1 Lq_121
    s_sleep 1
    s_add_u32 s74, s72, 0
    buffer_load_dwordx4 v[80:83], v2, s[4:7], s74 offen offset:0 sc1
    buffer_load_dwordx4 v[84:87], v2, s[4:7], s74 offen offset:1024 sc1
    buffer_load_dwordx4 v[88:91], v2, s[4:7], s74 offen offset:2048 sc1
    buffer_load_dwordx4 v[92:95], v2, s[4:7], s74 offen offset:3072 sc1
    s_add_u32 s74, s72, 4096
    buffer_load_dwordx4 v[96:99], v2, s[4:7], s74 offen offset:0 sc1
    buffer_load_dwordx4 v[100:103], v2, s[4:7], s74 offen offset:1024 sc1
    buffer_load_dwordx4 v[104:107], v2, s[4:7], s74 offen offset:2048 sc1
    buffer_load_dwordx4 v[108:111], v2, s[4:7], s74 offen offset:3072 sc1
    s_add_u32 s74, s72, 8192
    buffer_load_dwordx4 v[112:115], v2, s[4:7], s74 offen offset:0 sc1
    buffer_load_dwordx4 v[116:119], v2, s[4:7], s74 offen offset:1024 sc1
    buffer_load_dwordx4 v[120:123], v2, s[4:7], s74 offen offset:2048 sc1
    buffer_load_dwordx4 v[124:127], v2, s[4:7], s74 offen offset:3072 sc1
    s_waitcnt vmcnt(0)
    v_max3_u32 v5, v80, v84, v88
    v_max_u32 v5, v5, v92
    v_cmp_eq_u32 vcc, -1, v5
    s_cbranch_vccnz Ls_122
    s_branch Lq_121
Ls_124:
    s_add_u32 s71, s71, 1
    s_cmp_gt_u32 s71, 32768
    s_cbranch_scc1 Lq_123
    s_sleep 1
    s_add_u32 s74, s72, 4096
    buffer_load_dwordx4 v[96:99], v2, s[4:7], s74 offen offset:0 sc1
    buffer_load_dwordx4 v[100:103], v2, s[4:7], s74 offen offset:1024 sc1
    buffer_load_dwordx4 v[104:107], v2, s[4:7], s74 offen offset:2048 sc1
    buffer_load_dwordx4 v[108:111], v2, s[4:7], s74 offen offset:3072 sc1
    s_add_u32 s74, s72, 8192
    buffer_load_dwordx4 v[112:115], v2, s[4:7], s74 offen offset:0 sc1
    buffer_load_dwordx4 v[116:119], v2, s[4:7], s74 offen offset:1024 sc1
    buffer_load_dwordx4 v[120:123], v2, s[4:7], s74 offen offset:2048 sc1
    buffer_load_dwordx4 v[124:127], v2, s[4:7], s74 offen offset:3072 sc1
    s_add_u32 s74, s72, 12288
    buffer_load_dwordx4 v[64:67], v2, s[4:7], s74 offen offset:0 sc1
    buffer_load_dwordx4 v[68:71], v2, s[4:7], s74 offen offset:1024 sc1
    buffer_load_dwordx4 v[72:75], v2, s[4:7], s74 offen offset:2048 sc1
    buffer_load_dwordx4 v[76:79], v2, s[4:7], s74 offen offset:3072 sc1
    s_waitcnt vmcnt(0)
    v_max3_u32 v5, v96, v100, v104
    v_max_u32 v5, v5, v108
    v_cmp_eq_u32 vcc, -1, v5
    s_cbranch_vccnz Ls_124
    s_branch Lq_123
Ls_126:
    s_add_u32 s71, s71, 1
    s_cmp_gt_u32 s71, 32768
    s_cbranch_scc1 Lq_125
    s_sleep 1
    s_add_u32 s74, s72, 8192
    buffer_load_dwordx4 v[112:115], v2, s[4:7], s74 offen offset:0 sc1
    buffer_load_dwordx4 v[116:119], v2, s[4:7], s74 offen offset:1024 sc1
    buffer_load_dwordx4 v[120:123], v2, s[4:7], s74 offen offset:2048 sc1
    buffer_load_dwordx4 v[124:127], v2, s[4:7], s74 offen offset:3072 sc1
    s_add_u32 s74, s72, 12288
    buffer_load_dwordx4 v[64:67], v2, s[4:7], s74 offen offset:0 sc1
    buffer_load_dwordx4 v[68:71], v2, s[4:7], s74 offen offset:1024 sc1
    buffer_load_dwordx4 v[72:75], v2, s[4:7], s74 offen offset:2048 sc1
    buffer_load_dwordx4 v[76:79], v2, s[4:7], s74 offen offset:3072 sc1
    s_add_u32 s74, s72, 16384
    buffer_load_dwordx4 v[80:83], v2, s[4:7], s74 offen offset:0 sc1
    buffer_load_dwordx4 v[84:87], v2, s[4:7], s74 offen offset:1024 sc1
    buffer_load_dwordx4 v[88:91], v2, s[4:7], s74 offen offset:2048 sc1
    buffer_load_dwordx4 v[92:95], v2, s[4:7], s74 offen offset:3072 sc1
    s_waitcnt vmcnt(0)
    v_max3_u32 v5, v112, v116, v120
    v_max_u32 v5, v5, v124
    v_cmp_eq_u32 vcc, -1, v5
    s_cbranch_vccnz Ls_126
    s_branch Lq_125
Ls_128:
    s_add_u32 s71, s71, 1
    s_cmp_gt_u32 s71, 32768
    s_cbranch_scc1 Lq_127
    s_sleep 1
    s_add_u32 s74, s72, 12288
    buffer_load_dwordx4 v[64:67], v2, s[4:7], s74 offen offset:0 sc1
    buffer_load_dwordx4 v[68:71], v2, s[4:7], s74 offen offset:1024 sc1
    buffer_load_dwordx4 v[72:75], v2, s[4:7], s74 offen offset:2048 sc1
    buffer_load_dwordx4 v[76:79], v2, s[4:7], s74 offen offset:3072 sc1
    s_add_u32 s74, s72, 16384
    buffer_load_dwordx4 v[80:83], v2, s[4:7], s74 offen offset:0 sc1
    buffer_load_dwordx4 v[84:87], v2, s[4:7], s74 offen offset:1024 sc1
    buffer_load_dwordx4 v[88:91], v2, s[4:7], s74 offen offset:2048 sc1
    buffer_load_dwordx4 v[92:95], v2, s[4:7], s74 offen offset:3072 sc1
    s_add_u32 s74, s72, 20480
    buffer_load_dwordx4 v[96:99], v2, s[4:7], s74 offen offset:0 sc1
    buffer_load_dwordx4 v[100:103], v2, s[4:7], s74 offen offset:1024 sc1
    buffer_load_dwordx4 v[104:107], v2, s[4:7], s74 offen offset:2048 sc1
    buffer_load_dwordx4 v[108:111], v2, s[4:7], s74 offen offset:3072 sc1
    s_waitcnt vmcnt(0)
    v_max3_u32 v5, v64, v68, v72
    v_max_u32 v5, v5, v76
    v_cmp_eq_u32 vcc, -1, v5
    s_cbranch_vccnz Ls_128
    s_branch Lq_127
Ls_130:
    s_add_u32 s71, s71, 1
    s_cmp_gt_u32 s71, 32768
    s_cbranch_scc1 Lq_129
    s_sleep 1
    s_add_u32 s74, s72, 16384
    buffer_load_dwordx4 v[80:83], v2, s[4:7], s74 offen offset:0 sc1
    buffer_load_dwordx4 v[84:87], v2, s[4:7], s74 offen offset:1024 sc1
    buffer_load_dwordx4 v[88:91], v2, s[4:7], s74 offen offset:2048 sc1
    buffer_load_dwordx4 v[92:95], v2, s[4:7], s74 offen offset:3072 sc1
    s_add_u32 s74, s72, 20480
    buffer_load_dwordx4 v[96:99], v2, s[4:7], s74 offen offset:0 sc1
    buffer_load_dwordx4 v[100:103], v2, s[4:7], s74 offen offset:1024 sc1
    buffer_load_dwordx4 v[104:107], v2, s[4:7], s74 offen offset:2048 sc1
    buffer_load_dwordx4 v[108:111], v2, s[4:7], s74 offen offset:3072 sc1
    s_add_u32 s74, s72, 24576
    buffer_load_dwordx4 v[112:115], v2, s[4:7], s74 offen offset:0 sc1
    buffer_load_dwordx4 v[116:119], v2, s[4:7], s74 offen offset:1024 sc1
    buffer_load_dwordx4 v[120:123], v2, s[4:7], s74 offen offset:2048 sc1
    buffer_load_dwordx4 v[124:127], v2, s[4:7], s74 offen offset:3072 sc1
    s_waitcnt vmcnt(0)
    v_max3_u32 v5, v80, v84, v88
    v_max_u32 v5, v5, v92
    v_cmp_eq_u32 vcc, -1, v5
    s_cbranch_vccnz Ls_130
    s_branch Lq_129
Ls_132:
    s_add_u32 s71, s71, 1
    s_cmp_gt_u32 s71, 32768
    s_cbranch_scc1 Lq_131
    s_sleep 1
    s_add_u32 s74, s72, 20480
    buffer_load_dwordx4 v[96:99], v2, s[4:7], s74 offen offset:0 sc1
    buffer_load_dwordx4 v[100:103], v2, s[4:7], s74 offen offset:1024 sc1
    buffer_load_dwordx4 v[104:107], v2, s[4:7], s74 offen offset:2048 sc1
    buffer_load_dwordx4 v[108:111], v2, s[4:7], s74 offen offset:3072 sc1
    s_add_u32 s74, s72, 24576
    buffer_load_dwordx4 v[112:115], v2, s[4:7], s74 offen offset:0 sc1
    buffer_load_dwordx4 v[116:119], v2, s[4:7], s74 offen offset:1024 sc1
    buffer_load_dwordx4 v[120:123], v2, s[4:7], s74 offen offset:2048 sc1
    buffer_load_dwordx4 v[124:127], v2, s[4:7], s74 offen offset:3072 sc1
    s_add_u32 s74, s72, 28672
    buffer_load_dwordx4 v[64:67], v2, s[4:7], s74 offen offset:0 sc1
    buffer_load_dwordx4 v[68:71], v2, s[4:7], s74 offen offset:1024 sc1
    buffer_load_dwordx4 v[72:75], v2, s[4:7], s74 offen offset:2048 sc1
    buffer_load_dwordx4 v[76:79], v2, s[4:7], s74 offen offset:3072 sc1
    s_waitcnt vmcnt(0)
    v_max3_u32 v5, v96, v100, v104
    v_max_u32 v5, v5, v108
    v_cmp_eq_u32 vcc, -1, v5
    s_cbranch_vccnz Ls_132
    s_branch Lq_131
Ls_134:
    s_add_u32 s71, s71, 1
    s_cmp_gt_u32 s71, 32768
    s_cbranch_scc1 Lq_133
    s_sleep 1
    s_add_u32 s74, s72, 24576
    buffer_load_dwordx4 v[112:115], v2, s[4:7], s74 offen offset:0 sc1
    buffer_load_dwordx4 v[116:119], v2, s[4:7], s74 offen offset:1024 sc1
    buffer_load_dwordx4 v[120:123], v2, s[4:7], s74 offen offset:2048 sc1
    buffer_load_dwordx4 v[124:127], v2, s[4:7], s74 offen offset:3072 sc1
    s_add_u32 s74, s72, 28672
    buffer_load_dwordx4 v[64:67], v2, s[4:7], s74 offen offset:0 sc1
    buffer_load_dwordx4 v[68:71], v2, s[4:7], s74 offen offset:1024 sc1
    buffer_load_dwordx4 v[72:75], v2, s[4:7], s74 offen offset:2048 sc1
    buffer_load_dwordx4 v[76:79], v2, s[4:7], s74 offen offset:3072 sc1
    s_add_u32 s74, s72, 131072
    buffer_load_dwordx4 v[80:83], v2, s[4:7], s74 offen offset:0 sc1
    buffer_load_dwordx4 v[84:87], v2, s[4:7], s74 offen offset:1024 sc1
    buffer_load_dwordx4 v[88:91], v2, s[4:7], s74 offen offset:2048 sc1
    buffer_load_dwordx4 v[92:95], v2, s[4:7], s74 offen offset:3072 sc1
    s_waitcnt vmcnt(0)
    v_max3_u32 v5, v112, v116, v120
    v_max_u32 v5, v5, v124
    v_cmp_eq_u32 vcc, -1, v5
    s_cbranch_vccnz Ls_134
    s_branch Lq_133
Ls_136:
    s_add_u32 s71, s71, 1
    s_cmp_gt_u32 s71, 32768
    s_cbranch_scc1 Lq_135
    s_sleep 1
    s_add_u32 s74, s72, 28672
    buffer_load_dwordx4 v[64:67], v2, s[4:7], s74 offen offset:0 sc1
    buffer_load_dwordx4 v[68:71], v2, s[4:7], s74 offen offset:1024 sc1
    buffer_load_dwordx4 v[72:75], v2, s[4:7], s74 offen offset:2048 sc1
    buffer_load_dwordx4 v[76:79], v2, s[4:7], s74 offen offset:3072 sc1
    s_add_u32 s74, s72, 131072
    buffer_load_dwordx4 v[80:83], v2, s[4:7], s74 offen offset:0 sc1
    buffer_load_dwordx4 v[84:87], v2, s[4:7], s74 offen offset:1024 sc1
    buffer_load_dwordx4 v[88:91], v2, s[4:7], s74 offen offset:2048 sc1
    buffer_load_dwordx4 v[92:95], v2, s[4:7], s74 offen offset:3072 sc1
    s_add_u32 s74, s72, 135168
    buffer_load_dwordx4 v[96:99], v2, s[4:7], s74 offen offset:0 sc1
    buffer_load_dwordx4 v[100:103], v2, s[4:7], s74 offen offset:1024 sc1
    buffer_load_dwordx4 v[104:107], v2, s[4:7], s74 offen offset:2048 sc1
    buffer_load_dwordx4 v[108:111], v2, s[4:7], s74 offen offset:3072 sc1
    s_waitcnt vmcnt(0)
    v_max3_u32 v5, v64, v68, v72
    v_max_u32 v5, v5, v76
    v_cmp_eq_u32 vcc, -1, v5
    s_cbranch_vccnz Ls_136
    s_branch Lq_135
Ls_138:
    s_add_u32 s71, s71, 1
    s_cmp_gt_u32 s71, 32768
    s_cbranch_scc1 Lq_137
    s_sleep 1
    s_add_u32 s74, s72, 131072
    buffer_load_dwordx4 v[80:83], v2, s[4:7], s74 offen offset:0 sc1
    buffer_load_dwordx4 v[84:87], v2, s[4:7], s74 offen offset:1024 sc1
    buffer_load_dwordx4 v[88:91], v2, s[4:7], s74 offen offset:2048 sc1
    buffer_load_dwordx4 v[92:95], v2, s[4:7], s74 offen offset:3072 sc1
    s_add_u32 s74, s72, 135168
    buffer_load_dwordx4 v[96:99], v2, s[4:7], s74 offen offset:0 sc1
    buffer_load_dwordx4 v[100:103], v2, s[4:7], s74 offen offset:1024 sc1
    buffer_load_dwordx4 v[104:107], v2, s[4:7], s74 offen offset:2048 sc1
    buffer_load_dwordx4 v[108:111], v2, s[4:7], s74 offen offset:3072 sc1
    s_add_u32 s74, s72, 139264
    buffer_load_dwordx4 v[112:115], v2, s[4:7], s74 offen offset:0 sc1
    buffer_load_dwordx4 v[116:119], v2, s[4:7], s74 offen offset:1024 sc1
    buffer_load_dwordx4 v[120:123], v2, s[4:7], s74 offen offset:2048 sc1
    buffer_load_dwordx4 v[124:127], v2, s[4:7], s74 offen offset:3072 sc1
    s_waitcnt vmcnt(0)
    v_max3_u32 v5, v80, v84, v88
    v_max_u32 v5, v5, v92
    v_cmp_eq_u32 vcc, -1, v5
    s_cbranch_vccnz Ls_138
    s_branch Lq_137
Ls_140:
    s_add_u32 s71, s71, 1
    s_cmp_gt_u32 s71, 32768
    s_cbranch_scc1 Lq_139
    s_sleep 1
    s_add_u32 s74, s72, 135168
    buffer_load_dwordx4 v[96:99], v2, s[4:7], s74 offen offset:0 sc1
    buffer_load_dwordx4 v[100:103], v2, s[4:7], s74 offen offset:1024 sc1
    buffer_load_dwordx4 v[104:107], v2, s[4:7], s74 offen offset:2048 sc1
    buffer_load_dwordx4 v[108:111], v2, s[4:7], s74 offen offset:3072 sc1
    s_add_u32 s74, s72, 139264
    buffer_load_dwordx4 v[112:115], v2, s[4:7], s74 offen offset:0 sc1
    buffer_load_dwordx4 v[116:119], v2, s[4:7], s74 offen offset:1024 sc1
    buffer_load_dwordx4 v[120:123], v2, s[4:7], s74 offen offset:2048 sc1
    buffer_load_dwordx4 v[124:127], v2, s[4:7], s74 offen offset:3072 sc1
    s_add_u32 s74, s72, 143360
    buffer_load_dwordx4 v[80:83], v2, s[4:7], s74 offen offset:0 sc1
    buffer_load_dwordx4 v[84:87], v2, s[4:7], s74 offen offset:1024 sc1
    buffer_load_dwordx4 v[88:91], v2, s[4:7], s74 offen offset:2048 sc1
    buffer_load_dwordx4 v[92:95], v2, s[4:7], s74 offen offset:3072 sc1
    s_waitcnt vmcnt(0)
    v_max3_u32 v5, v96, v100, v104
    v_max_u32 v5, v5, v108
    v_cmp_eq_u32 vcc, -1, v5
    s_cbranch_vccnz Ls_140
    s_branch Lq_139
Ls_142:
    s_add_u32 s71, s71, 1
    s_cmp_gt_u32 s71, 32768
    s_cbranch_scc1 Lq_141
    s_sleep 1
    s_add_u32 s74, s72, 139264
    buffer_load_dwordx4 v[112:115], v2, s[4:7], s74 offen offset:0 sc1
    buffer_load_dwordx4 v[116:119], v2, s[4:7], s74 offen offset:1024 sc1
    buffer_load_dwordx4 v[120:123], v2, s[4:7], s74 offen offset:2048 sc1
    buffer_load_dwordx4 v[124:127], v2, s[4:7], s74 offen offset:3072 sc1
    s_add_u32 s74, s72, 143360
    buffer_load_dwordx4 v[80:83], v2, s[4:7], s74 offen offset:0 sc1
    buffer_load_dwordx4 v[84:87], v2, s[4:7], s74 offen offset:1024 sc1
    buffer_load_dwordx4 v[88:91], v2, s[4:7], s74 offen offset:2048 sc1
    buffer_load_dwordx4 v[92:95], v2, s[4:7], s74 offen offset:3072 sc1
    s_add_u32 s74, s72, 147456
    buffer_load_dwordx4 v[96:99], v2, s[4:7], s74 offen offset:0 sc1
    buffer_load_dwordx4 v[100:103], v2, s[4:7], s74 offen offset:1024 sc1
    buffer_load_dwordx4 v[104:107], v2, s[4:7], s74 offen offset:2048 sc1
    buffer_load_dwordx4 v[32:35], v2, s[4:7], s74 offen offset:3072 sc1
    s_waitcnt vmcnt(0)
    v_max3_u32 v5, v112, v116, v120
    v_max_u32 v5, v5, v124
    v_cmp_eq_u32 vcc, -1, v5
    s_cbranch_vccnz Ls_142
    s_branch Lq_141
Ls_144:
    s_add_u32 s71, s71, 1
    s_cmp_gt_u32 s71, 32768
    s_cbranch_scc1 Lq_143
    s_sleep 1
    s_add_u32 s74, s72, 143360
    buffer_load_dwordx4 v[80:83], v2, s[4:7], s74 offen offset:0 sc1
    buffer_load_dwordx4 v[84:87], v2, s[4:7], s74 offen offset:1024 sc1
    buffer_load_dwordx4 v[88:91], v2, s[4:7], s74 offen offset:2048 sc1
    buffer_load_dwordx4 v[92:95], v2, s[4:7], s74 offen offset:3072 sc1
    s_add_u32 s74, s72, 147456
    buffer_load_dwordx4 v[96:99], v2, s[4:7], s74 offen offset:0 sc1
    buffer_load_dwordx4 v[100:103], v2, s[4:7], s74 offen offset:1024 sc1
    buffer_load_dwordx4 v[104:107], v2, s[4:7], s74 offen offset:2048 sc1
    buffer_load_dwordx4 v[32:35], v2, s[4:7], s74 offen offset:3072 sc1
    s_add_u32 s74, s72, 151552
    buffer_load_dwordx4 v[36:39], v2, s[4:7], s74 offen offset:0 sc1
    buffer_load_dwordx4 v[40:43], v2, s[4:7], s74 offen offset:1024 sc1
    buffer_load_dwordx4 v[44:47], v2, s[4:7], s74 offen offset:2048 sc1
    buffer_load_dwordx4 v[108:111], v2, s[4:7], s74 offen offset:3072 sc1
    s_waitcnt vmcnt(0)
    v_max3_u32 v5, v80, v84, v88
    v_max_u32 v5, v5, v92
    v_cmp_eq_u32 vcc, -1, v5
    s_cbranch_vccnz Ls_144
    s_branch Lq_143
Ls_146:
    s_add_u32 s71, s71, 1
    s_cmp_gt_u32 s71, 32768
    s_cbranch_scc1 Lq_145
    s_sleep 1
    s_add_u32 s74, s72, 147456
    buffer_load_dwordx4 v[96:99], v2, s[4:7], s74 offen offset:0 sc1
    buffer_load_dwordx4 v[100:103], v2, s[4:7], s74 offen offset:1024 sc1
    buffer_load_dwordx4 v[104:107], v2, s[4:7], s74 offen offset:2048 sc1
    buffer_load_dwordx4 v[32:35], v2, s[4:7], s74 offen offset:3072 sc1
    s_add_u32 s74, s72, 151552
    buffer_load_dwordx4 v[36:39], v2, s[4:7], s74 offen offset:0 sc1
    buffer_load_dwordx4 v[40:43], v2, s[4:7], s74 offen offset:1024 sc1
    buffer_load_dwordx4 v[44:47], v2, s[4:7], s74 offen offset:2048 sc1
    buffer_load_dwordx4 v[108:111], v2, s[4:7], s74 offen offset:3072 sc1
    s_add_u32 s74, s72, 155648
    buffer_load_dwordx4 v[112:115], v2, s[4:7], s74 offen offset:0 sc1
    buffer_load_dwordx4 v[116:119], v2, s[4:7], s74 offen offset:1024 sc1
    buffer_load_dwordx4 v[120:123], v2, s[4:7], s74 offen offset:2048 sc1
    buffer_load_dwordx4 v[124:127], v2, s[4:7], s74 offen offset:3072 sc1
    s_waitcnt vmcnt(0)
    v_max3_u32 v5, v96, v100, v104
    v_max_u32 v5, v5, v32
    v_cmp_eq_u32 vcc, -1, v5
    s_cbranch_vccnz Ls_146
    s_branch Lq_145
Ls_148:
    s_add_u32 s71, s71, 1
    s_cmp_gt_u32 s71, 32768
    s_cbranch_scc1 Lq_147
    s_sleep 1
    s_add_u32 s74, s72, 151552
    buffer_load_dwordx4 v[36:39], v2, s[4:7], s74 offen offset:0 sc1
    buffer_load_dwordx4 v[40:43], v2, s[4:7], s74 offen offset:1024 sc1
    buffer_load_dwordx4 v[44:47], v2, s[4:7], s74 offen offset:2048 sc1
    buffer_load_dwordx4 v[108:111], v2, s[4:7], s74 offen offset:3072 sc1
    s_add_u32 s74, s72, 155648
    buffer_load_dwordx4 v[112:115], v2, s[4:7], s74 offen offset:0 sc1
    buffer_load_dwordx4 v[116:119], v2, s[4:7], s74 offen offset:1024 sc1
    buffer_load_dwordx4 v[120:123], v2, s[4:7], s74 offen offset:2048 sc1
    buffer_load_dwordx4 v[124:127], v2, s[4:7], s74 offen offset:3072 sc1
    s_add_u32 s74, s72, 159744
    buffer_load_dwordx4 v[80:83], v2, s[4:7], s74 offen offset:0 sc1
    buffer_load_dwordx4 v[84:87], v2, s[4:7], s74 offen offset:1024 sc1
    buffer_load_dwordx4 v[88:91], v2, s[4:7], s74 offen offset:2048 sc1
    buffer_load_dwordx4 v[92:95], v2, s[4:7], s74 offen offset:3072 sc1
    s_waitcnt vmcnt(0)
    v_max3_u32 v5, v36, v40, v44
    v_max_u32 v5, v5, v108
    v_cmp_eq_u32 vcc, -1, v5
    s_cbranch_vccnz Ls_148
    s_branch Lq_147
Ls_150:
    s_add_u32 s71, s71, 1
    s_cmp_gt_u32 s71, 32768
    s_cbranch_scc1 Lq_149
    s_sleep 1
    s_add_u32 s74, s72, 155648
    buffer_load_dwordx4 v[112:115], v2, s[4:7], s74 offen offset:0 sc1
    buffer_load_dwordx4 v[116:119], v2, s[4:7], s74 offen offset:1024 sc1
    buffer_load_dwordx4 v[120:123], v2, s[4:7], s74 offen offset:2048 sc1
    buffer_load_dwordx4 v[124:127], v2, s[4:7], s74 offen offset:3072 sc1
    s_add_u32 s74, s72, 159744
    buffer_load_dwordx4 v[80:83], v2, s[4:7], s74 offen offset:0 sc1
    buffer_load_dwordx4 v[84:87], v2, s[4:7], s74 offen offset:1024 sc1
    buffer_load_dwordx4 v[88:91], v2, s[4:7], s74 offen offset:2048 sc1
    buffer_load_dwordx4 v[92:95], v2, s[4:7], s74 offen offset:3072 sc1
    s_waitcnt vmcnt(0)
    v_max3_u32 v5, v112, v116, v120
    v_max_u32 v5, v5, v124
    v_cmp_eq_u32 vcc, -1, v5
    s_cbranch_vccnz Ls_150
    s_branch Lq_149
Ls_152:
    s_add_u32 s71, s71, 1
    s_cmp_gt_u32 s71, 32768
    s_cbranch_scc1 Lq_151
    s_sleep 1
    s_add_u32 s74, s72, 159744
    buffer_load_dwordx4 v[80:83], v2, s[4:7], s74 offen offset:0 sc1
    buffer_load_dwordx4 v[84:87], v2, s[4:7], s74 offen offset:1024 sc1
    buffer_load_dwordx4 v[88:91], v2, s[4:7], s74 offen offset:2048 sc1
    buffer_load_dwordx4 v[92:95], v2, s[4:7], s74 offen offset:3072 sc1
    s_waitcnt vmcnt(0)
    v_max3_u32 v5, v80, v84, v88
    v_max_u32 v5, v5, v92
    v_cmp_eq_u32 vcc, -1, v5
    s_cbranch_vccnz Ls_152
    s_branch Lq_151
L_code_end:
.section .rodata,"a"
.p2align 6
.amdhsa_kernel interleave_layers__ssm_conv_s4__mixer_token_mlp__prompt_kernel
  .amdhsa_next_free_vgpr 512
  .amdhsa_next_free_sgpr 102
  .amdhsa_accum_offset 256
  .amdhsa_group_segment_fixed_size 0
  .amdhsa_kernarg_size 136
  .amdhsa_user_sgpr_count 2
  .amdhsa_user_sgpr_kernarg_segment_ptr 1
  .amdhsa_system_sgpr_workgroup_id_x 1
  .amdhsa_float_denorm_mode_32 3
.end_amdhsa_kernel
```
